```python
import torch

def _softmax(x, axis=-1):
    return torch.softmax(x, dim=axis)
def _gelu(x):
    return torch.nn.functional.gelu(x, approximate="tanh")
def _silu(x):
    return torch.nn.functional.silu(x)
def _sigmoid(x):
    return torch.sigmoid(x)
def _layernorm(x, axis=-1, eps=1e-5):
    m = x.mean(dim=axis, keepdim=True)
    v = x.var(dim=axis, keepdim=True, unbiased=False)
    return (x - m) / torch.sqrt(v + eps)
def _scatter_add(tgt, idx, src, axis=0):
    return tgt.clone().index_add_(axis, idx, src)
def _segment_sum(src, seg, n):
    out = torch.zeros((n,) + src.shape[1:], dtype=src.dtype)
    return out.index_add_(0, seg, src)
def _pad(x, pw):
    flat = tuple(v for pair in reversed(pw) for v in pair)
    return torch.nn.functional.pad(x, flat)

kernel_name = 'recurrent_scan__sliding_block_cached__swiglu_ffn__prompt'

def setup_inputs():

    _w = (lambda a: (lambda t: t.to(torch.bfloat16) if t.is_floating_point() else t)(torch.as_tensor(a)))
    def _A_setup():
        B, Sq, D = 1, 2048, 576
        Hq, Hkv, Sk, Dh = 32, 16, 2048, 128
        assert Hq % Hkv == 0, (Hq, Hkv)
        return {
            "x": _w((lambda *s: torch.randn(*s, dtype=torch.bfloat16) * 0.05)(B, Sq, D)),
            "k_cache": _w((lambda *s: torch.randn(*s, dtype=torch.bfloat16) * 0.8)(B, Hkv, Sk, Dh)),
            "v_cache": _w((lambda *s: torch.randn(*s, dtype=torch.bfloat16) * 0.2)(B, Hkv, Sk, Dh)),
            "wq": _w((lambda *s: torch.randn(*s, dtype=torch.bfloat16) * 0.8)(D, Hq * Dh) * (D ** -0.5)),
            "wo": _w((lambda *s: torch.randn(*s, dtype=torch.bfloat16) * 0.2)(Hq * Dh, D) * ((Hq * Dh) ** -0.5)),
        }
    _A_in = _A_setup()

    def _B_setup():
        B, S, D, F = 1, 2048, 576, 4608
        return {
            "x": _w((lambda *s: torch.randn(*s, dtype=torch.bfloat16) * 0.05)(B, S, D)),
            "w_gate": _w((lambda *s: torch.randn(*s, dtype=torch.bfloat16) * 0.1)(D, F)),
            "w_up": _w((lambda *s: torch.randn(*s, dtype=torch.bfloat16) * 0.1)(D, F)),
            "w_down": _w((lambda *s: torch.randn(*s, dtype=torch.bfloat16) * 0.1)(F, D)),
        }
    _B_in = _B_setup()

    return {
        "A_x": _A_in["x"],
        "A_k_cache": _A_in["k_cache"],
        "A_v_cache": _A_in["v_cache"],
        "A_wq": _A_in["wq"],
        "A_wo": _A_in["wo"],
        "B_x": _B_in["x"],
        "B_w_gate": _B_in["w_gate"],
        "B_w_up": _B_in["w_up"],
        "B_w_down": _B_in["w_down"],
    }

def reference(A_x, A_k_cache, A_v_cache, A_wq, A_wo, B_x, B_w_gate, B_w_up, B_w_down):
    def _A_ref(x, k_cache, v_cache, wq, wo):
        B, Sq, D = x.shape
        Hq, Dh = 32, 128
        Hkv, Sk = k_cache.shape[1], k_cache.shape[2]
        W = min(4096, max(256, Sk // 4))
        rep = Hq // Hkv
        q = (lambda x, *d: x.permute(*d))((x @ wq).reshape(B, Sq, Hq, Dh), 0, 2, 1, 3)
        k = (lambda x, n, axis: torch.repeat_interleave(x, n, dim=axis))(k_cache[:, :, Sk - W:, :], rep, axis=1)
        v = (lambda x, n, axis: torch.repeat_interleave(x, n, dim=axis))(v_cache[:, :, Sk - W:, :], rep, axis=1)
        scores = torch.einsum("bhqd,bhkd->bhqk", q, k) * (Dh ** -0.5)
        p = _softmax(scores, axis=-1)
        o = torch.einsum("bhqk,bhkd->bhqd", p, v)
        return (lambda x, *d: x.permute(*d))(o, 0, 2, 1, 3).reshape(B, Sq, Hq * Dh) @ wo

    def _B_ref(x, w_gate, w_up, w_down):
        g = _silu(x @ w_gate)
        u = x @ w_up
        return (g * u) @ w_down

    x = A_x
    xn = _layernorm(x, axis=-1)
    s = _A_ref(xn, A_k_cache, A_v_cache, A_wq, A_wo)
    g = _silu(_B_ref(xn, B_w_gate, B_w_up, B_w_down))
    return x + s * g
```

```asm
; @launch grid=(256,1,1) block=(256,1,1) lds=163840
.amdgcn_target "amdgcn-amd-amdhsa--gfx950"
.macro add d a b
v_add_f32 v\d, v\a, v\b
.endm
.macro aw d a
v_accvgpr_write_b32 a\d, v\a
.endm
.macro cvt d a b
v_cvt_pk_bf16_f32 v\d, v\a, v\b
.endm
.macro dma v r s o
buffer_load_dwordx4 v\v, s[\r:\r+3], s\s offen offset:\o lds
.endm
.macro exp d a
v_exp_f32 v\d, v\a
.endm
.macro fma d a b c
v_fma_f32 v\d, v\a, v\b, v\c
.endm
.macro maav d a b
v_mfma_f32_16x16x32_bf16 a[\d:\d+3], a[\a:\a+3], v[\b:\b+3], a[\d:\d+3]
.endm
.macro mcvvv d a b c
v_mfma_f32_16x16x32_bf16 v[\d:\d+3], v[\a:\a+3], v[\b:\b+3], v[\c:\c+3]
.endm
.macro mul d a b
v_mul_f32 v\d, v\a, v\b
.endm
.macro mvaa d a b
v_mfma_f32_16x16x32_bf16 v[\d:\d+3], a[\a:\a+3], a[\b:\b+3], v[\d:\d+3]
.endm
.macro mvav d a b
v_mfma_f32_16x16x32_bf16 v[\d:\d+3], a[\a:\a+3], v[\b:\b+3], v[\d:\d+3]
.endm
.macro mvva d a b
v_mfma_f32_16x16x32_bf16 v[\d:\d+3], v[\a:\a+3], a[\b:\b+3], v[\d:\d+3]
.endm
.macro mvvv d a b
v_mfma_f32_16x16x32_bf16 v[\d:\d+3], v[\a:\a+3], v[\b:\b+3], v[\d:\d+3]
.endm
.macro mzaav d a b
v_mfma_f32_16x16x32_bf16 a[\d:\d+3], a[\a:\a+3], v[\b:\b+3], 0
.endm
.macro mzvaa d a b
v_mfma_f32_16x16x32_bf16 v[\d:\d+3], a[\a:\a+3], a[\b:\b+3], 0
.endm
.macro mzvav d a b
v_mfma_f32_16x16x32_bf16 v[\d:\d+3], a[\a:\a+3], v[\b:\b+3], 0
.endm
.macro mzvva d a b
v_mfma_f32_16x16x32_bf16 v[\d:\d+3], v[\a:\a+3], a[\b:\b+3], 0
.endm
.macro mzvvv d a b
v_mfma_f32_16x16x32_bf16 v[\d:\d+3], v[\a:\a+3], v[\b:\b+3], 0
.endm
.macro rcp d a
v_rcp_f32 v\d, v\a
.endm
.macro rda d a o
ds_read_b128 a[\d:\d+3], v\a offset:\o
.endm
.macro rdv d a o
ds_read_b128 v[\d:\d+3], v\a offset:\o
.endm
.macro tra d a o
ds_read_b64_tr_b16 a[\d:\d+1], v\a offset:\o
.endm
.macro trv d a o
ds_read_b64_tr_b16 v[\d:\d+1], v\a offset:\o
.endm
.macro wl n
s_waitcnt lgkmcnt(\n)
.endm
.text
.globl recurrent_scan__sliding_block_cached__swiglu_ffn__prompt_kernel
.p2align 8
.type recurrent_scan__sliding_block_cached__swiglu_ffn__prompt_kernel,@function
recurrent_scan__sliding_block_cached__swiglu_ffn__prompt_kernel:
s_cmp_lt_u32 s2, 256
s_cbranch_scc1 L_go
s_endpgm
L_go:
s_mov_b32 s88, 0
L_restart:
s_load_dwordx16 s[16:31], s[0:1], 0
s_load_dwordx8 s[32:39], s[0:1], 64
v_and_b32 v1, 63, v0
v_lshrrev_b32 v2, 6, v0
s_nop 0
v_readfirstlane_b32 s64, v2
s_and_b32 s78, s2, 7
s_lshr_b32 s71, s2, 3
s_lshr_b32 s73, s71, 4
s_and_b32 s71, s71, 15
s_mov_b32 s70, s78
s_mov_b32 s72, s71
s_and_b32 s74, s64, 1
s_lshr_b32 s75, s64, 1
s_lshl_b32 s65, s64, 11
s_lshl_b32 s78, s72, 2
s_lshl_b32 s79, s74, 1
s_add_u32 s78, s78, s79
s_add_u32 s78, s78, s75
s_mul_i32 s90, s78, 36864
s_add_u32 s91, s90, 9216
s_add_u32 s92, s90, 18432
s_add_u32 s93, s90, 27648
v_lshrrev_b32 v2, 3, v1
v_and_b32 v3, 7, v1
v_mul_u32_u24 v2, 1152, v2
v_lshl_add_u32 v52, v3, 4, v2
s_getpc_b64 s[84:85]
L_pc:
s_mul_i32 s78, s73, L_ffn - L_pc
s_add_u32 s84, s84, s78
s_addc_u32 s85, s85, 0
s_lshl_b32 s78, s71, 2
s_add_u32 s78, s78, s64
s_and_b32 s78, s78, 63
v_lshlrev_b32 v3, 13, v1
s_lshl_b32 s78, s78, 7
v_add_u32 v3, s78, v3
s_mul_i32 s86, s73, (L_end - L_ffn) - (L_redo - L_pc)
s_add_u32 s86, s86, L_redo - L_pc
s_mov_b32 s87, 0x20000
buffer_load_dword v43, v3, s[84:87], 0 offen
wl 0
s_mov_b32 s40, s16
s_mov_b32 s41, s17
s_mov_b32 s42, 2359296
s_mov_b32 s43, 0x20000
buffer_load_dwordx4 v[88:91], v52, s[40:43], s90 offen offset:0
s_lshl_b32 s78, s73, 3
buffer_load_dwordx4 v[92:95], v52, s[40:43], s90 offen offset:128
s_add_u32 s78, s78, s70
buffer_load_dwordx4 v[96:99], v52, s[40:43], s90 offen offset:256
s_lshl_b32 s78, s78, 4
buffer_load_dwordx4 v[100:103], v52, s[40:43], s90 offen offset:384
s_add_u32 s78, s78, s72
buffer_load_dwordx4 v[104:107], v52, s[40:43], s90 offen offset:512
s_mul_i32 s78, s78, 147456
buffer_load_dwordx4 v[108:111], v52, s[40:43], s90 offen offset:640
s_add_u32 s60, s38, s78
buffer_load_dwordx4 v[112:115], v52, s[40:43], s90 offen offset:768
s_addc_u32 s61, s39, 0
s_mov_b32 s62, 147456
buffer_load_dwordx4 v[116:119], v52, s[40:43], s90 offen offset:896
s_mov_b32 s63, 0x20000
buffer_load_dwordx4 v[120:123], v52, s[40:43], s90 offen offset:1024
buffer_load_dwordx4 v[124:127], v52, s[40:43], s91 offen offset:0
buffer_load_dwordx4 v[128:131], v52, s[40:43], s91 offen offset:128
buffer_load_dwordx4 v[132:135], v52, s[40:43], s91 offen offset:256
buffer_load_dwordx4 v[136:139], v52, s[40:43], s91 offen offset:384
buffer_load_dwordx4 v[140:143], v52, s[40:43], s91 offen offset:512
buffer_load_dwordx4 v[144:147], v52, s[40:43], s91 offen offset:640
buffer_load_dwordx4 v[148:151], v52, s[40:43], s91 offen offset:768
buffer_load_dwordx4 v[152:155], v52, s[40:43], s91 offen offset:896
buffer_load_dwordx4 v[156:159], v52, s[40:43], s91 offen offset:1024
s_cmp_eq_u32 s73, 0
s_cbranch_scc0 L_ffn
s_lshl_b32 s80, s70, 10
s_add_u32 s44, s22, s80
s_addc_u32 s45, s23, 0
s_sub_u32 s44, s44, 1024
s_subb_u32 s45, s45, 0
s_sub_u32 s46, 4719616, s80
s_mov_b32 s47, 0x20000
s_lshl_b32 s80, s70, 20
s_add_u32 s80, s80, 393216
s_add_u32 s48, s18, s80
s_addc_u32 s49, s19, 0
s_sub_u32 s50, 8388608, s80
s_mov_b32 s51, 0x20000
s_add_u32 s56, s20, s80
s_addc_u32 s57, s21, 0
s_sub_u32 s56, s56, 1024
s_subb_u32 s57, s57, 0
s_sub_u32 s58, 8389632, s80
s_mov_b32 s59, 0x20000
s_mul_i32 s80, s70, 589824
s_add_u32 s52, s24, s80
s_addc_u32 s53, s25, 0
s_mov_b32 s54, 589824
s_mov_b32 s55, 0x20000
v_lshrrev_b32 v24, 3, v1
v_and_b32 v25, 7, v1
v_bfe_u32 v26, v24, 1, 1
s_and_b32 s78, s64, 1
s_lshl_b32 s78, s78, 1
v_or_b32 v26, s78, v26
v_lshlrev_b32 v26, 1, v26
v_xor_b32 v25, v25, v26
s_lshl_b32 s78, s64, 3
v_add_u32 v27, s78, v24
v_mul_u32_u24 v27, 8192, v27
v_lshl_add_u32 v5, v25, 4, v27
v_add_u32 v4, 1024, v5
v_add_u32 v5, 256, v5
v_mov_b32 v249, v1
s_and_b32 s78, s72, 15
s_lshl_b32 s78, s78, 2
s_add_u32 s78, s78, s64
s_mul_i32 s78, s78, 9
v_add_u32 v254, s78, v1
v_mul_u32_u24 v254, 8192, v254
v_mov_b32 v24, 0x7fffffff
v_cmp_gt_u32 vcc, 9, v1
s_nop 1
v_cndmask_b32 v254, v24, v254, vcc
s_lshl_b32 s78, s73, 3
s_add_u32 s78, s78, s70
s_lshl_b32 s78, s78, 7
v_mov_b32 v250, 0x10000
v_mov_b32 v251, s78
v_cmp_eq_u32 vcc, 0, v0
s_cmp_eq_u32 s88, 0
s_cselect_b64 s[80:81], vcc, 0
v_cndmask_b32 v53, v250, v251, s[80:81]
v_cndmask_b32 v250, v250, v251, vcc
v_mov_b32 v251, 0
s_lshl_b32 s78, s72, 2
v_mov_b32 v54, s78
v_cndmask_b32 v54, v53, v54, s[80:81]
s_lshl_b32 s98, s72, 11
s_add_u32 s98, s98, 41943040
v_mov_b32 v248, v54
v_lshrrev_b32 v24, 3, v1
v_and_b32 v25, 7, v1
v_bfe_u32 v26, v24, 1, 1
s_and_b32 s78, s64, 1
s_lshl_b32 s78, s78, 1
v_or_b32 v26, s78, v26
v_lshlrev_b32 v26, 1, v26
v_xor_b32 v25, v25, v26
s_lshl_b32 s78, s64, 2
v_and_b32 v27, 3, v24
v_add_u32 v27, s78, v27
v_lshrrev_b32 v24, 2, v24
v_lshl_add_u32 v27, v24, 4, v27
v_mul_u32_u24 v27, 256, v27
v_lshl_add_u32 v3, v25, 4, v27
v_add_u32 v2, 1024, v3
v_add_u32 v3, 128, v3
v_lshrrev_b32 v24, 3, v1
v_and_b32 v25, 7, v1
v_bfe_u32 v26, v24, 1, 1
s_and_b32 s78, s64, 1
s_lshl_b32 s78, s78, 1
v_or_b32 v26, s78, v26
v_lshlrev_b32 v26, 1, v26
v_xor_b32 v25, v25, v26
s_lshl_b32 s78, s64, 2
v_and_b32 v27, 3, v24
v_add_u32 v27, s78, v27
v_lshrrev_b32 v24, 2, v24
v_lshl_add_u32 v27, v24, 4, v27
v_mul_u32_u24 v27, 1152, v27
v_lshl_add_u32 v30, v25, 4, v27
v_add_u32 v31, 35840, v30
v_lshrrev_b32 v24, 4, v1
v_bfe_u32 v25, v1, 2, 2
v_lshrrev_b32 v26, 1, v25
v_and_b32 v6, 1, v24
v_lshl_or_b32 v26, v6, 1, v26
v_lshlrev_b32 v6, 11, v24
v_lshl_or_b32 v6, v25, 7, v6
v_lshl_or_b32 v6, v26, 5, v6
v_and_b32 v24, 3, v1
v_lshl_or_b32 v6, v24, 3, v6
s_lshl_b32 s78, s75, 10
v_add_u32 v6, s78, v6
v_xor_b32 v7, 32, v6
v_xor_b32 v8, 64, v6
v_xor_b32 v9, 96, v6
v_add_u32 v10, 0x10000, v6
v_add_u32 v11, 0x10000, v7
v_add_u32 v12, 0x10000, v8
v_add_u32 v13, 0x10000, v9
v_lshrrev_b32 v24, 4, v1
s_lshl_b32 s78, s64, 3
v_add_u32 v24, s78, v24
v_xor_b32 v25, v24, v1
v_and_b32 v25, 15, v25
v_lshlrev_b32 v24, 8, v24
v_lshl_or_b32 v14, v25, 4, v24
v_xor_b32 v15, 64, v14
v_and_b32 v24, 15, v1
v_lshrrev_b32 v25, 4, v1
v_xor_b32 v26, v24, v25
v_lshlrev_b32 v26, 4, v26
v_lshl_or_b32 v16, v24, 8, v26
v_xor_b32 v17, 64, v16
v_xor_b32 v18, 128, v16
v_xor_b32 v19, 192, v16
v_lshrrev_b32 v26, 1, v25
v_lshl_add_u32 v26, v26, 4, v24
v_lshlrev_b32 v26, 4, v26
v_and_b32 v25, 1, v25
v_lshl_or_b32 v26, v25, 3, v26
s_lshl_b32 s78, s64, 14
s_add_u32 s78, s78, 98304
v_add_u32 v0, s78, v26
v_lshlrev_b32 v28, 4, v1
s_lshl_b32 s79, s64, 12
v_add_u32 v29, s79, v28
v_add_u32 v27, s78, v28
s_lshl_b32 s78, s74, 14
s_add_u32 s78, s78, 98304
v_add_u32 v28, s78, v28
v_lshrrev_b32 v242, 4, v1
v_bfe_u32 v240, v1, 2, 2
v_cmp_eq_u32 s[96:97], v240, v242
v_and_b32 v240, 1, v1
v_lshlrev_b32 v240, 4, v240
v_mov_b32 v241, 0x3f80
v_lshlrev_b32 v241, v240, v241
v_cndmask_b32 v241, 0, v241, s[96:97]
v_and_b32 v240, 2, v1
v_cmp_eq_u32 vcc, 0, v240
s_nop 1
v_cndmask_b32 v38, 0, v241, vcc
v_cndmask_b32 v39, v241, 0, vcc
v_mov_b32 v36, 0
v_mov_b32 v37, 0
v_mov_b32 v40, 0
v_mov_b32 v41, 0
v_mov_b32 v240, 0x3f803f80
v_cndmask_b32 v32, 0, v240, s[96:97]
v_cndmask_b32 v33, 0, v240, s[96:97]
v_cndmask_b32 v34, 0, v240, s[96:97]
v_cndmask_b32 v35, 0, v240, s[96:97]
s_mul_i32 s78, s64, 18432
s_add_u32 s78, s78, 90112
v_and_b32 v240, 7, v1
v_lshrrev_b32 v241, 3, v1
v_xor_b32 v55, v240, v241
v_lshlrev_b32 v55, 4, v55
v_and_b32 v242, 3, v240
v_lshl_or_b32 v55, v242, 8, v55
v_lshrrev_b32 v242, 2, v240
v_lshl_or_b32 v55, v242, 10, v55
v_add_u32 v55, s78, v55
s_lshl_b32 s78, s74, 8
s_add_u32 s78, s78, 89088
s_lshl_b32 s79, s75, 7
s_add_u32 s79, s79, s78
v_lshlrev_b32 v243, 2, v241
v_add_u32 v243, s79, v243
v_and_b32 v240, 15, v1
v_lshlrev_b32 v242, 2, v240
v_add_u32 v242, s78, v242
v_lshrrev_b32 v241, 4, v1
v_xor_b32 v240, v240, v241
v_lshl_or_b32 v240, v241, 4, v240
v_lshlrev_b32 v240, 4, v240
s_mul_i32 s78, s74, 18432
s_add_u32 s78, s78, 90112
v_xor_b32 v241, 64, v240
v_add_u32 v240, s78, v240
v_add_u32 v241, s78, v241
v_and_b32 v244, 3, v1
v_cmp_eq_u32 s[82:83], 1, v244
v_cmp_eq_u32 s[84:85], 2, v244
v_cmp_eq_u32 s[86:87], 3, v244
s_waitcnt vmcnt(18)
s_mov_b64 exec, 0
s_cmp_eq_u32 s64, 0
s_cbranch_scc1 L_pga0
s_cmp_eq_u32 s64, 1
s_cbranch_scc1 L_pga1
s_cmp_eq_u32 s64, 2
s_cbranch_scc1 L_pga2
s_branch L_pga3
L_pga_back:
s_mov_b64 exec, -1
buffer_load_dwordx4 v[160:163], v52, s[40:43], s92 offen offset:0
s_waitcnt vmcnt(18)
mzvvv 44 32 88
s_waitcnt vmcnt(17)
mvvv 44 32 92
s_waitcnt vmcnt(16)
mvvv 44 32 96
buffer_load_dwordx4 v[164:167], v52, s[40:43], s92 offen offset:128
s_waitcnt vmcnt(16)
mvvv 44 32 100
s_waitcnt vmcnt(15)
mvvv 44 32 104
s_waitcnt vmcnt(14)
mvvv 44 32 108
buffer_load_dwordx4 v[168:171], v52, s[40:43], s92 offen offset:256
s_waitcnt vmcnt(14)
mvvv 44 32 112
s_waitcnt vmcnt(13)
mvvv 44 32 116
s_waitcnt vmcnt(12)
mvvv 44 32 120
buffer_load_dwordx4 v[172:175], v52, s[40:43], s92 offen offset:384
s_waitcnt vmcnt(12)
mzvvv 232 32 124
s_waitcnt vmcnt(11)
mvvv 232 32 128
s_waitcnt vmcnt(10)
mvvv 232 32 132
buffer_load_dwordx4 v[176:179], v52, s[40:43], s92 offen offset:512
s_waitcnt vmcnt(10)
mvvv 232 32 136
v_add_f32_dpp v44, v44, v44 quad_perm:[1,0,3,2] row_mask:0xf bank_mask:0xf
s_nop 1
v_add_f32_dpp v44, v44, v44 quad_perm:[2,3,0,1] row_mask:0xf bank_mask:0xf
s_waitcnt vmcnt(9)
mvvv 232 32 140
v_add_f32_dpp v44, v44, v44 row_half_mirror row_mask:0xf bank_mask:0xf
v_mul_f32 v48, 0xbae38e39, v44
v_mul_f32 v49, 0xbae38e39, v44
v_mul_f32 v50, 0xbae38e39, v44
v_mul_f32 v51, 0xbae38e39, v44
v_mfma_f32_4x4x4_16b_bf16 v[56:59], v[88:89], v[88:89], 0
buffer_load_dwordx4 v[180:183], v52, s[40:43], s92 offen offset:640
mcvvv 60 38 88 48
v_mfma_f32_4x4x4_16b_bf16 v[56:59], v[90:91], v[90:91], v[56:59]
mcvvv 68 36 88 48
buffer_load_dwordx4 v[184:187], v52, s[40:43], s92 offen offset:768
s_waitcnt vmcnt(10)
mvvv 232 32 144
v_mfma_f32_4x4x4_16b_bf16 v[56:59], v[92:93], v[92:93], v[56:59]
mcvvv 76 38 92 48
buffer_load_dwordx4 v[188:191], v52, s[40:43], s92 offen offset:896
v_mfma_f32_4x4x4_16b_bf16 v[56:59], v[94:95], v[94:95], v[56:59]
cvt 88 60 61
cvt 89 62 63
mcvvv 84 36 92 48
cvt 90 68 69
cvt 91 70 71
s_waitcnt vmcnt(10)
mvvv 232 32 148
ds_write_b128 v55, v[88:91] offset:0
v_mfma_f32_4x4x4_16b_bf16 v[56:59], v[96:97], v[96:97], v[56:59]
buffer_load_dwordx4 v[192:195], v52, s[40:43], s92 offen offset:1024
mcvvv 244 38 96 48
cvt 92 76 77
cvt 93 78 79
v_mfma_f32_4x4x4_16b_bf16 v[56:59], v[98:99], v[98:99], v[56:59]
buffer_load_dwordx4 v[196:199], v52, s[40:43], s93 offen offset:0
mcvvv 20 36 96 48
cvt 94 84 85
cvt 95 86 87
s_waitcnt vmcnt(11)
mvvv 232 32 152
ds_write_b128 v55, v[92:95] offset:2048
v_mfma_f32_4x4x4_16b_bf16 v[56:59], v[100:101], v[100:101], v[56:59]
buffer_load_dwordx4 v[200:203], v52, s[40:43], s93 offen offset:128
mcvvv 60 38 100 48
cvt 96 244 245
cvt 97 246 247
v_mfma_f32_4x4x4_16b_bf16 v[56:59], v[102:103], v[102:103], v[56:59]
cvt 98 20 21
cvt 99 22 23
mcvvv 68 36 100 48
ds_write_b128 v55, v[96:99] offset:4096
s_waitcnt vmcnt(11)
mvvv 232 32 156
buffer_load_dwordx4 v[204:207], v52, s[40:43], s93 offen offset:256
v_mfma_f32_4x4x4_16b_bf16 v[56:59], v[104:105], v[104:105], v[56:59]
mcvvv 76 38 104 48
buffer_load_dwordx4 v[208:211], v52, s[40:43], s93 offen offset:384
v_mfma_f32_4x4x4_16b_bf16 v[56:59], v[106:107], v[106:107], v[56:59]
cvt 100 60 61
cvt 101 62 63
mcvvv 84 36 104 48
cvt 102 68 69
cvt 103 70 71
v_mfma_f32_4x4x4_16b_bf16 v[56:59], v[108:109], v[108:109], v[56:59]
ds_write_b128 v55, v[100:103] offset:6144
mcvvv 244 38 108 48
buffer_load_dwordx4 v[212:215], v52, s[40:43], s93 offen offset:512
v_mfma_f32_4x4x4_16b_bf16 v[56:59], v[110:111], v[110:111], v[56:59]
v_add_f32_dpp v232, v232, v232 quad_perm:[1,0,3,2] row_mask:0xf bank_mask:0xf
s_nop 1
v_add_f32_dpp v232, v232, v232 quad_perm:[2,3,0,1] row_mask:0xf bank_mask:0xf
mcvvv 20 36 108 48
buffer_load_dwordx4 v[216:219], v52, s[40:43], s93 offen offset:640
v_mfma_f32_4x4x4_16b_bf16 v[56:59], v[112:113], v[112:113], v[56:59]
v_add_f32_dpp v232, v232, v232 row_half_mirror row_mask:0xf bank_mask:0xf
v_mul_f32 v236, 0xbae38e39, v232
mcvvv 60 38 112 48
v_mul_f32 v237, 0xbae38e39, v232
v_mul_f32 v238, 0xbae38e39, v232
v_mfma_f32_4x4x4_16b_bf16 v[56:59], v[114:115], v[114:115], v[56:59]
buffer_load_dwordx4 v[220:223], v52, s[40:43], s93 offen offset:768
mcvvv 68 36 112 48
v_mul_f32 v239, 0xbae38e39, v232
cvt 104 76 77
v_mfma_f32_4x4x4_16b_bf16 v[56:59], v[116:117], v[116:117], v[56:59]
cvt 105 78 79
cvt 106 84 85
cvt 107 86 87
mcvvv 76 38 116 48
ds_write_b128 v55, v[104:107] offset:8192
v_mfma_f32_4x4x4_16b_bf16 v[56:59], v[118:119], v[118:119], v[56:59]
buffer_load_dwordx4 v[224:227], v52, s[40:43], s93 offen offset:896
mcvvv 84 36 116 48
cvt 108 244 245
cvt 109 246 247
v_mfma_f32_4x4x4_16b_bf16 v[56:59], v[120:121], v[120:121], v[56:59]
cvt 110 20 21
cvt 111 22 23
mcvvv 244 38 120 48
ds_write_b128 v55, v[108:111] offset:10240
v_mfma_f32_4x4x4_16b_bf16 v[56:59], v[122:123], v[122:123], v[56:59]
buffer_load_dwordx4 v[228:231], v52, s[40:43], s93 offen offset:1024
mcvvv 20 36 120 48
s_mov_b32 s66, 0
s_add_u32 m0, s65, 0
v_mfma_f32_4x4x4_16b_bf16 v[64:67], v[124:125], v[124:125], 0
cvt 112 60 61
cvt 113 62 63
cvt 114 68 69
cvt 115 70 71
mcvvv 60 38 124 236
ds_write_b128 v55, v[112:115] offset:12288
v_mfma_f32_4x4x4_16b_bf16 v[64:67], v[126:127], v[126:127], v[64:67]
dma 4 44 66 0
mcvvv 68 36 124 236
cvt 116 76 77
cvt 117 78 79
s_waitcnt vmcnt(18)
mzvvv 44 32 160
cvt 118 84 85
cvt 119 86 87
s_waitcnt vmcnt(17)
mvvv 44 32 164
ds_write_b128 v55, v[116:119] offset:14336
v_mfma_f32_4x4x4_16b_bf16 v[64:67], v[128:129], v[128:129], v[64:67]
dma 5 44 66 1024
mcvvv 76 38 128 236
v_cndmask_b32 v56, v56, v57, s[82:83]
cvt 120 244 245
v_mfma_f32_4x4x4_16b_bf16 v[64:67], v[130:131], v[130:131], v[64:67]
cvt 121 246 247
cvt 122 20 21
mcvvv 84 36 128 236
cvt 123 22 23
v_cndmask_b32 v56, v56, v58, s[84:85]
s_waitcnt vmcnt(17)
mvvv 44 32 168
ds_write_b128 v55, v[120:123] offset:16384
s_waitcnt vmcnt(16)
mvvv 44 32 172
s_mov_b32 s66, 262144
s_add_u32 m0, s65, 8192
v_mfma_f32_4x4x4_16b_bf16 v[64:67], v[132:133], v[132:133], v[64:67]
dma 4 44 66 0
v_cndmask_b32 v56, v56, v59, s[86:87]
mcvvv 244 38 132 236
s_nop 0
v_add_f32_dpp v56, v56, v56 quad_perm:[1,0,3,2] row_mask:0xf bank_mask:0xf
s_nop 1
v_add_f32_dpp v56, v56, v56 quad_perm:[2,3,0,1] row_mask:0xf bank_mask:0xf
s_nop 1
v_add_f32_dpp v56, v56, v56 row_half_mirror row_mask:0xf bank_mask:0xf
v_mul_f32 v56, 0x3ae38e39, v56
v_fma_f32 v56, -v48, v48, v56
v_max_f32 v56, 0, v56
v_add_f32 v56, 0x3727c5ac, v56
ds_write_b32 v243, v56 offset:0
v_mfma_f32_4x4x4_16b_bf16 v[64:67], v[134:135], v[134:135], v[64:67]
cvt 124 60 61
cvt 125 62 63
mcvvv 20 36 132 236
cvt 126 68 69
cvt 127 70 71
s_waitcnt vmcnt(16)
mvvv 44 32 176
ds_write_b128 v55, v[124:127] offset:128
s_waitcnt vmcnt(15)
mvvv 44 32 180
dma 5 44 66 1024
v_mfma_f32_4x4x4_16b_bf16 v[64:67], v[136:137], v[136:137], v[64:67]
cvt 128 76 77
cvt 129 78 79
mcvvv 60 38 136 236
cvt 130 84 85
cvt 131 86 87
v_mfma_f32_4x4x4_16b_bf16 v[64:67], v[138:139], v[138:139], v[64:67]
ds_write_b128 v55, v[128:131] offset:2176
mcvvv 68 36 136 236
cvt 132 244 245
cvt 133 246 247
s_waitcnt vmcnt(15)
mvvv 44 32 184
cvt 134 20 21
cvt 135 22 23
s_waitcnt vmcnt(14)
mvvv 44 32 188
ds_write_b128 v55, v[132:135] offset:4224
v_mfma_f32_4x4x4_16b_bf16 v[64:67], v[140:141], v[140:141], v[64:67]
s_mov_b32 s66, 524288
s_add_u32 m0, s65, 16384
mcvvv 76 38 140 236
dma 4 44 66 0
v_mfma_f32_4x4x4_16b_bf16 v[64:67], v[142:143], v[142:143], v[64:67]
cvt 136 60 61
cvt 137 62 63
mcvvv 84 36 140 236
cvt 138 68 69
cvt 139 70 71
s_waitcnt vmcnt(14)
L_pga0:
s_cbranch_execz L_pga4
mvvv 44 32 192
ds_write_b128 v55, v[136:139] offset:6272
v_mfma_f32_4x4x4_16b_bf16 v[64:67], v[144:145], v[144:145], v[64:67]
dma 5 44 66 1024
mcvvv 244 38 144 236
cvt 140 76 77
cvt 141 78 79
v_mfma_f32_4x4x4_16b_bf16 v[64:67], v[146:147], v[146:147], v[64:67]
cvt 142 84 85
cvt 143 86 87
mcvvv 20 36 144 236
ds_write_b128 v55, v[140:143] offset:8320
v_mfma_f32_4x4x4_16b_bf16 v[64:67], v[148:149], v[148:149], v[64:67]
v_add_f32_dpp v44, v44, v44 quad_perm:[1,0,3,2] row_mask:0xf bank_mask:0xf
s_nop 1
v_add_f32_dpp v44, v44, v44 quad_perm:[2,3,0,1] row_mask:0xf bank_mask:0xf
mcvvv 60 38 148 236
s_nop 0
v_add_f32_dpp v44, v44, v44 row_half_mirror row_mask:0xf bank_mask:0xf
v_mul_f32 v48, 0xbae38e39, v44
v_mfma_f32_4x4x4_16b_bf16 v[64:67], v[150:151], v[150:151], v[64:67]
s_mov_b32 s66, 786432
s_add_u32 m0, s65, 24576
mcvvv 68 36 148 236
dma 4 44 66 0
v_mfma_f32_4x4x4_16b_bf16 v[64:67], v[152:153], v[152:153], v[64:67]
v_mul_f32 v49, 0xbae38e39, v44
v_mul_f32 v50, 0xbae38e39, v44
mcvvv 76 38 152 236
v_mul_f32 v51, 0xbae38e39, v44
cvt 144 244 245
v_mfma_f32_4x4x4_16b_bf16 v[64:67], v[154:155], v[154:155], v[64:67]
cvt 145 246 247
cvt 146 20 21
mcvvv 84 36 152 236
cvt 147 22 23
cvt 148 60 61
v_mfma_f32_4x4x4_16b_bf16 v[64:67], v[156:157], v[156:157], v[64:67]
ds_write_b128 v55, v[144:147] offset:10368
mcvvv 244 38 156 236
dma 5 44 66 1024
v_mfma_f32_4x4x4_16b_bf16 v[64:67], v[158:159], v[158:159], v[64:67]
cvt 149 62 63
cvt 150 68 69
mcvvv 20 36 156 236
cvt 151 70 71
cvt 152 76 77
v_mfma_f32_4x4x4_16b_bf16 v[88:91], v[160:161], v[160:161], 0
ds_write_b128 v55, v[148:151] offset:12416
mcvvv 60 38 160 48
cvt 153 78 79
cvt 154 84 85
v_mfma_f32_4x4x4_16b_bf16 v[88:91], v[162:163], v[162:163], v[88:91]
cvt 155 86 87
ds_write_b128 v55, v[152:155] offset:14464
cvt 156 244 245
cvt 157 246 247
cvt 158 20 21
cvt 159 22 23
ds_write_b128 v55, v[156:159] offset:16512
mcvvv 68 36 160 48
wl 0
s_barrier
rda 0 240 0
rda 8 240 36864
s_waitcnt vmcnt(16)
mzvvv 232 32 196
rda 16 241 1024
v_cndmask_b32 v64, v64, v65, s[82:83]
s_waitcnt vmcnt(15)
mvvv 232 32 200
rda 24 241 37888
rda 32 240 2048
v_mfma_f32_4x4x4_16b_bf16 v[88:91], v[164:165], v[164:165], v[88:91]
rda 40 240 38912
v_cndmask_b32 v64, v64, v66, s[84:85]
mcvvv 76 38 164 48
rda 48 241 3072
v_cndmask_b32 v64, v64, v67, s[86:87]
v_mfma_f32_4x4x4_16b_bf16 v[88:91], v[166:167], v[166:167], v[88:91]
rda 56 241 39936
rda 64 240 4096
mcvvv 84 36 164 48
rda 72 240 40960
buffer_load_dword v252, v254, s[44:47], 0 offen offset:1024
s_waitcnt vmcnt(15)
mvvv 232 32 204
rda 80 241 5120
rda 88 241 41984
s_waitcnt vmcnt(14)
mvvv 232 32 208
rda 96 240 6144
v_add_f32_dpp v64, v64, v64 quad_perm:[1,0,3,2] row_mask:0xf bank_mask:0xf
v_mfma_f32_4x4x4_16b_bf16 v[88:91], v[168:169], v[168:169], v[88:91]
rda 104 240 43008
v_add_f32_dpp v64, v64, v64 quad_perm:[2,3,0,1] row_mask:0xf bank_mask:0xf
mcvvv 244 38 168 48
rda 112 241 7168
rda 120 241 44032
v_add_f32_dpp v64, v64, v64 row_half_mirror row_mask:0xf bank_mask:0xf
v_mul_f32 v64, 0x3ae38e39, v64
v_fma_f32 v64, -v236, v236, v64
v_max_f32 v64, 0, v64
v_add_f32 v64, 0x3727c5ac, v64
ds_write_b32 v243, v64 offset:32
v_mfma_f32_4x4x4_16b_bf16 v[88:91], v[170:171], v[170:171], v[88:91]
rda 128 240 8192
cvt 160 60 61
mcvvv 20 36 168 48
rda 136 240 45056
buffer_load_dword v252, v254, s[44:47], 0 offen offset:1280
s_waitcnt vmcnt(14)
mvvv 232 32 212
rda 144 241 9216
rda 152 241 46080
s_waitcnt vmcnt(13)
mvvv 232 32 216
rda 160 240 10240
cvt 161 62 63
v_mfma_f32_4x4x4_16b_bf16 v[88:91], v[172:173], v[172:173], v[88:91]
rda 168 240 47104
rda 176 241 11264
cvt 162 68 69
cvt 163 70 71
mcvvv 60 38 172 48
rda 184 241 48128
cvt 164 76 77
v_mfma_f32_4x4x4_16b_bf16 v[88:91], v[174:175], v[174:175], v[88:91]
rda 192 240 12288
cvt 165 78 79
mcvvv 68 36 172 48
rda 200 240 49152
rda 208 241 13312
s_waitcnt vmcnt(12)
mvvv 232 32 220
rda 216 241 50176
s_add_u32 s40, s38, s98
s_addc_u32 s41, s39, 0
s_waitcnt vmcnt(11)
mvvv 232 32 224
rda 224 240 14336
rda 232 240 51200
v_mfma_f32_4x4x4_16b_bf16 v[88:91], v[176:177], v[176:177], v[88:91]
rda 240 241 15360
cvt 166 84 85
cvt 167 86 87
mcvvv 76 38 176 48
rda 248 241 52224
s_mov_b32 s42, 2048
v_mfma_f32_4x4x4_16b_bf16 v[88:91], v[178:179], v[178:179], v[88:91]
rdv 56 240 16384
rdv 64 240 53248
mcvvv 84 36 176 48
rdv 72 241 17408
buffer_store_dword v251, v53, s[40:43], 0 offen sc1
s_waitcnt vmcnt(11)
mvvv 232 32 228
rdv 80 241 54272
cvt 168 244 245
v_mfma_f32_4x4x4_16b_bf16 v[88:91], v[180:181], v[180:181], v[88:91]
cvt 169 246 247
cvt 170 20 21
cvt 171 22 23
mcvvv 244 38 180 48
cvt 172 60 61
cvt 173 62 63
v_mfma_f32_4x4x4_16b_bf16 v[88:91], v[182:183], v[182:183], v[88:91]
wl 0
s_barrier
mcvvv 20 36 180 48
ds_write_b128 v55, v[160:163] offset:0
v_mfma_f32_4x4x4_16b_bf16 v[88:91], v[184:185], v[184:185], v[88:91]
cvt 174 68 69
cvt 175 70 71
mcvvv 60 38 184 48
ds_write_b128 v55, v[164:167] offset:2048
v_mfma_f32_4x4x4_16b_bf16 v[88:91], v[186:187], v[186:187], v[88:91]
cvt 176 76 77
cvt 177 78 79
mcvvv 68 36 184 48
cvt 178 84 85
cvt 179 86 87
v_mfma_f32_4x4x4_16b_bf16 v[88:91], v[188:189], v[188:189], v[88:91]
ds_write_b128 v55, v[168:171] offset:4096
mcvvv 76 38 188 48
v_add_f32_dpp v232, v232, v232 quad_perm:[1,0,3,2] row_mask:0xf bank_mask:0xf
s_nop 1
v_add_f32_dpp v232, v232, v232 quad_perm:[2,3,0,1] row_mask:0xf bank_mask:0xf
v_mfma_f32_4x4x4_16b_bf16 v[88:91], v[190:191], v[190:191], v[88:91]
s_nop 0
v_add_f32_dpp v232, v232, v232 row_half_mirror row_mask:0xf bank_mask:0xf
v_mul_f32 v236, 0xbae38e39, v232
mcvvv 84 36 188 48
ds_write_b128 v55, v[172:175] offset:6144
v_mfma_f32_4x4x4_16b_bf16 v[88:91], v[192:193], v[192:193], v[88:91]
cvt 180 244 245
cvt 181 246 247
cvt 182 20 21
cvt 183 22 23
mcvvv 244 38 192 48
v_mul_f32 v237, 0xbae38e39, v232
v_mul_f32 v238, 0xbae38e39, v232
v_mfma_f32_4x4x4_16b_bf16 v[88:91], v[194:195], v[194:195], v[88:91]
ds_write_b128 v55, v[176:179] offset:8192
mcvvv 20 36 192 48
v_mul_f32 v239, 0xbae38e39, v232
cvt 184 60 61
v_mfma_f32_4x4x4_16b_bf16 v[92:95], v[196:197], v[196:197], 0
cvt 185 62 63
cvt 186 68 69
cvt 187 70 71
mcvvv 60 38 196 236
ds_write_b128 v55, v[180:183] offset:10240
v_mfma_f32_4x4x4_16b_bf16 v[92:95], v[198:199], v[198:199], v[92:95]
cvt 188 76 77
cvt 189 78 79
mcvvv 68 36 196 236
cvt 190 84 85
cvt 191 86 87
v_mfma_f32_4x4x4_16b_bf16 v[92:95], v[200:201], v[200:201], v[92:95]
ds_write_b128 v55, v[184:187] offset:12288
mcvvv 76 38 200 236
v_cndmask_b32 v88, v88, v89, s[82:83]
cvt 192 244 245
v_mfma_f32_4x4x4_16b_bf16 v[92:95], v[202:203], v[202:203], v[92:95]
cvt 193 246 247
cvt 194 20 21
mcvvv 84 36 200 236
ds_write_b128 v55, v[188:191] offset:14336
v_mfma_f32_4x4x4_16b_bf16 v[92:95], v[204:205], v[204:205], v[92:95]
cvt 195 22 23
v_cndmask_b32 v88, v88, v90, s[84:85]
mcvvv 244 38 204 236
v_cndmask_b32 v88, v88, v91, s[86:87]
s_nop 1
v_add_f32_dpp v88, v88, v88 quad_perm:[1,0,3,2] row_mask:0xf bank_mask:0xf
v_mfma_f32_4x4x4_16b_bf16 v[92:95], v[206:207], v[206:207], v[92:95]
ds_write_b128 v55, v[192:195] offset:16384
mcvvv 20 36 204 236
v_add_f32_dpp v88, v88, v88 quad_perm:[2,3,0,1] row_mask:0xf bank_mask:0xf
cvt 196 60 61
v_mfma_f32_4x4x4_16b_bf16 v[92:95], v[208:209], v[208:209], v[92:95]
cvt 197 62 63
cvt 198 68 69
cvt 199 70 71
mcvvv 60 38 208 236
ds_write_b128 v55, v[196:199] offset:128
v_mfma_f32_4x4x4_16b_bf16 v[92:95], v[210:211], v[210:211], v[92:95]
v_add_f32_dpp v88, v88, v88 row_half_mirror row_mask:0xf bank_mask:0xf
v_mul_f32 v88, 0x3ae38e39, v88
mcvvv 68 36 208 236
v_fma_f32 v88, -v48, v48, v88
v_max_f32 v88, 0, v88
v_mfma_f32_4x4x4_16b_bf16 v[92:95], v[212:213], v[212:213], v[92:95]
cvt 200 76 77
cvt 201 78 79
cvt 202 84 85
cvt 203 86 87
mcvvv 76 38 212 236
ds_write_b128 v55, v[200:203] offset:2176
v_mfma_f32_4x4x4_16b_bf16 v[92:95], v[214:215], v[214:215], v[92:95]
v_add_f32 v88, 0x3727c5ac, v88
cvt 204 244 245
mcvvv 84 36 212 236
ds_write_b32 v243, v88 offset:64
v_mfma_f32_4x4x4_16b_bf16 v[92:95], v[216:217], v[216:217], v[92:95]
cvt 205 246 247
cvt 206 20 21
cvt 207 22 23
mcvvv 244 38 216 236
ds_write_b128 v55, v[204:207] offset:4224
v_mfma_f32_4x4x4_16b_bf16 v[92:95], v[218:219], v[218:219], v[92:95]
cvt 208 60 61
cvt 209 62 63
mcvvv 20 36 216 236
cvt 210 68 69
cvt 211 70 71
v_mfma_f32_4x4x4_16b_bf16 v[92:95], v[220:221], v[220:221], v[92:95]
cvt 212 76 77
cvt 213 78 79
mcvvv 60 38 220 236
ds_write_b128 v55, v[208:211] offset:6272
v_mfma_f32_4x4x4_16b_bf16 v[92:95], v[222:223], v[222:223], v[92:95]
cvt 214 84 85
cvt 215 86 87
mcvvv 68 36 220 236
cvt 216 244 245
cvt 217 246 247
v_mfma_f32_4x4x4_16b_bf16 v[92:95], v[224:225], v[224:225], v[92:95]
cvt 218 20 21
cvt 219 22 23
mcvvv 76 38 224 236
ds_write_b128 v55, v[212:215] offset:8320
v_mfma_f32_4x4x4_16b_bf16 v[92:95], v[226:227], v[226:227], v[92:95]
cvt 220 60 61
cvt 221 62 63
mcvvv 84 36 224 236
cvt 222 68 69
cvt 223 70 71
v_mfma_f32_4x4x4_16b_bf16 v[92:95], v[228:229], v[228:229], v[92:95]
mcvvv 244 38 228 236
ds_write_b128 v55, v[216:219] offset:10368
v_mfma_f32_4x4x4_16b_bf16 v[92:95], v[230:231], v[230:231], v[92:95]
cvt 224 76 77
cvt 225 78 79
mcvvv 20 36 228 236
ds_write_b128 v55, v[220:223] offset:12416
cvt 226 84 85
cvt 227 86 87
ds_write_b128 v55, v[224:227] offset:14464
cvt 228 244 245
cvt 229 246 247
s_nop 1
cvt 230 20 21
cvt 231 22 23
ds_write_b128 v55, v[228:231] offset:16512
v_cndmask_b32 v92, v92, v93, s[82:83]
v_cndmask_b32 v92, v92, v94, s[84:85]
v_cndmask_b32 v92, v92, v95, s[86:87]
s_nop 1
v_add_f32_dpp v92, v92, v92 quad_perm:[1,0,3,2] row_mask:0xf bank_mask:0xf
s_nop 1
v_add_f32_dpp v92, v92, v92 quad_perm:[2,3,0,1] row_mask:0xf bank_mask:0xf
s_nop 1
v_add_f32_dpp v92, v92, v92 row_half_mirror row_mask:0xf bank_mask:0xf
v_mul_f32 v92, 0x3ae38e39, v92
v_fma_f32 v92, -v236, v236, v92
v_max_f32 v92, 0, v92
v_add_f32 v92, 0x3727c5ac, v92
ds_write_b32 v243, v92 offset:96
s_waitcnt vmcnt(7) lgkmcnt(0)
s_barrier
v_mov_b32 v25, v250
v_mov_b32 v26, 0
trv 32 6 0
trv 34 6 512
trv 36 6 8192
trv 38 6 8704
rda 4 240 0
rda 12 240 36864
rda 20 241 1024
rda 28 241 37888
wl 4
mzvva 88 32 0
trv 40 7 0
mvva 88 36 16
trv 42 7 512
wl 3
mzvva 92 36 20
trv 44 7 8192
trv 46 7 8704
mvva 92 32 4
trv 48 8 0
mzvva 96 32 8
rda 36 240 2048
mvva 96 36 24
trv 50 8 512
wl 7
mzvva 100 36 28
rda 44 240 38912
mvva 100 32 12
trv 52 8 8192
wl 5
mzvva 116 40 12
rda 52 241 3072
mvva 116 44 28
trv 54 8 8704
mzvva 112 44 24
rda 60 241 39936
mvva 112 40 8
trv 216 9 0
mzvva 108 40 4
rda 68 240 4096
mvva 108 44 20
s_waitcnt vmcnt(3)
s_barrier
mzvva 104 44 16
trv 218 9 512
s_mov_b32 s66, 1048576
mvva 104 40 0
rda 76 240 40960
wl 5
mzvva 120 48 0
trv 220 9 8192
s_add_u32 m0, s65, 32768
mvva 120 52 16
rda 84 241 5120
mzvva 124 52 20
trv 222 9 8704
mvva 124 48 4
rda 92 241 41984
mzvva 128 48 8
trv 32 9 16384
mvva 128 52 24
dma 4 44 66 0
mzvva 132 52 28
rda 100 240 6144
mvva 132 48 12
trv 34 9 16896
wl 4
mzvva 148 216 12
dma 5 44 66 1024
s_mov_b32 s66, 1310720
mvva 148 220 28
rda 108 240 43008
trv 36 9 24576
mzvva 144 220 24
trv 38 9 25088
s_add_u32 m0, s65, 40960
mvva 144 216 8
rda 116 241 7168
dma 4 44 66 0
mzvva 140 216 4
rda 124 241 44032
mvva 140 220 20
trv 40 8 16384
mzvva 136 220 16
dma 5 44 66 1024
s_mov_b32 s66, 1572864
mvva 136 216 0
rda 132 240 8192
wl 4
mvva 136 32 32
trv 42 8 16896
s_add_u32 m0, s65, 49152
mvva 136 36 48
rda 140 240 45056
trv 44 8 24576
mvva 140 36 52
trv 46 8 25088
dma 4 44 66 0
mvva 140 32 36
rda 148 241 9216
mvva 144 32 40
dma 5 44 66 1024
s_mov_b32 s66, 1835008
mvva 144 36 56
ds_read_b32 v20, v242 offset:0
rda 156 241 46080
mvva 148 36 60
trv 48 7 16384
s_add_u32 m0, s65, 57344
mvva 148 32 44
rda 164 240 10240
wl 5
mvva 132 40 44
trv 50 7 16896
dma 4 44 66 0
mvva 132 44 60
ds_read_b32 v21, v242 offset:64
rda 172 240 47104
mvva 128 44 56
trv 52 7 24576
trv 54 7 25088
mvva 128 40 40
dma 5 44 66 1024
mvva 124 40 36
rda 180 241 11264
ds_read_b32 v22, v242 offset:128
mvva 124 44 52
s_waitcnt vmcnt(4)
s_barrier
mvva 120 44 48
rda 188 241 48128
trv 216 6 16384
mvva 120 40 32
rda 196 240 12288
wl 5
mvva 104 48 32
trv 218 6 16896
ds_read_b32 v23, v242 offset:192
mvva 104 52 48
rda 204 240 49152
trv 220 6 24576
mvva 108 52 52
trv 222 6 25088
rda 212 241 13312
mvva 108 48 36
rda 220 241 50176
s_mov_b32 s66, 2097152
mvva 112 48 40
s_add_u32 m0, s65, 65536
trv 32 6 32768
mvva 112 52 56
dma 4 44 66 0
mvva 116 52 60
rda 228 240 14336
mvva 116 48 44
trv 34 6 33280
wl 5
mvva 100 216 44
rda 236 240 51200
mvva 100 220 60
trv 36 6 40960
mvva 96 220 56
trv 38 6 41472
rda 244 241 15360
mvva 96 216 40
dma 5 44 66 1024
s_mov_b32 s66, 2359296
mvva 92 216 36
rda 252 241 52224
s_add_u32 m0, s65, 73728
mvva 92 220 52
trv 40 7 32768
mvva 88 220 48
rdv 60 240 16384
mvva 88 216 32
trv 42 7 33280
wl 5
mvva 88 32 64
rdv 68 240 53248
mvva 88 36 80
trv 44 7 40960
dma 4 44 66 0
mvva 92 36 84
trv 46 7 41472
rdv 76 241 17408
mvva 92 32 68
rdv 84 241 54272
mvva 96 32 72
trv 48 8 32768
mvva 96 36 88
trv 50 8 33280
mvva 100 36 92
dma 5 44 66 1024
mvva 100 32 76
trv 52 8 40960
wl 5
mvva 116 40 76
trv 54 8 41472
mvva 116 44 92
trv 216 9 32768
mvva 112 44 88
trv 218 9 33280
L_pga1:
s_cbranch_execz L_pga5
mvva 112 40 72
trv 220 9 40960
mvva 108 40 68
trv 222 9 41472
mvva 108 44 84
s_waitcnt vmcnt(4) lgkmcnt(8)
s_barrier
mvva 104 44 80
s_mov_b32 s66, 2621440
s_add_u32 m0, s65, 81920
mvva 104 40 64
trv 32 9 49152
wl 5
mvva 120 48 64
dma 4 44 66 0
mvva 120 52 80
trv 34 9 49664
mvva 124 52 84
dma 5 44 66 1024
mvva 124 48 68
trv 36 9 57344
s_mov_b32 s66, 2883584
mvva 128 48 72
s_add_u32 m0, s65, 90112
trv 38 9 57856
mvva 128 52 88
dma 4 44 66 0
mvva 132 52 92
trv 40 8 49152
mvva 132 48 76
dma 5 44 66 1024
wl 5
mvva 148 216 76
trv 42 8 49664
v_rsq_f32 v20, v20
mvva 148 220 92
s_mov_b32 s66, 3145728
s_add_u32 m0, s65, 0
mvva 144 220 88
trv 44 8 57344
mvva 144 216 72
dma 4 44 66 0
mvva 140 216 68
trv 46 8 57856
mvva 140 220 84
dma 5 44 66 1024
mvva 136 220 80
trv 48 7 49152
mvva 136 216 64
s_mov_b32 s66, 3407872
wl 5
mvva 136 32 96
s_add_u32 m0, s65, 8192
trv 50 7 49664
mvva 136 36 112
dma 4 44 66 0
mvva 140 36 116
trv 52 7 57344
mvva 140 32 100
dma 5 44 66 1024
mvva 144 32 104
trv 54 7 57856
mvva 144 36 120
v_rsq_f32 v21, v21
mvva 148 36 124
trv 216 6 49152
mvva 148 32 108
wl 5
mvva 132 40 108
trv 218 6 49664
mvva 132 44 124
mvva 128 44 120
trv 220 6 57344
mvva 128 40 104
mvva 124 40 100
trv 222 6 57856
mvva 124 44 116
s_waitcnt vmcnt(8)
s_barrier
mvva 120 44 112
s_mov_b32 s66, 3670016
s_add_u32 m0, s65, 16384
mvva 120 40 96
trv 32 10 0
wl 5
mvva 104 48 96
dma 4 44 66 0
mvva 104 52 112
trv 34 10 512
mvva 108 52 116
dma 5 44 66 1024
mvva 108 48 100
trv 36 10 8192
s_mov_b32 s66, 3932160
mvva 112 48 104
s_add_u32 m0, s65, 24576
trv 38 10 8704
mvva 112 52 120
dma 4 44 66 0
mvva 116 52 124
trv 40 11 0
mvva 116 48 108
dma 5 44 66 1024
wl 5
mvva 100 216 108
trv 42 11 512
mvva 100 220 124
s_mov_b32 s66, 4194304
s_add_u32 m0, s65, 32768
mvva 96 220 120
trv 44 11 8192
mvva 96 216 104
dma 4 44 66 0
mvva 92 216 100
trv 46 11 8704
mvva 92 220 116
dma 5 44 66 1024
mvva 88 220 112
trv 48 12 0
v_rsq_f32 v22, v22
mvva 88 216 96
s_mov_b32 s66, 4456448
wl 5
mvva 88 32 128
s_add_u32 m0, s65, 40960
trv 50 12 512
mvva 88 36 144
dma 4 44 66 0
mvva 92 36 148
trv 52 12 8192
mvva 92 32 132
dma 5 44 66 1024
mvva 96 32 136
trv 54 12 8704
mvva 96 36 152
mvva 100 36 156
trv 216 13 0
mvva 100 32 140
wl 5
mvva 116 40 140
trv 218 13 512
mvva 116 44 156
mvva 112 44 152
trv 220 13 8192
mvva 112 40 136
v_rsq_f32 v23, v23
mvva 108 40 132
trv 222 13 8704
mvva 108 44 148
s_waitcnt vmcnt(12)
s_barrier
mvva 104 44 144
s_mov_b32 s66, 128
s_add_u32 m0, s65, 49152
mvva 104 40 128
trv 32 13 16384
wl 5
mvva 120 48 128
dma 4 44 66 0
mvva 120 52 144
trv 34 13 16896
mvva 124 52 148
trv 36 13 24576
mvva 124 48 132
mvva 128 48 136
trv 38 13 25088
mvva 128 52 152
dma 5 44 66 1024
mvva 132 52 156
trv 40 12 16384
mvva 132 48 140
wl 5
mvva 148 216 140
trv 42 12 16896
mvva 148 220 156
s_mov_b32 s66, 262272
s_add_u32 m0, s65, 57344
mvva 144 220 152
trv 44 12 24576
mvva 144 216 136
dma 4 44 66 0
mvva 140 216 132
trv 46 12 25088
mvva 140 220 148
mvva 136 220 144
trv 48 11 16384
mvva 136 216 128
v_mul_f32 v20, 0x3e0293ee, v20
wl 5
mvva 136 32 160
trv 50 11 16896
mvva 136 36 176
dma 5 44 66 1024
mvva 140 36 180
trv 52 11 24576
mvva 140 32 164
mvva 144 32 168
trv 54 11 25088
mvva 144 36 184
mvva 148 36 188
trv 216 10 16384
mvva 148 32 172
wl 5
mvva 132 40 172
trv 218 10 16896
mvva 132 44 188
v_mul_f32 v21, 0x3e0293ee, v21
mvva 128 44 184
trv 220 10 24576
mvva 128 40 168
mvva 124 40 164
trv 222 10 25088
mvva 124 44 180
s_waitcnt vmcnt(12)
s_barrier
mvva 120 44 176
s_mov_b32 s66, 524416
s_add_u32 m0, s65, 65536
mvva 120 40 160
trv 32 6 0
wl 5
mvva 104 48 160
dma 4 44 66 0
mvva 104 52 176
trv 34 6 512
mvva 108 52 180
trv 36 6 8192
mvva 108 48 164
v_mul_f32 v22, 0x3e0293ee, v22
mvva 112 48 168
trv 38 6 8704
mvva 112 52 184
dma 5 44 66 1024
mvva 116 52 188
trv 40 7 0
mvva 116 48 172
wl 5
mvva 100 216 172
trv 42 7 512
mvva 100 220 188
s_mov_b32 s66, 786560
s_add_u32 m0, s65, 73728
mvva 96 220 184
trv 44 7 8192
mvva 96 216 168
dma 4 44 66 0
mvva 92 216 164
trv 46 7 8704
mvva 92 220 180
v_mul_f32 v23, 0x3e0293ee, v23
mvva 88 220 176
trv 48 8 0
mvva 88 216 160
wl 5
mvva 88 32 192
trv 50 8 512
mvva 88 36 208
dma 5 44 66 1024
mvva 92 36 212
trv 52 8 8192
mvva 92 32 196
mvva 96 32 200
trv 54 8 8704
mvva 96 36 216
mvva 100 36 220
trv 216 9 0
mvva 100 32 204
wl 5
mvva 116 40 204
trv 218 9 512
mvva 116 44 220
mvva 112 44 216
trv 220 9 8192
mvva 112 40 200
mvva 108 40 196
trv 222 9 8704
mvva 108 44 212
s_waitcnt vmcnt(12)
s_barrier
mvva 104 44 208
s_mov_b32 s66, 1048704
s_add_u32 m0, s65, 81920
mvva 104 40 192
trv 32 9 16384
wl 5
mvva 120 48 192
dma 4 44 66 0
mvva 120 52 208
trv 34 9 16896
mvva 124 52 212
trv 36 9 24576
mvva 124 48 196
mvva 128 48 200
trv 38 9 25088
mvva 128 52 216
dma 5 44 66 1024
mvva 132 52 220
trv 40 8 16384
mvva 132 48 204
wl 5
mvva 148 216 204
trv 42 8 16896
mvva 148 220 220
s_mov_b32 s66, 1310848
s_add_u32 m0, s65, 90112
mvva 144 220 216
trv 44 8 24576
mvva 144 216 200
dma 4 44 66 0
mvva 140 216 196
trv 46 8 25088
mvva 140 220 212
mvva 136 220 208
trv 48 7 16384
mvva 136 216 192
wl 5
mvva 136 32 224
trv 50 7 16896
mvva 136 36 240
dma 5 44 66 1024
mvva 140 36 244
trv 52 7 24576
mvva 140 32 228
mvva 144 32 232
trv 54 7 25088
mvva 144 36 248
mvva 148 36 252
trv 216 6 16384
mvva 148 32 236
wl 5
mvva 132 40 236
trv 218 6 16896
mvva 132 44 252
mvva 128 44 248
trv 220 6 24576
mvva 128 40 232
mvva 124 40 228
trv 222 6 25088
mvva 124 44 244
s_waitcnt vmcnt(12)
s_barrier
mvva 120 44 240
s_mov_b32 s66, 1572992
s_add_u32 m0, s65, 0
mvva 120 40 224
trv 32 6 32768
wl 5
mvva 104 48 224
dma 4 44 66 0
mvva 104 52 240
trv 34 6 33280
mvva 108 52 244
trv 36 6 40960
mvva 108 48 228
mvva 112 48 232
trv 38 6 41472
mvva 112 52 248
dma 5 44 66 1024
mvva 116 52 252
trv 40 7 32768
mvva 116 48 236
wl 5
mvva 100 216 236
trv 42 7 33280
mvva 100 220 252
s_mov_b32 s66, 1835136
s_add_u32 m0, s65, 8192
mvva 96 220 248
trv 44 7 40960
mvva 96 216 232
dma 4 44 66 0
mvva 92 216 228
trv 46 7 41472
mvva 92 220 244
mvva 88 220 240
trv 48 8 32768
mvva 88 216 224
wl 5
mvvv 88 32 56
trv 50 8 33280
mvvv 88 36 72
dma 5 44 66 1024
mvvv 92 36 76
trv 52 8 40960
mvvv 92 32 60
mvvv 96 32 64
trv 54 8 41472
mvvv 96 36 80
mvvv 100 36 84
trv 216 9 32768
mvvv 100 32 68
wl 5
mvvv 116 40 68
trv 218 9 33280
mvvv 116 44 84
mvvv 112 44 80
trv 220 9 40960
mvvv 112 40 64
mvvv 108 40 60
trv 222 9 41472
mvvv 108 44 76
s_waitcnt vmcnt(12)
s_barrier
mvvv 104 44 72
s_mov_b32 s66, 2097280
s_add_u32 m0, s65, 16384
mvvv 104 40 56
trv 32 9 49152
wl 5
mvvv 120 48 56
dma 4 44 66 0
mvvv 120 52 72
trv 34 9 49664
mvvv 124 52 76
trv 36 9 57344
mvvv 124 48 60
mvvv 128 48 64
trv 38 9 57856
mvvv 128 52 80
dma 5 44 66 1024
mvvv 132 52 84
trv 40 8 49152
mvvv 132 48 68
wl 5
mvvv 148 216 68
trv 42 8 49664
mvvv 148 220 84
s_mov_b32 s66, 2359424
s_add_u32 m0, s65, 24576
mvvv 144 220 80
trv 44 8 57344
mvvv 144 216 64
dma 4 44 66 0
mvvv 140 216 60
trv 46 8 57856
mvvv 140 220 76
mvvv 136 220 72
trv 48 7 49152
mvvv 136 216 56
wl 5
mzvva 200 32 0
trv 50 7 49664
mvva 200 36 16
dma 5 44 66 1024
mzvva 204 36 20
trv 52 7 57344
mvva 204 32 4
mul 88 20 88
mul 89 20 89
mzvva 208 32 8
trv 54 7 57856
mul 91 20 91
mvva 208 36 24
mul 90 20 90
mul 104 20 104
mzvva 212 36 28
trv 216 6 49152
mul 105 20 105
mvva 212 32 12
mul 106 20 106
wl 5
mzvva 196 40 12
trv 218 6 49664
cvt 88 88 89
mvva 196 44 28
ds_write_b32 v0, v88 offset:0
mzvva 192 44 24
trv 220 6 57344
cvt 89 90 91
mvva 192 40 8
cvt 104 104 105
mzvva 188 40 4
trv 222 6 57856
mvva 188 44 20
s_waitcnt vmcnt(12)
s_barrier
mzvva 184 44 16
s_mov_b32 s66, 2621568
s_add_u32 m0, s65, 32768
mvva 184 40 0
trv 32 10 0
wl 6
mzvva 168 48 0
dma 4 44 66 0
mvva 168 52 16
trv 34 10 512
mul 107 20 107
mzvva 172 52 20
trv 36 10 8192
mvva 172 48 4
ds_write_b32 v0, v89 offset:4
mzvva 176 48 8
trv 38 10 8704
cvt 105 106 107
mvva 176 52 24
dma 5 44 66 1024
mzvva 180 52 28
trv 40 11 0
mul 92 21 92
mvva 180 48 12
mul 93 21 93
wl 6
mzvva 164 216 12
trv 42 11 512
mvva 164 220 28
s_mov_b32 s66, 2883712
s_add_u32 m0, s65, 40960
mzvva 160 220 24
trv 44 11 8192
mul 94 21 94
mvva 160 216 8
dma 4 44 66 0
mzvva 156 216 4
trv 46 11 8704
mul 95 21 95
mvva 156 220 20
ds_write_b32 v0, v104 offset:512
mzvva 152 220 16
trv 48 12 0
cvt 92 92 93
mvva 152 216 0
cvt 93 94 95
wl 6
mvva 152 32 32
ds_write_b32 v0, v105 offset:516
mvva 152 36 48
trv 50 12 512
mul 109 21 109
mvva 156 36 52
dma 5 44 66 1024
mvva 156 32 36
trv 52 12 8192
mul 110 21 110
mvva 160 32 40
trv 54 12 8704
mvva 160 36 56
mul 111 21 111
mvva 164 36 60
trv 216 13 0
mvva 164 32 44
wl 7
mvva 180 40 44
trv 218 13 512
mvva 180 44 60
mvva 176 44 56
trv 220 13 8192
L_pga2:
s_cbranch_execz L_pga6
mvva 176 40 40
ds_write_b32 v0, v92 offset:1024
mvva 172 40 36
trv 222 13 8704
mvva 172 44 52
s_waitcnt vmcnt(12)
s_barrier
mvva 168 44 48
s_mov_b32 s66, 3145856
s_add_u32 m0, s65, 49152
mvva 168 40 32
trv 32 13 16384
wl 6
mvva 184 48 32
dma 4 44 66 0
mvva 184 52 48
trv 34 13 16896
mul 108 21 108
mvva 188 52 52
trv 36 13 24576
mvva 188 48 36
ds_write_b32 v0, v93 offset:1028
mvva 192 48 40
trv 38 13 25088
cvt 108 108 109
mvva 192 52 56
dma 5 44 66 1024
mvva 196 52 60
trv 40 12 16384
cvt 109 110 111
mvva 196 48 44
mul 96 22 96
wl 6
mvva 212 216 44
trv 42 12 16896
mvva 212 220 60
s_mov_b32 s66, 3408000
s_add_u32 m0, s65, 57344
mvva 208 220 56
trv 44 12 24576
mul 97 22 97
mvva 208 216 40
dma 4 44 66 0
mvva 204 216 36
trv 46 12 25088
mul 98 22 98
mvva 204 220 52
ds_write_b32 v0, v108 offset:1536
mvva 200 220 48
trv 48 11 16384
mul 99 22 99
mvva 200 216 32
cvt 96 96 97
wl 6
mvva 200 32 64
trv 50 11 16896
cvt 97 98 99
mvva 200 36 80
dma 5 44 66 1024
mvva 204 36 84
ds_write_b32 v0, v109 offset:1540
mvva 204 32 68
trv 52 11 24576
mul 113 22 113
mvva 208 32 72
trv 54 11 25088
mul 114 22 114
mvva 208 36 88
mvva 212 36 92
trv 216 10 16384
mul 115 22 115
mvva 212 32 76
wl 7
mvva 196 40 76
trv 218 10 16896
mvva 196 44 92
mvva 192 44 88
trv 220 10 24576
mvva 192 40 72
ds_write_b32 v0, v96 offset:2048
mvva 188 40 68
trv 222 10 25088
mvva 188 44 84
s_waitcnt vmcnt(12)
s_barrier
mvva 184 44 80
s_mov_b32 s66, 3670144
s_add_u32 m0, s65, 65536
mvva 184 40 64
trv 32 6 0
wl 6
mvva 168 48 64
dma 4 44 66 0
mvva 168 52 80
trv 34 6 512
mul 112 22 112
mvva 172 52 84
trv 36 6 8192
mvva 172 48 68
ds_write_b32 v0, v97 offset:2052
mvva 176 48 72
trv 38 6 8704
mvva 176 52 88
dma 5 44 66 1024
mvva 180 52 92
trv 40 7 0
cvt 112 112 113
mvva 180 48 76
cvt 113 114 115
wl 6
mvva 164 216 76
trv 42 7 512
mul 100 23 100
mvva 164 220 92
s_mov_b32 s66, 3932288
s_add_u32 m0, s65, 73728
mvva 160 220 88
trv 44 7 8192
mul 101 23 101
mvva 160 216 72
dma 4 44 66 0
mvva 156 216 68
trv 46 7 8704
mul 102 23 102
mvva 156 220 84
mul 103 23 103
mvva 152 220 80
trv 48 8 0
mvva 152 216 64
cvt 100 100 101
wl 5
mvva 152 32 96
ds_write_b32 v0, v112 offset:2560
mvva 152 36 112
trv 50 8 512
cvt 101 102 103
mvva 156 36 116
dma 5 44 66 1024
mvva 156 32 100
trv 52 8 8192
mul 116 23 116
mvva 160 32 104
ds_write_b32 v0, v113 offset:2564
mvva 160 36 120
trv 54 8 8704
mvva 164 36 124
trv 216 9 0
mul 118 23 118
mvva 164 32 108
mul 119 23 119
wl 7
mvva 180 40 108
trv 218 9 512
mvva 180 44 124
mvva 176 44 120
trv 220 9 8192
mvva 176 40 104
mvva 172 40 100
trv 222 9 8704
mvva 172 44 116
s_waitcnt vmcnt(12)
s_barrier
mvva 168 44 112
s_mov_b32 s66, 4194432
s_add_u32 m0, s65, 81920
mvva 168 40 96
trv 32 9 16384
wl 5
mvva 184 48 96
dma 4 44 66 0
mvva 184 52 112
trv 34 9 16896
mul 117 23 117
mvva 188 52 116
trv 36 9 24576
mvva 188 48 100
ds_write_b32 v0, v100 offset:3072
mvva 192 48 104
trv 38 9 25088
mvva 192 52 120
dma 5 44 66 1024
mvva 196 52 124
trv 40 8 16384
cvt 116 116 117
mvva 196 48 108
wl 6
mvva 212 216 108
trv 42 8 16896
cvt 117 118 119
mvva 212 220 124
s_mov_b32 s66, 4456576
s_add_u32 m0, s65, 90112
mvva 208 220 120
trv 44 8 24576
mul 120 20 120
mvva 208 216 104
dma 4 44 66 0
mvva 204 216 100
trv 46 8 25088
mul 121 20 121
mvva 204 220 116
ds_write_b32 v0, v101 offset:3076
mvva 200 220 112
trv 48 7 16384
mul 122 20 122
mvva 200 216 96
mul 123 20 123
wl 6
mvva 200 32 128
trv 50 7 16896
cvt 120 120 121
mvva 200 36 144
dma 5 44 66 1024
mvva 204 36 148
ds_write_b32 v0, v116 offset:3584
mvva 204 32 132
trv 52 7 24576
cvt 121 122 123
mvva 208 32 136
ds_write_b32 v0, v117 offset:3588
mvva 208 36 152
trv 54 7 25088
mul 137 20 137
mvva 212 36 156
trv 216 6 16384
mvva 212 32 140
mul 138 20 138
wl 8
mvva 196 40 140
trv 218 6 16896
mul 139 20 139
mvva 196 44 156
mvva 192 44 152
trv 220 6 24576
mvva 192 40 136
mvva 188 40 132
trv 222 6 25088
mvva 188 44 148
s_waitcnt vmcnt(12)
s_barrier
mvva 184 44 144
s_mov_b32 s66, 512
s_add_u32 m0, s65, 0
mvva 184 40 128
trv 32 6 32768
wl 5
mvva 168 48 128
dma 4 44 66 0
mvva 168 52 144
trv 34 6 33280
mul 136 20 136
mvva 172 52 148
trv 36 6 40960
mvva 172 48 132
ds_write_b32 v0, v120 offset:4096
mvva 176 48 136
trv 38 6 41472
mvva 176 52 152
dma 5 44 66 1024
mvva 180 52 156
trv 40 7 32768
mvva 180 48 140
cvt 136 136 137
wl 6
mvva 164 216 140
trv 42 7 33280
mvva 164 220 156
s_mov_b32 s66, 262656
s_add_u32 m0, s65, 8192
mvva 160 220 152
trv 44 7 40960
cvt 137 138 139
mvva 160 216 136
dma 4 44 66 0
mvva 156 216 132
trv 46 7 41472
mul 124 21 124
mvva 156 220 148
mul 125 21 125
mvva 152 220 144
trv 48 8 32768
mul 126 21 126
mvva 152 216 128
wl 5
mvva 152 32 160
ds_write_b32 v0, v121 offset:4100
mvva 152 36 176
trv 50 8 33280
mul 127 21 127
mvva 156 36 180
dma 5 44 66 1024
mvva 156 32 164
ds_write_b32 v0, v136 offset:4608
mvva 160 32 168
trv 52 8 40960
cvt 124 124 125
mvva 160 36 184
trv 54 8 41472
cvt 125 126 127
mvva 164 36 188
ds_write_b32 v0, v137 offset:4612
mvva 164 32 172
trv 216 9 32768
wl 8
mvva 180 40 172
trv 218 9 33280
mul 141 21 141
mvva 180 44 188
mul 142 21 142
mvva 176 44 184
trv 220 9 40960
mul 143 21 143
mvva 176 40 168
mvva 172 40 164
trv 222 9 41472
mvva 172 44 180
s_waitcnt vmcnt(12)
s_barrier
mvva 168 44 176
s_mov_b32 s66, 524800
s_add_u32 m0, s65, 16384
mvva 168 40 160
trv 32 9 49152
wl 6
mvva 184 48 160
dma 4 44 66 0
s_mov_b32 s92, s36
mvva 184 52 176
trv 34 9 49664
s_mov_b32 s93, s37
mvva 188 52 180
trv 36 9 57344
mul 140 21 140
mvva 188 48 164
ds_write_b32 v0, v124 offset:5120
mvva 192 48 168
trv 38 9 57856
s_mov_b32 s94, 64
mvva 192 52 184
dma 5 44 66 1024
mvva 196 52 188
trv 40 8 49152
mvva 196 48 172
s_mov_b32 s95, 0x20000
wl 6
mvva 212 216 172
trv 42 8 49664
cvt 140 140 141
mvva 212 220 188
s_mov_b32 s66, 786944
s_add_u32 m0, s65, 24576
mvva 208 220 184
trv 44 8 57344
v_mov_b32 v24, 1
mvva 208 216 168
dma 4 44 66 0
mvva 204 216 164
trv 46 8 57856
cvt 141 142 143
mvva 204 220 180
buffer_atomic_add v24, v248, s[92:95], 0 offen sc1
mvva 200 220 176
trv 48 7 49152
mul 128 22 128
mvva 200 216 160
mul 129 22 129
wl 5
mvva 200 32 192
ds_write_b32 v0, v125 offset:5124
mvva 200 36 208
trv 50 7 49664
mul 130 22 130
mvva 204 36 212
dma 5 44 66 1024
mvva 204 32 196
trv 52 7 57344
mul 131 22 131
mvva 208 32 200
ds_write_b32 v0, v140 offset:5632
mvva 208 36 216
trv 54 7 57856
cvt 128 128 129
mvva 212 36 220
trv 216 6 49152
cvt 129 130 131
mvva 212 32 204
mul 144 22 144
wl 7
mvva 196 40 204
ds_write_b32 v0, v141 offset:5636
mvva 196 44 220
trv 218 6 49664
mul 146 22 146
mvva 192 44 216
trv 220 6 57344
mvva 192 40 200
mul 147 22 147
mvva 188 40 196
trv 222 6 57856
mvva 188 44 212
s_waitcnt vmcnt(13)
s_barrier
mvva 184 44 208
s_mov_b32 s66, 1049088
s_add_u32 m0, s65, 32768
mvva 184 40 192
trv 32 10 0
wl 6
mvva 168 48 192
dma 4 44 66 0
mvva 168 52 208
trv 34 10 512
mvva 172 52 212
trv 36 10 8192
mvva 172 48 196
ds_write_b32 v0, v128 offset:6144
mvva 176 48 200
trv 38 10 8704
mvva 176 52 216
dma 5 44 66 1024
mvva 180 52 220
trv 40 11 0
mul 145 22 145
mvva 180 48 204
wl 6
mvva 164 216 204
trv 42 11 512
mvva 164 220 220
s_mov_b32 s66, 1311232
s_add_u32 m0, s65, 40960
mvva 160 220 216
trv 44 11 8192
cvt 144 144 145
mvva 160 216 200
dma 4 44 66 0
mvva 156 216 196
trv 46 11 8704
cvt 145 146 147
mvva 156 220 212
mul 132 23 132
mvva 152 220 208
trv 48 12 0
mvva 152 216 192
mul 133 23 133
wl 5
mvva 152 32 224
trv 50 12 512
mvva 152 36 240
dma 5 44 66 1024
mvva 156 36 244
ds_write_b32 v0, v129 offset:6148
mvva 156 32 228
trv 52 12 8192
mul 134 23 134
mvva 160 32 232
trv 54 12 8704
mul 135 23 135
mvva 160 36 248
ds_write_b32 v0, v144 offset:6656
mvva 164 36 252
trv 216 13 0
cvt 132 132 133
mvva 164 32 236
cvt 133 134 135
wl 7
mvva 180 40 236
ds_write_b32 v0, v145 offset:6660
mvva 180 44 252
trv 218 13 512
mul 149 23 149
mvva 176 44 248
trv 220 13 8192
mvva 176 40 232
mul 150 23 150
mvva 172 40 228
trv 222 13 8704
mul 151 23 151
mvva 172 44 244
s_waitcnt vmcnt(13)
s_barrier
mvva 168 44 240
s_mov_b32 s66, 1573376
s_add_u32 m0, s65, 49152
mvva 168 40 224
trv 32 13 16384
wl 7
mvva 184 48 224
dma 4 44 66 0
mvva 184 52 240
trv 34 13 16896
mvva 188 52 244
trv 36 13 24576
mvva 188 48 228
ds_write_b32 v0, v132 offset:7168
mvva 192 48 232
trv 38 13 25088
mul 148 23 148
mvva 192 52 248
dma 5 44 66 1024
mvva 196 52 252
trv 40 12 16384
mvva 196 48 236
wl 6
mvva 212 216 236
trv 42 12 16896
mvva 212 220 252
s_mov_b32 s66, 1835520
s_add_u32 m0, s65, 57344
mvva 208 220 248
trv 44 12 24576
mvva 208 216 232
dma 4 44 66 0
mvva 204 216 228
trv 46 12 25088
cvt 148 148 149
mvva 204 220 244
ds_write_b32 v0, v133 offset:7172
mvva 200 220 240
trv 48 11 16384
cvt 149 150 151
mvva 200 216 224
wl 6
mvvv 200 32 56
trv 50 11 16896
mvvv 200 36 72
dma 5 44 66 1024
mvvv 204 36 76
trv 52 11 24576
mvvv 204 32 60
mvvv 208 32 64
trv 54 11 25088
mvvv 208 36 80
ds_write_b32 v0, v148 offset:7680
mvvv 212 36 84
trv 216 10 16384
mvvv 212 32 68
wl 7
mvvv 196 40 68
ds_write_b32 v0, v149 offset:7684
mvvv 196 44 84
trv 218 10 16896
mvvv 192 44 80
trv 220 10 24576
mvvv 192 40 64
mvvv 188 40 60
trv 222 10 25088
mvvv 188 44 76
s_waitcnt vmcnt(13)
s_barrier
mvvv 184 44 72
s_mov_b32 s66, 2097664
s_add_u32 m0, s65, 65536
mvvv 184 40 56
trv 32 6 0
wl 7
mvvv 168 48 56
dma 4 44 66 0
mvvv 168 52 72
trv 34 6 512
mvvv 172 52 76
trv 36 6 8192
L_pga3:
s_cbranch_execz L_pga7
mvvv 172 48 60
mvvv 176 48 64
trv 38 6 8704
mvvv 176 52 80
dma 5 44 66 1024
mvvv 180 52 84
trv 40 7 0
mvvv 180 48 68
wl 5
mvvv 164 216 68
trv 42 7 512
mvvv 164 220 84
s_mov_b32 s66, 2359808
s_add_u32 m0, s65, 73728
mvvv 160 220 80
trv 44 7 8192
mvvv 160 216 64
dma 4 44 66 0
mvvv 156 216 60
trv 46 7 8704
mvvv 156 220 76
mvvv 152 220 72
trv 48 8 0
mvvv 152 216 56
wl 5
mzvva 88 32 0
trv 50 8 512
mvva 88 36 16
dma 5 44 66 1024
mzvva 92 36 20
trv 52 8 8192
mvva 92 32 4
mul 152 20 152
mul 153 20 153
mzvva 96 32 8
trv 54 8 8704
mul 155 20 155
mvva 96 36 24
mul 154 20 154
mul 168 20 168
mzvva 100 36 28
trv 216 9 0
mul 169 20 169
mvva 100 32 12
mul 170 20 170
wl 5
mzvva 116 40 12
trv 218 9 512
cvt 152 152 153
mvva 116 44 28
ds_write_b32 v0, v152 offset:8192
mzvva 112 44 24
trv 220 9 8192
cvt 153 154 155
mvva 112 40 8
cvt 168 168 169
mzvva 108 40 4
trv 222 9 8704
mvva 108 44 20
s_waitcnt vmcnt(12)
s_barrier
mzvva 104 44 16
s_mov_b32 s66, 2621952
s_add_u32 m0, s65, 81920
mvva 104 40 0
trv 32 9 16384
wl 6
mzvva 120 48 0
dma 4 44 66 0
mvva 120 52 16
trv 34 9 16896
mul 171 20 171
mzvva 124 52 20
trv 36 9 24576
mvva 124 48 4
ds_write_b32 v0, v153 offset:8196
mzvva 128 48 8
trv 38 9 25088
cvt 169 170 171
mvva 128 52 24
dma 5 44 66 1024
mzvva 132 52 28
trv 40 8 16384
mul 156 21 156
mvva 132 48 12
mul 157 21 157
wl 6
mzvva 148 216 12
trv 42 8 16896
s_mov_b32 s76, 0x3f803f80
mvva 148 220 28
s_mov_b32 s66, 2884096
s_add_u32 m0, s65, 90112
mzvva 144 220 24
trv 44 8 24576
s_mov_b32 s89, 0
mvva 144 216 8
dma 4 44 66 0
s_mov_b32 s87, 8192
mzvva 140 216 4
trv 46 8 25088
s_mov_b32 s79, 0
mvva 140 220 20
ds_write_b32 v0, v168 offset:8704
mzvva 136 220 16
trv 48 7 16384
s_mov_b32 s69, 0
mvva 136 216 0
mul 158 21 158
wl 6
mvva 136 32 32
ds_write_b32 v0, v169 offset:8708
mvva 136 36 48
trv 50 7 16896
cvt 156 156 157
mvva 140 36 52
dma 5 44 66 1024
mvva 140 32 36
trv 52 7 24576
mul 172 21 172
mvva 144 32 40
trv 54 7 25088
mul 173 21 173
mvva 144 36 56
mul 174 21 174
mul 175 21 175
mvva 148 36 60
trv 216 6 16384
cvt 172 172 173
mvva 148 32 44
wl 7
mvva 132 40 44
trv 218 6 16896
mul 159 21 159
mvva 132 44 60
cvt 173 174 175
mvva 128 44 56
trv 220 6 24576
mvva 128 40 40
ds_write_b32 v0, v156 offset:9216
mvva 124 40 36
trv 222 6 25088
cvt 157 158 159
mvva 124 44 52
s_waitcnt vmcnt(12)
s_barrier
mvva 120 44 48
s_mov_b32 s66, 3146240
s_add_u32 m0, s65, 0
mvva 120 40 32
trv 32 6 32768
wl 6
mvva 104 48 32
dma 4 44 66 0
mvva 104 52 48
trv 34 6 33280
mvva 108 52 52
trv 36 6 40960
mvva 108 48 36
mvva 112 48 40
trv 38 6 41472
mvva 112 52 56
dma 5 44 66 1024
mvva 116 52 60
trv 40 7 32768
mvva 116 48 44
mul 160 22 160
wl 5
mvva 100 216 44
trv 42 7 33280
mvva 100 220 60
s_mov_b32 s66, 3408384
s_add_u32 m0, s65, 8192
mvva 96 220 56
trv 44 7 40960
mul 161 22 161
mvva 96 216 40
dma 4 44 66 0
mvva 92 216 36
ds_write_b32 v0, v157 offset:9220
mvva 92 220 52
trv 46 7 41472
mul 162 22 162
mvva 88 220 48
ds_write_b32 v0, v172 offset:9728
mvva 88 216 32
trv 48 8 32768
wl 7
mvva 88 32 64
trv 50 8 33280
mul 163 22 163
mvva 88 36 80
dma 5 44 66 1024
mvva 92 36 84
ds_write_b32 v0, v173 offset:9732
mvva 92 32 68
trv 52 8 40960
mul 176 22 176
mvva 96 32 72
trv 54 8 41472
mul 177 22 177
mvva 96 36 88
mul 178 22 178
mvva 100 36 92
trv 216 9 32768
mul 179 22 179
mvva 100 32 76
wl 7
mvva 116 40 76
trv 218 9 33280
cvt 176 176 177
mvva 116 44 92
cvt 177 178 179
mvva 112 44 88
trv 220 9 40960
mvva 112 40 72
cvt 160 160 161
mvva 108 40 68
trv 222 9 41472
cvt 161 162 163
mvva 108 44 84
s_waitcnt vmcnt(12)
s_barrier
mvva 104 44 80
s_mov_b32 s66, 3670528
s_add_u32 m0, s65, 16384
mvva 104 40 64
trv 32 9 49152
wl 5
mvva 120 48 64
dma 4 44 66 0
mvva 120 52 80
trv 34 9 49664
mvva 124 52 84
trv 36 9 57344
mvva 124 48 68
mvva 128 48 72
trv 38 9 57856
mvva 128 52 88
dma 5 44 66 1024
mvva 132 52 92
trv 40 8 49152
mvva 132 48 76
wl 5
mvva 148 216 76
trv 42 8 49664
mul 164 23 164
mvva 148 220 92
ds_write_b32 v0, v160 offset:10240
mvva 144 220 88
s_mov_b32 s66, 3932672
s_add_u32 m0, s65, 24576
mvva 144 216 72
trv 44 8 57344
mul 165 23 165
mvva 140 216 68
dma 4 44 66 0
mvva 140 220 84
ds_write_b32 v0, v161 offset:10244
mvva 136 220 80
trv 46 8 57856
mul 166 23 166
mvva 136 216 64
trv 48 7 49152
wl 7
mvva 136 32 96
ds_write_b32 v0, v176 offset:10752
mvva 136 36 112
trv 50 7 49664
mul 167 23 167
mvva 140 36 116
dma 5 44 66 1024
mvva 140 32 100
trv 52 7 57344
cvt 164 164 165
mvva 144 32 104
ds_write_b32 v0, v177 offset:10756
mvva 144 36 120
trv 54 7 57856
mul 180 23 180
mvva 148 36 124
trv 216 6 49152
mul 181 23 181
mvva 148 32 108
mul 182 23 182
wl 7
mvva 132 40 108
trv 218 6 49664
mul 183 23 183
mvva 132 44 124
cvt 180 180 181
mvva 128 44 120
trv 220 6 57344
mvva 128 40 104
cvt 181 182 183
mvva 124 40 100
trv 222 6 57856
mvva 124 44 116
s_waitcnt vmcnt(12)
s_barrier
mvva 120 44 112
s_mov_b32 s66, 4194816
s_add_u32 m0, s65, 32768
mvva 120 40 96
trv 32 10 0
wl 5
mvva 104 48 96
dma 4 44 66 0
mvva 104 52 112
trv 34 10 512
cvt 165 166 167
mvva 108 52 116
trv 36 10 8192
mvva 108 48 100
mvva 112 48 104
trv 38 10 8704
mvva 112 52 120
dma 5 44 66 1024
mvva 116 52 124
trv 40 11 0
mvva 116 48 108
wl 5
mvva 100 216 108
trv 42 11 512
mvva 100 220 124
s_mov_b32 s66, 4456960
s_add_u32 m0, s65, 40960
mvva 96 220 120
ds_write_b32 v0, v164 offset:11264
mvva 96 216 104
trv 44 11 8192
mul 184 20 184
mvva 92 216 100
dma 4 44 66 0
s_lshl_b32 s83, s75, 10
mvva 92 220 116
trv 46 11 8704
s_sub_u32 s84, 0x8000, s83
mvva 88 220 112
ds_write_b32 v0, v165 offset:11268
mvva 88 216 96
trv 48 12 0
wl 7
mvva 88 32 128
trv 50 12 512
s_lshl_b32 s85, s75, 6
mvva 88 36 144
dma 5 44 66 1024
mvva 92 36 148
ds_write_b32 v0, v180 offset:11776
mvva 92 32 132
trv 52 12 8192
mul 185 20 185
mvva 96 32 136
ds_write_b32 v0, v181 offset:11780
mvva 96 36 152
trv 54 12 8704
mul 187 20 187
mvva 100 36 156
trv 216 13 0
cvt 184 184 185
mvva 100 32 140
mul 200 20 200
wl 8
mvva 116 40 140
trv 218 13 512
mul 201 20 201
mvva 116 44 156
mul 202 20 202
mul 203 20 203
mvva 112 44 152
trv 220 13 8192
mul 186 20 186
mvva 112 40 136
cvt 200 200 201
mvva 108 40 132
trv 222 13 8704
cvt 201 202 203
mvva 108 44 148
s_waitcnt vmcnt(12)
s_barrier
mvva 104 44 144
s_mov_b32 s66, 640
s_add_u32 m0, s65, 49152
mvva 104 40 128
trv 32 13 16384
wl 5
mvva 120 48 128
dma 4 44 66 0
mvva 120 52 144
trv 34 13 16896
cvt 185 186 187
mvva 124 52 148
trv 36 13 24576
mvva 124 48 132
mvva 128 48 136
trv 38 13 25088
mvva 128 52 152
dma 5 44 66 1024
mvva 132 52 156
trv 40 12 16384
mvva 132 48 140
wl 5
mvva 148 216 140
trv 42 12 16896
mvva 148 220 156
s_mov_b32 s66, 262784
s_add_u32 m0, s65, 57344
mvva 144 220 152
trv 44 12 24576
mvva 144 216 136
dma 4 44 66 0
mvva 140 216 132
ds_write_b32 v0, v184 offset:12288
mvva 140 220 148
trv 46 12 25088
mul 188 21 188
mvva 136 220 144
trv 48 11 16384
mul 189 21 189
mvva 136 216 128
mul 190 21 190
wl 6
mvva 136 32 160
ds_write_b32 v0, v185 offset:12292
mvva 136 36 176
trv 50 11 16896
mul 191 21 191
mvva 140 36 180
dma 5 44 66 1024
mvva 140 32 164
ds_write_b32 v0, v200 offset:12800
mvva 144 32 168
trv 52 11 24576
cvt 188 188 189
mvva 144 36 184
trv 54 11 25088
cvt 189 190 191
mvva 148 36 188
ds_write_b32 v0, v201 offset:12804
mvva 148 32 172
trv 216 10 16384
wl 8
mvva 132 40 172
trv 218 10 16896
mul 205 21 205
mvva 132 44 188
mul 206 21 206
mvva 128 44 184
trv 220 10 24576
mul 207 21 207
mvva 128 40 168
mvva 124 40 164
trv 222 10 25088
mvva 124 44 180
s_waitcnt vmcnt(12)
s_barrier
mvva 120 44 176
s_mov_b32 s66, 524928
s_add_u32 m0, s65, 65536
mvva 120 40 160
trv 32 6 0
wl 6
mvva 104 48 160
dma 4 44 66 0
mvva 104 52 176
trv 34 6 512
mvva 108 52 180
trv 36 6 8192
mul 204 21 204
mvva 108 48 164
ds_write_b32 v0, v188 offset:13312
mvva 112 48 168
trv 38 6 8704
mvva 112 52 184
dma 5 44 66 1024
mvva 116 52 188
trv 40 7 0
mvva 116 48 172
wl 6
mvva 100 216 172
trv 42 7 512
cvt 204 204 205
mvva 100 220 188
s_mov_b32 s66, 787072
s_add_u32 m0, s65, 73728
mvva 96 220 184
trv 44 7 8192
cvt 205 206 207
mvva 96 216 168
dma 4 44 66 0
mvva 92 216 164
trv 46 7 8704
mul 192 22 192
mvva 92 220 180
mvva 88 220 176
trv 48 8 0
mul 193 22 193
mvva 88 216 160
mul 194 22 194
wl 5
mvva 88 32 192
ds_write_b32 v0, v189 offset:13316
mvva 88 36 208
trv 50 8 512
mul 195 22 195
mvva 92 36 212
dma 5 44 66 1024
mvva 92 32 196
trv 52 8 8192
cvt 192 192 193
mvva 96 32 200
ds_write_b32 v0, v204 offset:13824
mvva 96 36 216
trv 54 8 8704
cvt 193 194 195
mvva 100 36 220
trv 216 9 0
mul 208 22 208
mvva 100 32 204
wl 7
mvva 116 40 204
ds_write_b32 v0, v205 offset:13828
mvva 116 44 220
trv 218 9 512
mul 210 22 210
mvva 112 44 216
trv 220 9 8192
mvva 112 40 200
mul 211 22 211
mvva 108 40 196
trv 222 9 8704
mvva 108 44 212
s_waitcnt vmcnt(12)
s_barrier
mvva 104 44 208
s_mov_b32 s66, 1049216
s_add_u32 m0, s65, 81920
mvva 104 40 192
trv 32 9 16384
wl 6
mvva 120 48 192
dma 4 44 66 0
mvva 120 52 208
trv 34 9 16896
mvva 124 52 212
trv 36 9 24576
mvva 124 48 196
ds_write_b32 v0, v192 offset:14336
mvva 128 48 200
trv 38 9 25088
mvva 128 52 216
dma 5 44 66 1024
mvva 132 52 220
trv 40 8 16384
mul 209 22 209
mvva 132 48 204
wl 6
mvva 148 216 204
trv 42 8 16896
mvva 148 220 220
s_mov_b32 s66, 1311360
s_add_u32 m0, s65, 90112
mvva 144 220 216
L_pga4:
s_cbranch_execz L_pga8
trv 44 8 24576
cvt 208 208 209
mvva 144 216 200
dma 4 44 66 0
mvva 140 216 196
trv 46 8 25088
cvt 209 210 211
mvva 140 220 212
mul 196 23 196
mvva 136 220 208
trv 48 7 16384
mvva 136 216 192
mul 197 23 197
wl 5
mvva 136 32 224
trv 50 7 16896
mvva 136 36 240
dma 5 44 66 1024
mvva 140 36 244
ds_write_b32 v0, v193 offset:14340
mvva 140 32 228
trv 52 7 24576
mul 198 23 198
mvva 144 32 232
trv 54 7 25088
mul 199 23 199
mvva 144 36 248
ds_write_b32 v0, v208 offset:14848
mvva 148 36 252
trv 216 6 16384
cvt 196 196 197
mvva 148 32 236
cvt 197 198 199
wl 7
mvva 132 40 236
ds_write_b32 v0, v209 offset:14852
mvva 132 44 252
trv 218 6 16896
mul 213 23 213
mvva 128 44 248
trv 220 6 24576
mvva 128 40 232
mul 214 23 214
mvva 124 40 228
trv 222 6 25088
mul 215 23 215
mvva 124 44 244
s_waitcnt vmcnt(12)
s_barrier
mvva 120 44 240
s_mov_b32 s66, 1573504
s_add_u32 m0, s65, 0
mvva 120 40 224
trv 32 6 32768
wl 7
mvva 104 48 224
dma 4 44 66 0
mvva 104 52 240
trv 34 6 33280
mvva 108 52 244
trv 36 6 40960
mvva 108 48 228
ds_write_b32 v0, v196 offset:15360
mvva 112 48 232
trv 38 6 41472
mul 212 23 212
mvva 112 52 248
dma 5 44 66 1024
mvva 116 52 252
trv 40 7 32768
mvva 116 48 236
wl 6
mvva 100 216 236
trv 42 7 33280
mvva 100 220 252
s_mov_b32 s66, 1835648
s_add_u32 m0, s65, 8192
mvva 96 220 248
trv 44 7 40960
mvva 96 216 232
dma 4 44 66 0
mvva 92 216 228
trv 46 7 41472
cvt 212 212 213
mvva 92 220 244
ds_write_b32 v0, v197 offset:15364
mvva 88 220 240
trv 48 8 32768
cvt 213 214 215
mvva 88 216 224
wl 6
mvvv 88 32 56
trv 50 8 33280
mvvv 88 36 72
dma 5 44 66 1024
mvvv 92 36 76
trv 52 8 40960
mvvv 92 32 60
mvvv 96 32 64
trv 54 8 41472
mvvv 96 36 80
ds_write_b32 v0, v212 offset:15872
mvvv 100 36 84
trv 216 9 32768
mvvv 100 32 68
wl 7
mvvv 116 40 68
ds_write_b32 v0, v213 offset:15876
mvvv 116 44 84
trv 218 9 33280
mvvv 112 44 80
trv 220 9 40960
mvvv 112 40 64
mvvv 108 40 60
trv 222 9 41472
mvvv 108 44 76
s_waitcnt vmcnt(12)
s_barrier
mvvv 104 44 72
s_mov_b32 s66, 2097792
s_add_u32 m0, s65, 16384
mvvv 104 40 56
trv 32 9 49152
wl 7
mvvv 120 48 56
dma 4 44 66 0
mvvv 120 52 72
trv 34 9 49664
mvvv 124 52 76
trv 36 9 57344
mvvv 124 48 60
mvvv 128 48 64
trv 38 9 57856
mvvv 128 52 80
dma 5 44 66 1024
mvvv 132 52 84
trv 40 8 49152
mvvv 132 48 68
wl 5
mvvv 148 216 68
trv 42 8 49664
mvvv 148 220 84
s_mov_b32 s66, 2359936
s_add_u32 m0, s65, 24576
mvvv 144 220 80
trv 44 8 57344
mvvv 144 216 64
dma 4 44 66 0
mvvv 140 216 60
trv 46 8 57856
mvvv 140 220 76
mvvv 136 220 72
trv 48 7 49152
mvvv 136 216 56
wl 5
mzvva 200 32 0
trv 50 7 49664
mvva 200 36 16
dma 5 44 66 1024
mzvva 204 36 20
trv 52 7 57344
mvva 204 32 4
mul 88 20 88
mul 90 20 90
mzvva 208 32 8
trv 54 7 57856
mul 89 20 89
mvva 208 36 24
cvt 88 88 89
mul 104 20 104
mzvva 212 36 28
trv 216 6 49152
mul 105 20 105
mvva 212 32 12
mul 106 20 106
wl 5
mzvva 196 40 12
trv 218 6 49664
mul 91 20 91
mvva 196 44 28
mul 107 20 107
cvt 104 104 105
mzvva 192 44 24
trv 220 6 57344
mvva 192 40 8
cvt 105 106 107
mzvva 188 40 4
trv 222 6 57856
cvt 89 90 91
mvva 188 44 20
s_waitcnt vmcnt(12)
s_barrier
mzvva 184 44 16
s_mov_b32 s66, 2622080
s_add_u32 m0, s65, 32768
mvva 184 40 0
trv 32 10 0
wl 5
mzvva 168 48 0
dma 4 44 66 0
mvva 168 52 16
trv 34 10 512
mul 93 21 93
mzvva 172 52 20
trv 36 10 8192
mul 94 21 94
mvva 172 48 4
mul 95 21 95
mzvva 176 48 8
trv 38 10 8704
mvva 176 52 24
dma 5 44 66 1024
mzvva 180 52 28
trv 40 11 0
mvva 180 48 12
wl 5
mzvva 164 216 12
trv 42 11 512
mvva 164 220 28
s_mov_b32 s66, 2884224
s_add_u32 m0, s65, 40960
mzvva 160 220 24
trv 44 11 8192
mul 92 21 92
mvva 160 216 8
dma 4 44 66 0
mzvva 156 216 4
trv 46 11 8704
mul 108 21 108
mvva 156 220 20
mul 109 21 109
mul 110 21 110
mzvva 152 220 16
trv 48 12 0
mvva 152 216 0
mul 111 21 111
wl 5
mvva 152 32 32
trv 50 12 512
mvva 152 36 48
dma 5 44 66 1024
mvva 156 36 52
trv 52 12 8192
cvt 92 92 93
mvva 156 32 36
cvt 108 108 109
cvt 109 110 111
mvva 160 32 40
trv 54 12 8704
s_and_b32 s86, s72, 15
mvva 160 36 56
cvt 93 94 95
mvva 164 36 60
trv 216 13 0
s_lshl_b32 s86, s86, 2
mvva 164 32 44
wl 5
mvva 180 40 44
trv 218 13 512
mul 97 22 97
mvva 180 44 60
s_add_u32 s86, s86, s64
mvva 176 44 56
trv 220 13 8192
mul 98 22 98
mvva 176 40 40
mvva 172 40 36
trv 222 13 8704
s_mul_i32 s86, s86, 384
mvva 172 44 52
s_waitcnt vmcnt(12)
s_barrier
mvva 168 44 48
s_mov_b32 s66, 3146368
s_add_u32 m0, s65, 49152
mvva 168 40 32
trv 32 13 16384
wl 5
mvva 184 48 32
dma 4 44 66 0
mvva 184 52 48
trv 34 13 16896
v_mov_b32 v24, v249
mvva 188 52 52
trv 36 13 24576
v_cmp_gt_u32 vcc, 3, v24
mvva 188 48 36
mul 96 22 96
cvt 96 96 97
mvva 192 48 40
trv 38 13 25088
mul 112 22 112
mvva 192 52 56
dma 5 44 66 1024
mvva 196 52 60
trv 40 12 16384
v_lshlrev_b32 v24, 7, v24
mvva 196 48 44
mul 113 22 113
wl 5
mvva 212 216 44
trv 42 12 16896
v_mov_b32 v247, 0x7fffffff
mvva 212 220 60
s_mov_b32 s66, 3408512
s_add_u32 m0, s65, 57344
mvva 208 220 56
trv 44 12 24576
mul 99 22 99
mvva 208 216 40
dma 4 44 66 0
mvva 204 216 36
trv 46 12 25088
v_cndmask_b32 v24, v247, v24, vcc
mvva 204 220 52
cvt 97 98 99
mul 115 22 115
mvva 200 220 48
trv 48 11 16384
cvt 112 112 113
mvva 200 216 32
mul 100 23 100
wl 5
mvva 200 32 64
rda 0 27 0
mul 101 23 101
mvva 200 36 80
trv 50 11 16896
mvva 204 36 84
dma 5 44 66 1024
mvva 204 32 68
trv 52 11 24576
mul 114 22 114
mvva 208 32 72
rda 4 27 1024
mul 102 23 102
mvva 208 36 88
trv 54 11 25088
mul 103 23 103
mvva 212 36 92
trv 216 10 16384
cvt 100 100 101
mvva 212 32 76
rda 8 27 2048
wl 8
mvva 196 40 76
trv 218 10 16896
cvt 101 102 103
mvva 196 44 92
cvt 113 114 115
mvva 192 44 88
trv 220 10 24576
mvva 192 40 72
rda 12 27 3072
mvva 188 40 68
trv 222 10 25088
mul 117 23 117
mvva 188 44 84
s_waitcnt vmcnt(12)
s_barrier
mvva 184 44 80
s_mov_b32 s66, 3670656
s_add_u32 m0, s65, 65536
mvva 184 40 64
trv 32 6 0
wl 7
mvva 168 48 64
dma 4 44 66 0
mvva 168 52 80
rda 16 27 4096
mul 118 23 118
mvva 172 52 84
trv 34 6 512
mul 119 23 119
mvva 172 48 68
trv 36 6 8192
mvva 176 48 72
rda 20 27 5120
mvva 176 52 88
trv 38 6 8704
mvva 180 52 92
dma 5 44 66 1024
mvva 180 48 76
trv 40 7 0
wl 7
mvva 164 216 76
rda 24 27 6144
mul 116 23 116
mvva 164 220 92
trv 42 7 512
s_mov_b32 s66, 3932800
mvva 160 220 88
s_add_u32 m0, s65, 73728
trv 44 7 8192
mvva 160 216 72
dma 4 44 66 0
mvva 156 216 68
rda 28 27 7168
mul 120 20 120
mvva 156 220 84
trv 46 7 8704
mul 121 20 121
mvva 152 220 80
trv 48 8 0
mul 122 20 122
mvva 152 216 64
rda 32 27 8192
wl 8
mvva 152 32 96
trv 50 8 512
cvt 116 116 117
mvva 152 36 112
dma 5 44 66 1024
mvva 156 36 116
trv 52 8 8192
cvt 117 118 119
mvva 156 32 100
rda 36 27 9216
cvt 120 120 121
mvva 160 32 104
trv 54 8 8704
mul 136 20 136
mvva 160 36 120
mul 137 20 137
mvva 164 36 124
trv 216 9 0
mvva 164 32 108
rda 40 27 10240
wl 8
mvva 180 40 108
trv 218 9 512
mul 138 20 138
mvva 180 44 124
mul 139 20 139
mvva 176 44 120
trv 220 9 8192
mul 123 20 123
mvva 176 40 104
rda 44 27 11264
cvt 136 136 137
mvva 172 40 100
trv 222 9 8704
mvva 172 44 116
s_waitcnt vmcnt(12)
s_barrier
mvva 168 44 112
s_mov_b32 s66, 4194944
s_add_u32 m0, s65, 81920
mvva 168 40 96
trv 32 9 16384
wl 7
mvva 184 48 96
dma 4 44 66 0
mvva 184 52 112
rda 48 27 12288
cvt 121 122 123
mvva 188 52 116
trv 34 9 16896
mul 124 21 124
mvva 188 48 100
trv 36 9 24576
mul 125 21 125
mvva 192 48 104
rda 52 27 13312
mul 126 21 126
mvva 192 52 120
trv 38 9 25088
mul 127 21 127
mvva 196 52 124
dma 5 44 66 1024
mvva 196 48 108
trv 40 8 16384
wl 7
mvva 212 216 108
rda 56 27 14336
cvt 124 124 125
mvva 212 220 124
trv 42 8 16896
s_mov_b32 s66, 4457088
mvva 208 220 120
s_add_u32 m0, s65, 90112
trv 44 8 24576
mvva 208 216 104
dma 4 44 66 0
mvva 204 216 100
rda 60 27 15360
cvt 137 138 139
mvva 204 220 116
trv 46 8 25088
mul 140 21 140
mvva 200 220 112
trv 48 7 16384
mul 141 21 141
mvva 200 216 96
mul 142 21 142
wl 7
mvva 200 32 128
trv 50 7 16896
mvva 200 36 144
dma 5 44 66 1024
mvva 204 36 148
trv 52 7 24576
mul 143 21 143
mvva 204 32 132
cvt 140 140 141
mvva 208 32 136
trv 54 7 25088
mvva 208 36 152
cvt 141 142 143
mvva 212 36 156
trv 216 6 16384
cvt 125 126 127
mvva 212 32 140
wl 5
mvva 196 40 140
trv 218 6 16896
mvva 196 44 156
mvva 192 44 152
trv 220 6 24576
mul 129 22 129
mvva 192 40 136
mvva 188 40 132
trv 222 6 25088
mul 130 22 130
mvva 188 44 148
s_waitcnt vmcnt(12)
s_barrier
mvva 184 44 144
s_mov_b32 s80, 0
s_add_u32 m0, s65, 0
mvva 184 40 128
trv 32 6 32768
wl 5
mvva 168 48 128
dma 14 48 80 0
mvva 168 52 144
trv 34 6 33280
mul 131 22 131
mvva 172 52 148
trv 36 6 40960
mvva 172 48 132
mvva 176 48 136
trv 38 6 41472
mul 144 22 144
mvva 176 52 152
dma 15 48 80 1024
mvva 180 52 156
trv 40 7 32768
mul 128 22 128
mvva 180 48 140
mul 145 22 145
wl 5
mvva 164 216 140
trv 42 7 33280
mul 146 22 146
mvva 164 220 156
s_add_u32 s80, s80, 8192
s_add_u32 m0, s65, 8192
mvva 160 220 152
trv 44 7 40960
mul 147 22 147
mvva 160 216 136
dma 14 48 80 0
mvva 156 216 132
trv 46 7 41472
cvt 144 144 145
mvva 156 220 148
cvt 128 128 129
mvva 152 220 144
trv 48 8 32768
L_pga5:
s_cbranch_execz L_pga9
cvt 145 146 147
mvva 152 216 128
cvt 129 130 131
wl 5
mvva 152 32 160
trv 50 8 33280
mvva 152 36 176
dma 15 48 80 1024
mvva 156 36 180
trv 52 8 40960
mul 133 23 133
mvva 156 32 164
mvva 160 32 168
trv 54 8 41472
mul 134 23 134
mvva 160 36 184
mvva 164 36 188
trv 216 9 32768
mul 135 23 135
mvva 164 32 172
wl 5
mvva 180 40 172
trv 218 9 33280
mvva 180 44 188
mvva 176 44 184
trv 220 9 40960
mvva 176 40 168
mvva 172 40 164
trv 222 9 41472
mul 148 23 148
mvva 172 44 180
s_waitcnt vmcnt(12)
s_barrier
mvva 168 44 176
s_add_u32 s80, s80, 8192
s_add_u32 m0, s65, 16384
mvva 168 40 160
trv 32 9 49152
wl 5
mvva 184 48 160
dma 14 48 80 0
mvva 184 52 176
trv 34 9 49664
mul 132 23 132
mvva 188 52 180
trv 36 9 57344
mul 149 23 149
mvva 188 48 164
mul 150 23 150
mul 151 23 151
mvva 192 48 168
trv 38 9 57856
cvt 148 148 149
mvva 192 52 184
cvt 132 132 133
mvva 196 52 188
trv 40 8 49152
cvt 149 150 151
mvva 196 48 172
cvt 133 134 135
wl 5
mvva 212 216 172
trv 42 8 49664
mvva 212 220 188
mvva 208 220 184
trv 44 8 57344
mvva 208 216 168
dma 15 48 80 1024
mvva 204 216 164
trv 46 8 57856
mvva 204 220 180
mvva 200 220 176
trv 48 7 49152
mvva 200 216 160
wl 5
mvva 200 32 192
trv 50 7 49664
mvva 200 36 208
mvva 204 36 212
trv 52 7 57344
mvva 204 32 196
mvva 208 32 200
trv 54 7 57856
mvva 208 36 216
mvva 212 36 220
trv 216 6 49152
mvva 212 32 204
wl 5
mvva 196 40 204
trv 218 6 49664
mvva 196 44 220
mvva 192 44 216
trv 220 6 57344
mvva 192 40 200
ds_write_b32 v0, v88 offset:0
mvva 188 40 196
trv 222 6 57856
mvva 188 44 212
s_waitcnt vmcnt(10)
s_barrier
mvva 184 44 208
ds_write_b32 v0, v89 offset:4
mvva 184 40 192
s_mov_b32 s81, 0
wl 6
mvva 168 48 192
s_add_u32 m0, s65, 32768
trv 32 10 0
mvva 168 52 208
dma 2 56 81 0
mvva 172 52 212
ds_write_b32 v0, v104 offset:512
mvva 172 48 196
trv 34 10 512
mvva 176 48 200
ds_write_b32 v0, v105 offset:516
mvva 176 52 216
trv 36 10 8192
mvva 180 52 220
dma 3 56 81 1024
s_add_u32 s80, s80, 8192
mvva 180 48 204
trv 38 10 8704
wl 7
mvva 164 216 204
ds_write_b32 v0, v92 offset:1024
mvva 164 220 220
ds_write_b32 v0, v93 offset:1028
mvva 160 220 216
s_add_u32 m0, s65, 24576
trv 40 11 0
mvva 160 216 200
dma 14 48 80 0
mvva 156 216 196
ds_write_b32 v0, v108 offset:1536
mvva 156 220 212
trv 42 11 512
mvva 152 220 208
ds_write_b32 v0, v109 offset:1540
mvva 152 216 192
trv 44 11 8192
wl 7
mvva 152 32 224
dma 15 48 80 1024
s_add_u32 s81, s81, 8192
mvva 152 36 240
ds_write_b32 v0, v96 offset:2048
mvva 156 36 244
trv 46 11 8704
s_add_u32 m0, s65, 40960
mvva 156 32 228
ds_write_b32 v0, v97 offset:2052
mvva 160 32 232
trv 48 12 0
mvva 160 36 248
dma 2 56 81 0
mvva 164 36 252
ds_write_b32 v0, v112 offset:2560
mvva 164 32 236
trv 50 12 512
wl 4
mvva 180 40 236
trv 52 12 8192
mvva 180 44 252
dma 3 56 81 1024
mvva 176 44 248
trv 54 12 8704
ds_write_b32 v0, v113 offset:2564
mvva 176 40 232
ds_write_b32 v0, v100 offset:3072
mvva 172 40 228
trv 216 13 0
mvva 172 44 244
s_waitcnt vmcnt(12)
s_barrier
mvva 168 44 240
ds_write_b32 v0, v101 offset:3076
mvva 168 40 224
trv 218 13 512
wl 5
mvva 184 48 224
ds_write_b32 v0, v116 offset:3584
mvva 184 52 240
trv 220 13 8192
ds_write_b32 v0, v117 offset:3588
mvva 188 52 244
trv 222 13 8704
mvva 188 48 228
ds_write_b32 v0, v120 offset:4096
mvva 192 48 232
trv 32 13 16384
mvva 192 52 248
ds_write_b32 v0, v121 offset:4100
mvva 196 52 252
trv 34 13 16896
mvva 196 48 236
trv 36 13 24576
wl 5
mvva 212 216 236
ds_write_b32 v0, v136 offset:4608
mvva 212 220 252
ds_write_b32 v0, v137 offset:4612
mvva 208 220 248
trv 38 13 25088
mvva 208 216 232
ds_write_b32 v0, v124 offset:5120
mvva 204 216 228
trv 40 12 16384
mvva 204 220 244
ds_write_b32 v0, v125 offset:5124
mvva 200 220 240
trv 42 12 16896
mvva 200 216 224
trv 44 12 24576
wl 5
mvvv 200 32 56
ds_write_b32 v0, v140 offset:5632
mvvv 200 36 72
trv 46 12 25088
mvvv 204 36 76
ds_write_b32 v0, v141 offset:5636
mvvv 204 32 60
trv 48 11 16384
mvvv 208 32 64
ds_write_b32 v0, v128 offset:6144
mvvv 208 36 80
trv 50 11 16896
mvvv 212 36 84
ds_write_b32 v0, v129 offset:6148
mvvv 212 32 68
trv 52 11 24576
wl 6
mvvv 196 40 68
ds_write_b32 v0, v144 offset:6656
mvvv 196 44 84
trv 54 11 25088
mvvv 192 44 80
ds_write_b32 v0, v145 offset:6660
mvvv 192 40 64
trv 216 10 16384
mvvv 188 40 60
ds_write_b32 v0, v132 offset:7168
mvvv 188 44 76
s_waitcnt vmcnt(10)
s_barrier
mvvv 184 44 72
trv 218 10 16896
mvvv 184 40 56
trv 220 10 24576
wl 5
mvvv 168 48 56
ds_write_b32 v0, v133 offset:7172
mvvv 168 52 72
ds_write_b32 v0, v148 offset:7680
mvvv 172 52 76
trv 222 10 25088
mvvv 172 48 60
rda 64 16 0
rda 68 17 0
mvvv 176 48 64
ds_write_b32 v0, v149 offset:7684
mvvv 176 52 80
rda 72 18 0
mvvv 180 52 84
rda 76 19 0
mvvv 180 48 68
rda 80 16 4096
wl 6
mvvv 164 216 68
mvvv 164 220 84
mvvv 160 220 80
mvvv 160 216 64
rda 84 17 4096
v_subrev_u32 v10, s83, v6
mvvv 156 216 60
v_xor_b32 v10, s85, v10
v_add_u32 v6, s84, v6
mvvv 156 220 76
v_add_u32 v7, s84, v7
v_add_u32 v8, s84, v8
mvvv 152 220 72
v_add_u32 v9, s84, v9
v_mov_b32 v4, v10
mvvv 152 216 56
wl 2
s_cmp_lg_u32 s88, 0
s_cbranch_scc1 L_slow
mzvaa 32 64 0
rda 88 18 4096
mvaa 32 68 16
mvaa 32 72 32
mvaa 32 76 48
rda 92 19 4096
mul 152 20 152
mzvaa 36 76 52
mul 153 20 153
mul 154 20 154
mvaa 36 72 36
mul 155 20 155
cvt 152 152 153
mvaa 36 68 20
cvt 153 154 155
mul 168 20 168
mvaa 36 64 4
mul 169 20 169
mzvaa 40 64 8
mul 170 20 170
mul 171 20 171
mvaa 40 68 24
cvt 168 168 169
cvt 169 170 171
mvaa 40 72 40
ds_write2st64_b64 v0, v[152:153], v[168:169] offset0:16 offset1:17
mvaa 40 76 56
mul 156 21 156
mul 157 21 157
mzvaa 44 76 60
s_waitcnt vmcnt(8)
s_barrier
mvaa 44 72 44
mul 158 21 158
mul 159 21 159
mvaa 44 68 28
cvt 156 156 157
cvt 157 158 159
mvaa 44 64 12
rda 64 16 8192
wl 2
mzvaa 48 80 0
rda 68 17 8192
mul 172 21 172
mvaa 48 84 16
rda 72 18 8192
mul 173 21 173
mvaa 48 88 32
mul 174 21 174
mul 175 21 175
mvaa 48 92 48
rda 76 19 8192
cvt 172 172 173
mzvaa 52 92 52
cvt 173 174 175
mul 160 22 160
mvaa 52 88 36
ds_write2st64_b64 v0, v[156:157], v[172:173] offset0:18 offset1:19
mvaa 52 84 20
mul 161 22 161
mul 162 22 162
mvaa 52 80 4
mul 163 22 163
mzvaa 56 80 8
cvt 160 160 161
cvt 161 162 163
mvaa 56 84 24
mul 176 22 176
mul 177 22 177
mvaa 56 88 40
mul 178 22 178
mul 179 22 179
mvaa 56 92 56
cvt 176 176 177
cvt 177 178 179
mzvaa 60 92 60
ds_write2st64_b64 v0, v[160:161], v[176:177] offset0:20 offset1:21
mvaa 60 88 44
mul 164 23 164
mul 165 23 165
mvaa 60 84 28
mul 166 23 166
mul 167 23 167
mvaa 60 80 12
rda 80 16 12288
wl 3
mzvaa 64 64 0
rda 84 17 12288
cvt 164 164 165
mvaa 64 68 16
rda 88 18 12288
cvt 165 166 167
mvaa 64 72 32
exp 32 32
mvaa 64 76 48
rda 92 19 12288
mul 180 23 180
mzvaa 68 76 52
exp 33 33
mvaa 68 72 36
exp 34 34
mvaa 68 68 20
s_waitcnt vmcnt(4)
s_barrier
mvaa 68 64 4
s_add_u32 s80, s80, 8192
mzvaa 72 64 8
s_add_u32 m0, s65, 0
mul 181 23 181
mvaa 72 68 24
dma 14 48 80 0
mul 182 23 182
mvaa 72 72 40
exp 35 35
mvaa 72 76 56
tra 128 6 0
mul 183 23 183
mzvaa 76 76 60
exp 36 36
mvaa 76 72 44
tra 130 6 512
cvt 180 180 181
mvaa 76 68 28
exp 37 37
mvaa 76 64 12
rda 64 16 16384
wl 3
mzvaa 80 80 0
rda 68 17 16384
cvt 181 182 183
mvaa 80 84 16
ds_write2st64_b64 v0, v[164:165], v[180:181] offset0:22 offset1:23
mvaa 80 88 32
rda 72 18 16384
v_accvgpr_write_b32 a240, s76
mvaa 80 92 48
rda 76 19 16384
v_accvgpr_write_b32 a241, s76
mzvaa 84 92 52
tra 132 7 0
v_accvgpr_write_b32 a242, s76
mvaa 84 88 36
dma 15 48 80 1024
mul 184 20 184
mvaa 84 84 20
tra 134 7 512
mul 185 20 185
mvaa 84 80 4
mul 186 20 186
mzvaa 88 80 8
exp 38 38
mvaa 88 84 24
exp 39 39
mvaa 88 88 40
exp 40 40
mvaa 88 92 56
tra 136 8 0
v_accvgpr_write_b32 a243, s76
mzvaa 92 92 60
exp 41 41
mvaa 92 88 44
mul 187 20 187
cvt 184 184 185
cvt 185 186 187
mul 200 20 200
mul 201 20 201
v_pk_mul_f32 v[202:203], v[20:21], v[202:203] op_sel_hi:[0,1]
cvt 200 200 201
cvt 201 202 203
ds_write2st64_b64 v0, v[184:185], v[200:201] offset0:24 offset1:25
v_pk_mul_f32 v[188:189], v[20:21], v[188:189] op_sel:[1,0] op_sel_hi:[1,1]
v_pk_mul_f32 v[190:191], v[20:21], v[190:191] op_sel:[1,0] op_sel_hi:[1,1]
cvt 188 188 189
cvt 189 190 191
v_pk_mul_f32 v[204:205], v[20:21], v[204:205] op_sel:[1,0] op_sel_hi:[1,1]
v_pk_mul_f32 v[206:207], v[20:21], v[206:207] op_sel:[1,0] op_sel_hi:[1,1]
cvt 204 204 205
cvt 205 206 207
ds_write2st64_b64 v0, v[188:189], v[204:205] offset0:26 offset1:27
v_pk_mul_f32 v[192:193], v[22:23], v[192:193] op_sel_hi:[0,1]
v_pk_mul_f32 v[194:195], v[22:23], v[194:195] op_sel_hi:[0,1]
cvt 192 192 193
cvt 193 194 195
v_pk_mul_f32 v[208:209], v[22:23], v[208:209] op_sel_hi:[0,1]
v_pk_mul_f32 v[210:211], v[22:23], v[210:211] op_sel_hi:[0,1]
cvt 208 208 209
cvt 209 210 211
ds_write2st64_b64 v0, v[192:193], v[208:209] offset0:28 offset1:29
v_pk_mul_f32 v[196:197], v[22:23], v[196:197] op_sel:[1,0] op_sel_hi:[1,1]
v_pk_mul_f32 v[198:199], v[22:23], v[198:199] op_sel:[1,0] op_sel_hi:[1,1]
cvt 196 196 197
cvt 197 198 199
v_pk_mul_f32 v[212:213], v[22:23], v[212:213] op_sel:[1,0] op_sel_hi:[1,1]
v_pk_mul_f32 v[214:215], v[22:23], v[214:215] op_sel:[1,0] op_sel_hi:[1,1]
cvt 212 212 213
cvt 213 214 215
ds_write2st64_b64 v0, v[196:197], v[212:213] offset0:30 offset1:31
mvaa 92 84 28
tra 138 8 512
cvt 96 32 33
mvaa 92 80 12
cvt 97 34 35
cvt 100 36 37
cvt 101 38 39
exp 42 42
exp 43 43
cvt 104 40 41
cvt 105 42 43
exp 44 44
exp 45 45
exp 46 46
exp 47 47
cvt 108 44 45
cvt 109 46 47
exp 48 48
exp 49 49
exp 50 50
exp 51 51
cvt 98 48 49
cvt 99 50 51
exp 52 52
exp 53 53
exp 54 54
exp 55 55
cvt 102 52 53
cvt 103 54 55
exp 56 56
exp 57 57
exp 58 58
exp 59 59
cvt 106 56 57
cvt 107 58 59
exp 60 60
exp 61 61
exp 62 62
exp 63 63
cvt 110 60 61
cvt 111 62 63
wl 8
mzvaa 32 64 0
s_add_u32 s81, s81, 8192
s_add_u32 m0, s65, 49152
mvaa 32 68 16
dma 2 56 81 0
mvaa 32 72 32
exp 64 64
mvaa 32 76 48
tra 140 9 0
mzvav 128 128 96
exp 65 65
mzvav 132 128 100
tra 142 9 512
cvt 112 64 65
mzvav 136 128 104
exp 66 66
mzvav 140 128 108
rda 80 16 20480
wl 9
mzvaa 36 76 52
exp 67 67
mvaa 36 72 36
exp 68 68
mvaa 36 68 20
exp 69 69
mvaa 36 64 4
rda 84 17 20480
cvt 113 66 67
mzvav 156 132 108
tra 144 6 1024
cvt 116 68 69
mzvav 152 132 104
tra 146 6 1536
mzvav 148 132 100
dma 3 56 81 1024
mzvav 144 132 96
rda 88 18 20480
wl 7
mzvaa 40 64 8
exp 70 70
mvaa 40 68 24
exp 71 71
mvaa 40 72 40
exp 72 72
mvaa 40 76 56
rda 92 19 20480
cvt 117 70 71
mzvav 160 136 96
tra 148 7 1024
mzvav 164 136 100
tra 150 7 1536
mzvav 168 136 104
L_pga6:
s_cbranch_execz L_pga10
exp 73 73
mzvav 172 136 108
cvt 120 72 73
wl 8
mzvaa 44 76 60
exp 74 74
mvaa 44 72 44
exp 75 75
mvaa 44 68 28
exp 76 76
mvaa 44 64 12
tra 152 8 1024
cvt 121 74 75
mzvav 188 140 108
exp 77 77
mzvav 184 140 104
tra 154 8 1536
cvt 124 76 77
mzvav 180 140 100
exp 78 78
mzvav 176 140 96
wl 4
mzvaa 48 80 0
exp 79 79
mvaa 48 84 16
exp 80 80
mvaa 48 88 32
exp 81 81
mvaa 48 92 48
tra 156 9 1024
cvt 125 78 79
mzvav 192 144 96
exp 82 82
mzvav 196 144 100
tra 158 9 1536
cvt 114 80 81
mzvav 200 144 104
exp 83 83
mzvav 204 144 108
cvt 115 82 83
wl 4
mzvaa 52 92 52
exp 84 84
mvaa 52 88 36
exp 86 86
mvaa 52 84 20
s_waitcnt vmcnt(4)
s_barrier
mvaa 52 80 4
s_add_u32 s80, s80, 8192
s_add_u32 m0, s65, 8192
mzvav 220 148 108
rda 64 16 24576
mzvav 216 148 104
dma 14 48 80 0
mzvav 212 148 100
exp 85 85
mzvav 208 148 96
rda 68 17 24576
wl 4
mzvaa 56 80 8
tra 128 6 8192
cvt 118 84 85
mvaa 56 84 24
tra 130 6 8704
mvaa 56 88 40
exp 87 87
mvaa 56 92 56
rda 72 18 24576
cvt 119 86 87
mzvav 224 152 96
exp 88 88
mzvav 228 152 100
exp 89 89
mzvav 232 152 104
exp 90 90
mzvav 236 152 108
rda 76 19 24576
wl 6
mzvaa 60 92 60
tra 132 7 8192
cvt 122 88 89
mvaa 60 88 44
dma 15 48 80 1024
mvaa 60 84 28
tra 134 7 8704
mvaa 60 80 12
exp 91 91
mzvav 252 156 108
exp 92 92
mzvav 248 156 104
exp 93 93
mzvav 244 156 100
exp 94 94
mzvav 240 156 96
tra 136 8 8192
cvt 123 90 91
mzaav 224 240 96
exp 95 95
mzaav 228 240 100
tra 138 8 8704
cvt 126 92 93
mzaav 232 240 104
cvt 127 94 95
mzaav 236 240 108
exp 32 32
wl 4
s_mov_b32 s68, 2
.p2align 3
L_att:
mzvaa 64 64 0
s_add_u32 s81, s81, 8192
s_add_u32 m0, s65, 57344
mvaa 64 68 16
dma 2 56 81 0
mvaa 64 72 32
exp 33 33
mvaa 64 76 48
tra 140 9 8192
cvt 96 32 33
mvav 128 128 112
exp 34 34
mvav 132 128 116
tra 142 9 8704
mvav 136 128 120
exp 35 35
mvav 140 128 124
rda 80 16 28672
wl 5
mzvaa 68 76 52
exp 36 36
mvaa 68 72 36
exp 37 37
mvaa 68 68 20
exp 38 38
mvaa 68 64 4
rda 84 17 28672
s_cmp_eq_u32 s68, 0
s_cselect_b32 s82, 401408, s87
mvav 156 132 124
tra 144 6 9216
cvt 97 34 35
mvav 152 132 120
tra 146 6 9728
cvt 100 36 37
mvav 148 132 116
dma 3 56 81 1024
mvav 144 132 112
rda 88 18 28672
wl 7
mzvaa 72 64 8
exp 39 39
mvaa 72 68 24
exp 40 40
mvaa 72 72 40
exp 41 41
mvaa 72 76 56
rda 92 19 28672
cvt 101 38 39
mvav 160 136 112
tra 148 7 9216
cvt 104 40 41
mvav 164 136 116
buffer_load_dword v0, v24, s[52:55], s86 offen
s_add_u32 s86, s86, 24576
mvav 168 136 120
tra 150 7 9728
mvav 172 136 124
wl 8
mzvaa 76 76 60
exp 42 42
mvaa 76 72 44
exp 43 43
mvaa 76 68 28
exp 44 44
mvaa 76 64 12
tra 152 8 9216
cvt 105 42 43
mvav 188 140 124
exp 45 45
mvav 184 140 120
tra 154 8 9728
cvt 108 44 45
mvav 180 140 116
exp 46 46
mvav 176 140 112
wl 4
mzvaa 80 80 0
exp 47 47
mvaa 80 84 16
exp 48 48
mvaa 80 88 32
exp 49 49
mvaa 80 92 48
tra 156 9 9216
cvt 109 46 47
mvav 192 144 112
exp 50 50
mvav 196 144 116
tra 158 9 9728
cvt 98 48 49
mvav 200 144 120
exp 51 51
mvav 204 144 124
cvt 99 50 51
wl 4
mzvaa 84 92 52
exp 52 52
mvaa 84 88 36
exp 54 54
mvaa 84 84 20
s_waitcnt vmcnt(5)
s_barrier
mvaa 84 80 4
s_add_u32 s80, s80, 8192
s_add_u32 m0, s65, 16384
mvav 220 148 124
rda 64 16 0
mvav 216 148 120
dma 14 48 80 0
mvav 212 148 116
exp 53 53
mvav 208 148 112
rda 68 17 0
wl 4
mzvaa 88 80 8
tra 128 6 16384
cvt 102 52 53
mvaa 88 84 24
tra 130 6 16896
mvaa 88 88 40
exp 55 55
mvaa 88 92 56
rda 72 18 0
cvt 103 54 55
mvav 224 152 112
exp 56 56
mvav 228 152 116
exp 57 57
mvav 232 152 120
exp 58 58
mvav 236 152 124
rda 76 19 0
wl 6
mzvaa 92 92 60
tra 132 7 16384
cvt 106 56 57
mvaa 92 88 44
dma 15 48 80 1024
mvaa 92 84 28
tra 134 7 16896
mvaa 92 80 12
exp 59 59
mvav 252 156 124
exp 60 60
mvav 248 156 120
exp 61 61
mvav 244 156 116
exp 62 62
mvav 240 156 112
tra 136 8 16384
cvt 107 58 59
maav 224 240 112
exp 63 63
maav 228 240 116
tra 138 8 16896
cvt 110 60 61
maav 232 240 120
cvt 111 62 63
maav 236 240 124
wl 4
mzvaa 32 64 0
s_add_u32 s81, s81, 8192
s_add_u32 m0, s65, 32768
mvaa 32 68 16
dma 2 56 81 0
mvaa 32 72 32
exp 64 64
mvaa 32 76 48
tra 140 9 16384
mvav 128 128 96
exp 65 65
mvav 132 128 100
tra 142 9 16896
cvt 112 64 65
mvav 136 128 104
exp 66 66
mvav 140 128 108
rda 80 16 4096
wl 5
mzvaa 36 76 52
exp 67 67
mvaa 36 72 36
exp 68 68
mvaa 36 68 20
exp 69 69
mvaa 36 64 4
rda 84 17 4096
cvt 113 66 67
mvav 156 132 108
tra 144 6 17408
cvt 116 68 69
mvav 152 132 104
tra 146 6 17920
mvav 148 132 100
dma 3 56 81 1024
mvav 144 132 96
rda 88 18 4096
wl 7
mzvaa 40 64 8
exp 70 70
mvaa 40 68 24
exp 71 71
mvaa 40 72 40
exp 72 72
mvaa 40 76 56
rda 92 19 4096
cvt 117 70 71
mvav 160 136 96
tra 148 7 17408
mvav 164 136 100
buffer_load_dword v0, v24, s[52:55], s86 offen
s_add_u32 s86, s86, 24576
mvav 168 136 104
tra 150 7 17920
mvav 172 136 108
exp 73 73
wl 8
mzvaa 44 76 60
exp 74 74
mvaa 44 72 44
exp 75 75
mvaa 44 68 28
exp 76 76
mvaa 44 64 12
tra 152 8 17408
cvt 120 72 73
mvav 188 140 108
exp 77 77
mvav 184 140 104
tra 154 8 17920
cvt 121 74 75
mvav 180 140 100
exp 78 78
mvav 176 140 96
cvt 124 76 77
wl 4
mzvaa 48 80 0
exp 79 79
mvaa 48 84 16
exp 80 80
mvaa 48 88 32
exp 81 81
mvaa 48 92 48
tra 156 9 17408
cvt 125 78 79
mvav 192 144 96
exp 82 82
mvav 196 144 100
tra 158 9 17920
cvt 114 80 81
mvav 200 144 104
exp 83 83
mvav 204 144 108
cvt 115 82 83
wl 4
mzvaa 52 92 52
exp 84 84
mvaa 52 88 36
exp 86 86
mvaa 52 84 20
s_waitcnt vmcnt(6)
s_barrier
mvaa 52 80 4
s_add_u32 s80, s80, 8192
s_add_u32 m0, s65, 24576
mvav 220 148 108
rda 64 16 8192
mvav 216 148 104
dma 14 48 80 0
mvav 212 148 100
exp 85 85
mvav 208 148 96
rda 68 17 8192
wl 4
mzvaa 56 80 8
tra 128 6 24576
cvt 118 84 85
mvaa 56 84 24
tra 130 6 25088
mvaa 56 88 40
exp 87 87
mvaa 56 92 56
rda 72 18 8192
cvt 119 86 87
mvav 224 152 96
exp 88 88
mvav 228 152 100
exp 89 89
mvav 232 152 104
exp 90 90
mvav 236 152 108
rda 76 19 8192
wl 6
mzvaa 60 92 60
tra 132 7 24576
cvt 122 88 89
mvaa 60 88 44
dma 15 48 80 1024
mvaa 60 84 28
tra 134 7 25088
mvaa 60 80 12
exp 91 91
mvav 252 156 108
exp 92 92
mvav 248 156 104
exp 93 93
mvav 244 156 100
exp 94 94
mvav 240 156 96
tra 136 8 24576
cvt 123 90 91
maav 224 240 96
exp 95 95
maav 228 240 100
tra 138 8 25088
cvt 126 92 93
maav 232 240 104
cvt 127 94 95
maav 236 240 108
wl 4
mzvaa 64 64 0
s_add_u32 s81, s81, 8192
s_add_u32 m0, s65, 40960
mvaa 64 68 16
dma 2 56 81 0
mvaa 64 72 32
exp 32 32
mvaa 64 76 48
tra 140 9 24576
mvav 128 128 112
exp 33 33
mvav 132 128 116
tra 142 9 25088
cvt 96 32 33
mvav 136 128 120
exp 34 34
mvav 140 128 124
rda 80 16 12288
wl 5
mzvaa 68 76 52
exp 35 35
mvaa 68 72 36
exp 36 36
mvaa 68 68 20
exp 37 37
mvaa 68 64 4
rda 84 17 12288
cvt 97 34 35
mvav 156 132 124
tra 144 6 25600
cvt 100 36 37
mvav 152 132 120
tra 146 6 26112
mvav 148 132 116
dma 3 56 81 1024
mvav 144 132 112
rda 88 18 12288
wl 7
mzvaa 72 64 8
exp 38 38
mvaa 72 68 24
exp 39 39
mvaa 72 72 40
exp 40 40
mvaa 72 76 56
rda 92 19 12288
cvt 101 38 39
mvav 160 136 112
tra 148 7 25600
mvav 164 136 116
buffer_load_dword v0, v24, s[52:55], s86 offen
s_add_u32 s86, s86, 24576
mvav 168 136 120
tra 150 7 26112
mvav 172 136 124
exp 41 41
wl 8
mzvaa 76 76 60
exp 42 42
mvaa 76 72 44
exp 43 43
mvaa 76 68 28
exp 44 44
mvaa 76 64 12
tra 152 8 25600
cvt 104 40 41
mvav 188 140 124
exp 45 45
mvav 184 140 120
tra 154 8 26112
cvt 105 42 43
mvav 180 140 116
exp 46 46
mvav 176 140 112
cvt 108 44 45
wl 4
mzvaa 80 80 0
exp 47 47
mvaa 80 84 16
exp 48 48
mvaa 80 88 32
exp 49 49
mvaa 80 92 48
tra 156 9 25600
cvt 109 46 47
mvav 192 144 112
exp 50 50
mvav 196 144 116
tra 158 9 26112
cvt 98 48 49
mvav 200 144 120
exp 51 51
mvav 204 144 124
cvt 99 50 51
wl 4
mzvaa 84 92 52
exp 52 52
mvaa 84 88 36
exp 54 54
mvaa 84 84 20
s_waitcnt vmcnt(6)
s_barrier
mvaa 84 80 4
s_add_u32 s80, s80, s82
s_add_u32 m0, s65, 0
mvav 220 148 124
rda 64 16 16384
mvav 216 148 120
dma 14 48 80 0
mvav 212 148 116
exp 53 53
mvav 208 148 112
rda 68 17 16384
wl 4
mzvaa 88 80 8
tra 128 6 0
cvt 102 52 53
mvaa 88 84 24
tra 130 6 512
mvaa 88 88 40
exp 55 55
mvaa 88 92 56
rda 72 18 16384
cvt 103 54 55
mvav 224 152 112
exp 56 56
mvav 228 152 116
exp 57 57
mvav 232 152 120
exp 58 58
mvav 236 152 124
rda 76 19 16384
wl 6
mzvaa 92 92 60
tra 132 7 0
cvt 106 56 57
mvaa 92 88 44
dma 15 48 80 1024
mvaa 92 84 28
tra 134 7 512
mvaa 92 80 12
exp 59 59
mvav 252 156 124
exp 60 60
mvav 248 156 120
exp 61 61
mvav 244 156 116
exp 62 62
mvav 240 156 112
tra 136 8 0
cvt 107 58 59
maav 224 240 112
exp 63 63
maav 228 240 116
tra 138 8 512
cvt 110 60 61
maav 232 240 120
cvt 111 62 63
maav 236 240 124
wl 4
mzvaa 32 64 0
s_add_u32 s81, s81, 8192
L_pga7:
s_cbranch_execz L_pga11
s_add_u32 m0, s65, 49152
mvaa 32 68 16
dma 2 56 81 0
mvaa 32 72 32
exp 64 64
mvaa 32 76 48
tra 140 9 0
mvav 128 128 96
exp 65 65
mvav 132 128 100
tra 142 9 512
cvt 112 64 65
mvav 136 128 104
exp 66 66
mvav 140 128 108
rda 80 16 20480
wl 5
mzvaa 36 76 52
exp 67 67
mvaa 36 72 36
exp 68 68
mvaa 36 68 20
exp 69 69
mvaa 36 64 4
rda 84 17 20480
cvt 113 66 67
mvav 156 132 108
tra 144 6 1024
cvt 116 68 69
mvav 152 132 104
tra 146 6 1536
mvav 148 132 100
dma 3 56 81 1024
mvav 144 132 96
rda 88 18 20480
wl 7
mzvaa 40 64 8
exp 70 70
mvaa 40 68 24
exp 71 71
mvaa 40 72 40
exp 72 72
mvaa 40 76 56
rda 92 19 20480
cvt 117 70 71
mvav 160 136 96
tra 148 7 1024
mvav 164 136 100
buffer_load_dword v0, v24, s[52:55], s86 offen
s_add_u32 s86, s86, 24576
mvav 168 136 104
tra 150 7 1536
mvav 172 136 108
exp 73 73
wl 8
mzvaa 44 76 60
exp 74 74
mvaa 44 72 44
exp 75 75
mvaa 44 68 28
exp 76 76
mvaa 44 64 12
tra 152 8 1024
cvt 120 72 73
mvav 188 140 108
exp 77 77
mvav 184 140 104
tra 154 8 1536
cvt 121 74 75
mvav 180 140 100
exp 78 78
mvav 176 140 96
cvt 124 76 77
wl 4
mzvaa 48 80 0
exp 79 79
mvaa 48 84 16
exp 80 80
mvaa 48 88 32
exp 81 81
mvaa 48 92 48
tra 156 9 1024
cvt 125 78 79
mvav 192 144 96
exp 82 82
mvav 196 144 100
tra 158 9 1536
cvt 114 80 81
mvav 200 144 104
exp 83 83
mvav 204 144 108
cvt 115 82 83
wl 4
mzvaa 52 92 52
exp 84 84
mvaa 52 88 36
exp 86 86
mvaa 52 84 20
s_waitcnt vmcnt(6)
s_barrier
mvaa 52 80 4
s_add_u32 s80, s80, 8192
s_add_u32 m0, s65, 8192
mvav 220 148 108
rda 64 16 24576
mvav 216 148 104
dma 14 48 80 0
mvav 212 148 100
exp 85 85
mvav 208 148 96
rda 68 17 24576
wl 4
mzvaa 56 80 8
tra 128 6 8192
cvt 118 84 85
mvaa 56 84 24
tra 130 6 8704
mvaa 56 88 40
exp 87 87
mvaa 56 92 56
rda 72 18 24576
cvt 119 86 87
mvav 224 152 96
exp 88 88
mvav 228 152 100
exp 89 89
mvav 232 152 104
exp 90 90
mvav 236 152 108
rda 76 19 24576
wl 6
mzvaa 60 92 60
tra 132 7 8192
cvt 122 88 89
mvaa 60 88 44
dma 15 48 80 1024
mvaa 60 84 28
tra 134 7 8704
mvaa 60 80 12
exp 91 91
mvav 252 156 108
exp 92 92
mvav 248 156 104
exp 93 93
mvav 244 156 100
exp 94 94
mvav 240 156 96
tra 136 8 8192
cvt 123 90 91
maav 224 240 96
exp 95 95
maav 228 240 100
tra 138 8 8704
cvt 126 92 93
maav 232 240 104
cvt 127 94 95
maav 236 240 108
exp 32 32
wl 4
s_sub_u32 s68, s68, 1
s_cbranch_scc0 L_att
s_cmp_lg_u32 s79, 0
s_cbranch_scc1 L_att2_done
mzvaa 64 64 0
s_add_u32 s81, s81, 8192
s_add_u32 m0, s65, 57344
mvaa 64 68 16
dma 2 56 81 0
s_mov_b32 s82, 8192
mvaa 64 72 32
exp 33 33
mvaa 64 76 48
tra 140 9 8192
s_mov_b32 s77, 0x4e800000
mvav 128 128 112
exp 34 34
mvav 132 128 116
tra 142 9 8704
s_mov_b32 s84, 0x30800000
mvav 136 128 120
exp 35 35
mvav 140 128 124
rda 80 16 28672
wl 5
mzvaa 68 76 52
exp 36 36
mvaa 68 72 36
exp 37 37
mvaa 68 68 20
exp 38 38
mvaa 68 64 4
rda 84 17 28672
s_lshl_b32 s85, s64, 2
mvav 156 132 124
tra 144 6 9216
s_add_u32 s85, s85, 98240
mvav 152 132 120
tra 146 6 9728
cvt 96 32 33
mvav 148 132 116
dma 3 56 81 1024
cvt 97 34 35
mvav 144 132 112
rda 88 18 28672
wl 7
mzvaa 72 64 8
exp 39 39
mvaa 72 68 24
exp 40 40
mvaa 72 72 40
exp 41 41
mvaa 72 76 56
rda 92 19 28672
cvt 100 36 37
mvav 160 136 112
tra 148 7 9216
cvt 101 38 39
mvav 164 136 116
tra 150 7 9728
cvt 104 40 41
mvav 168 136 120
exp 42 42
mvav 172 136 124
wl 8
mzvaa 76 76 60
exp 43 43
mvaa 76 72 44
exp 44 44
mvaa 76 68 28
exp 45 45
mvaa 76 64 12
tra 152 8 9216
cvt 105 42 43
mvav 188 140 124
exp 46 46
mvav 184 140 120
tra 154 8 9728
cvt 108 44 45
mvav 180 140 116
exp 47 47
mvav 176 140 112
cvt 109 46 47
wl 4
mzvaa 80 80 0
exp 48 48
mvaa 80 84 16
exp 49 49
mvaa 80 88 32
exp 51 51
mvaa 80 92 48
rda 0 27 0
cvt 98 48 49
mvav 192 144 112
tra 156 9 9216
mvav 196 144 116
rda 16 27 4096
mvav 200 144 120
tra 158 9 9728
mvav 204 144 124
rda 32 27 8192
wl 7
mzvaa 84 92 52
rda 48 27 12288
mvaa 84 88 36
exp 50 50
mvaa 84 84 20
s_waitcnt vmcnt(5)
s_barrier
mvaa 84 80 4
rda 4 27 1024
s_add_u32 s80, s80, 8192
mvav 220 148 124
s_add_u32 m0, s65, 16384
rda 64 16 0
mvav 216 148 120
dma 14 48 80 0
mvav 212 148 116
rda 20 27 5120
cvt 99 50 51
mvav 208 148 112
rda 36 27 9216
wl 10
mzvaa 88 80 8
rda 68 17 0
exp 52 52
mvaa 88 84 24
tra 128 6 16384
exp 53 53
mvaa 88 88 40
rda 52 27 13312
exp 54 54
mvaa 88 92 56
tra 130 6 16896
cvt 102 52 53
mvav 224 152 112
rda 8 27 2048
exp 55 55
mvav 228 152 116
rda 72 18 0
cvt 103 54 55
mvav 232 152 120
rda 24 27 6144
mvav 236 152 124
rda 40 27 10240
wl 14
mzvaa 92 92 60
rda 76 19 0
exp 56 56
mvaa 92 88 44
tra 132 7 16384
exp 57 57
mvaa 92 84 28
rda 56 27 14336
cvt 106 56 57
mvaa 92 80 12
dma 15 48 80 1024
mvav 252 156 124
tra 134 7 16896
exp 58 58
mvav 248 156 120
rda 12 27 3072
exp 59 59
mvav 244 156 116
rda 28 27 7168
cvt 107 58 59
mvav 240 156 112
rda 44 27 11264
maav 224 240 112
tra 136 8 16384
exp 60 60
maav 228 240 116
rda 60 27 15360
maav 232 240 120
tra 138 8 16896
exp 61 61
maav 236 240 124
exp 62 62
exp 63 63
cvt 110 60 61
cvt 111 62 63
wl 9
mzvaa 32 64 0
s_add_u32 s81, s81, 401408
s_add_u32 m0, s65, 32768
mvaa 32 68 16
dma 2 56 81 0
mvaa 32 72 32
exp 64 64
mvaa 32 76 48
tra 140 9 16384
mvav 128 128 96
exp 65 65
mvav 132 128 100
tra 142 9 16896
cvt 112 64 65
mvav 136 128 104
exp 66 66
mvav 140 128 108
rda 80 16 4096
wl 9
mzvaa 36 76 52
exp 67 67
mvaa 36 72 36
exp 68 68
mvaa 36 68 20
exp 69 69
mvaa 36 64 4
rda 84 17 4096
cvt 113 66 67
mvav 156 132 108
tra 144 6 17408
cvt 116 68 69
mvav 152 132 104
tra 146 6 17920
mvav 148 132 100
dma 3 56 81 1024
mvav 144 132 96
rda 88 18 4096
wl 7
mzvaa 40 64 8
exp 70 70
mvaa 40 68 24
exp 71 71
mvaa 40 72 40
exp 72 72
mvaa 40 76 56
rda 92 19 4096
cvt 117 70 71
mvav 160 136 96
tra 148 7 17408
mvav 164 136 100
tra 150 7 17920
mvav 168 136 104
exp 73 73
mvav 172 136 108
cvt 120 72 73
wl 8
mzvaa 44 76 60
exp 74 74
mvaa 44 72 44
exp 75 75
mvaa 44 68 28
exp 76 76
mvaa 44 64 12
tra 152 8 17408
cvt 121 74 75
mvav 188 140 108
exp 77 77
mvav 184 140 104
tra 154 8 17920
cvt 124 76 77
mvav 180 140 100
exp 78 78
mvav 176 140 96
wl 4
mzvaa 48 80 0
exp 79 79
mvaa 48 84 16
exp 80 80
mvaa 48 88 32
exp 81 81
mvaa 48 92 48
tra 156 9 17408
cvt 125 78 79
mvav 192 144 96
exp 82 82
mvav 196 144 100
tra 158 9 17920
cvt 114 80 81
mvav 200 144 104
exp 83 83
mvav 204 144 108
cvt 115 82 83
wl 4
mzvaa 52 92 52
exp 84 84
mvaa 52 88 36
exp 85 85
mvaa 52 84 20
s_waitcnt vmcnt(4)
s_barrier
mvaa 52 80 4
s_add_u32 s80, s80, 8192
s_add_u32 m0, s65, 24576
mvav 220 148 108
dma 14 48 80 0
mvav 216 148 104
exp 86 86
mvav 212 148 100
exp 87 87
mvav 208 148 96
tra 128 6 24576
wl 3
mzvaa 56 80 8
exp 88 88
mvaa 56 84 24
tra 130 6 25088
cvt 118 84 85
mvaa 56 88 40
exp 89 89
mvaa 56 92 56
tra 132 7 24576
cvt 119 86 87
mvav 224 152 96
exp 90 90
mvav 228 152 100
tra 134 7 25088
cvt 122 88 89
mvav 232 152 104
exp 91 91
mvav 236 152 108
tra 136 8 24576
wl 5
mzvaa 60 92 60
dma 15 48 80 1024
mvaa 60 88 44
tra 138 8 25088
cvt 123 90 91
mvaa 60 84 28
exp 92 92
mvaa 60 80 12
tra 140 9 24576
mvav 252 156 108
exp 93 93
mvav 248 156 104
tra 142 9 25088
cvt 126 92 93
mvav 244 156 100
exp 94 94
mvav 240 156 96
tra 144 6 25600
maav 224 240 96
exp 95 95
maav 228 240 100
tra 146 6 26112
cvt 127 94 95
maav 232 240 104
maav 236 240 108
tra 148 7 25600
wl 9
maav 224 240 112
s_add_u32 s81, s81, 8192
s_add_u32 m0, s65, 40960
maav 228 240 116
tra 150 7 26112
maav 232 240 120
dma 2 56 81 0
maav 236 240 124
tra 152 8 25600
mvav 128 128 112
exp 32 32
mvav 132 128 116
tra 154 8 26112
mvav 136 128 120
exp 33 33
mvav 140 128 124
tra 156 9 25600
wl 9
mvav 156 132 124
exp 34 34
mvav 152 132 120
tra 158 9 26112
cvt 96 32 33
mvav 148 132 116
exp 35 35
mvav 144 132 112
rda 64 16 8192
cvt 97 34 35
mvav 160 136 112
exp 36 36
mvav 164 136 116
exp 37 37
mvav 168 136 120
dma 3 56 81 1024
v_accvgpr_read_b32 v10, a224
mvav 172 136 124
rda 68 17 8192
wl 8
mvav 188 140 124
exp 38 38
mvav 184 140 120
exp 39 39
mvav 180 140 116
exp 40 40
mvav 176 140 112
rda 72 18 8192
v_accvgpr_read_b32 v11, a228
mvav 192 144 112
exp 41 41
mvav 196 144 116
exp 42 42
mvav 200 144 120
exp 43 43
mvav 204 144 124
rda 76 19 8192
wl 6
mvav 220 148 124
exp 44 44
mvav 216 148 120
exp 45 45
mvav 212 148 116
exp 46 46
mvav 208 148 112
rda 80 16 12288
v_accvgpr_read_b32 v12, a232
mvav 224 152 112
exp 47 47
mvav 228 152 116
exp 48 48
mvav 232 152 120
exp 49 49
mvav 236 152 124
rda 84 17 12288
wl 2
mvav 252 156 124
exp 50 50
mvav 248 156 120
exp 51 51
mvav 244 156 116
exp 52 52
mvav 240 156 112
rda 88 18 12288
v_accvgpr_read_b32 v13, a236
mzvaa 64 64 0
exp 53 53
mvaa 64 68 16
exp 54 54
mvaa 64 72 32
exp 55 55
mvaa 64 76 48
rda 92 19 12288
L_pga8:
s_cbranch_execz L_pga12
mzvaa 68 76 52
exp 56 56
mvaa 68 72 36
exp 57 57
mvaa 68 68 20
s_waitcnt vmcnt(4)
s_barrier
mvaa 68 64 4
s_add_u32 s80, s80, s82
s_add_u32 m0, s65, 0
mzvaa 72 64 8
dma 14 48 80 0
v_max3_f32 v5, v10, v11, v12
mvaa 72 68 24
exp 58 58
mvaa 72 72 40
exp 59 59
mvaa 72 76 56
v_max_f32 v5, v5, v13
wl 0
mzvaa 76 76 60
exp 60 60
mvaa 76 72 44
exp 61 61
mvaa 76 68 28
exp 62 62
mvaa 76 64 12
rda 64 16 16384
v_cmp_nlt_f32 vcc, v5, s77
mzvaa 80 80 0
rda 68 17 16384
s_or_b32 s89, s89, vcc_lo
mvaa 80 84 16
rda 72 18 16384
s_or_b32 s89, s89, vcc_hi
mvaa 80 88 32
exp 63 63
mvaa 80 92 48
rda 76 19 16384
mzvaa 84 92 52
dma 15 48 80 1024
add 5 10 11
mvaa 84 88 36
add 5 5 12
add 5 5 13
mvaa 84 84 20
v_cmp_u_f32 vcc, v5, v5
s_nop 0
s_or_b32 s89, s89, vcc_lo
mvaa 84 80 4
s_or_b32 s89, s89, vcc_hi
v_min3_f32 v5, v10, v11, v12
mzvaa 88 80 8
rcp 10 10
mvaa 88 84 24
rcp 11 11
mvaa 88 88 40
rcp 12 12
mvaa 88 92 56
v_min_f32 v5, v5, v13
mzvaa 92 92 60
rcp 13 13
mvaa 92 88 44
cvt 100 36 37
v_cmp_ngt_f32 vcc, v5, s84
mvaa 92 84 28
s_or_b32 s89, s89, vcc_lo
s_or_b32 s89, s89, vcc_hi
mvaa 92 80 12
cvt 101 38 39
cvt 104 40 41
cvt 105 42 43
cvt 108 44 45
cvt 109 46 47
cvt 98 48 49
cvt 99 50 51
cvt 102 52 53
cvt 103 54 55
cvt 106 56 57
cvt 107 58 59
cvt 110 60 61
cvt 111 62 63
wl 0
mzvaa 32 64 0
rda 80 16 20480
s_add_u32 s81, s81, 8192
mvaa 32 68 16
rda 84 17 20480
s_add_u32 m0, s65, 49152
mvaa 32 72 32
rda 88 18 20480
mul 128 10 128
mvaa 32 76 48
dma 2 56 81 0
mul 129 10 129
mzvaa 36 76 52
rda 92 19 20480
mul 130 10 130
mvaa 36 72 36
exp 64 64
mvaa 36 68 20
exp 65 65
mvaa 36 64 4
tra 128 6 0
mzvaa 40 64 8
exp 66 66
mvaa 40 68 24
tra 130 6 512
mul 131 10 131
mvaa 40 72 40
exp 67 67
mvaa 40 76 56
tra 132 7 0
mul 144 10 144
mzvaa 44 76 60
exp 68 68
mvaa 44 72 44
tra 134 7 512
mul 145 10 145
mvaa 44 68 28
dma 3 56 81 1024
mul 146 10 146
mvaa 44 64 12
tra 136 8 0
wl 5
mzvaa 48 80 0
exp 69 69
mvaa 48 84 16
tra 138 8 512
mul 147 10 147
mvaa 48 88 32
exp 70 70
mvaa 48 92 48
tra 140 9 0
cvt 128 128 129
mzvaa 52 92 52
exp 71 71
mvaa 52 88 36
tra 142 9 512
cvt 129 130 131
mvaa 52 84 20
exp 72 72
mvaa 52 80 4
tra 144 6 1024
mzvaa 56 80 8
exp 73 73
mvaa 56 84 24
tra 146 6 1536
cvt 130 144 145
mvaa 56 88 40
exp 74 74
mvaa 56 92 56
tra 148 7 1024
cvt 131 146 147
mzvaa 60 92 60
ds_write_b128 v27, v[128:131] offset:0
mvaa 60 88 44
tra 150 7 1536
mul 132 11 132
mvaa 60 84 28
exp 75 75
mvaa 60 80 12
mul 133 11 133
mul 134 11 134
mul 135 11 135
mul 148 11 148
mul 149 11 149
v_pk_mul_f32 v[150:151], v[10:11], v[150:151] op_sel:[1,0] op_sel_hi:[1,1]
cvt 132 132 133
cvt 133 134 135
cvt 134 148 149
cvt 135 150 151
ds_write_b128 v27, v[132:135] offset:1024
v_pk_mul_f32 v[136:137], v[12:13], v[136:137] op_sel_hi:[0,1]
v_pk_mul_f32 v[138:139], v[12:13], v[138:139] op_sel_hi:[0,1]
v_pk_mul_f32 v[152:153], v[12:13], v[152:153] op_sel_hi:[0,1]
v_pk_mul_f32 v[154:155], v[12:13], v[154:155] op_sel_hi:[0,1]
cvt 136 136 137
cvt 137 138 139
cvt 138 152 153
cvt 139 154 155
ds_write_b128 v27, v[136:139] offset:2048
v_pk_mul_f32 v[140:141], v[12:13], v[140:141] op_sel:[1,0] op_sel_hi:[1,1]
v_pk_mul_f32 v[142:143], v[12:13], v[142:143] op_sel:[1,0] op_sel_hi:[1,1]
v_pk_mul_f32 v[156:157], v[12:13], v[156:157] op_sel:[1,0] op_sel_hi:[1,1]
v_pk_mul_f32 v[158:159], v[12:13], v[158:159] op_sel:[1,0] op_sel_hi:[1,1]
cvt 140 140 141
cvt 141 142 143
cvt 142 156 157
cvt 143 158 159
ds_write_b128 v27, v[140:143] offset:3072
wl 12
mzvav 128 128 96
tra 152 8 1024
mul 160 10 160
mzvav 132 128 100
tra 154 8 1536
mul 161 10 161
mzvav 136 128 104
exp 76 76
mzvav 140 128 108
tra 156 9 1024
mul 162 10 162
mzvav 156 132 108
exp 77 77
mzvav 152 132 104
tra 158 9 1536
mul 163 10 163
mzvav 148 132 100
exp 78 78
mzvav 144 132 96
mul 176 10 176
mul 177 10 177
mul 178 10 178
mul 179 10 179
cvt 160 160 161
cvt 161 162 163
cvt 162 176 177
cvt 163 178 179
ds_write_b128 v27, v[160:163] offset:4096
v_pk_mul_f32 v[164:165], v[10:11], v[164:165] op_sel:[1,0] op_sel_hi:[1,1]
v_pk_mul_f32 v[166:167], v[10:11], v[166:167] op_sel:[1,0] op_sel_hi:[1,1]
v_pk_mul_f32 v[180:181], v[10:11], v[180:181] op_sel:[1,0] op_sel_hi:[1,1]
v_pk_mul_f32 v[182:183], v[10:11], v[182:183] op_sel:[1,0] op_sel_hi:[1,1]
cvt 164 164 165
cvt 165 166 167
cvt 166 180 181
cvt 167 182 183
ds_write_b128 v27, v[164:167] offset:5120
v_pk_mul_f32 v[168:169], v[12:13], v[168:169] op_sel_hi:[0,1]
v_pk_mul_f32 v[170:171], v[12:13], v[170:171] op_sel_hi:[0,1]
v_pk_mul_f32 v[184:185], v[12:13], v[184:185] op_sel_hi:[0,1]
v_pk_mul_f32 v[186:187], v[12:13], v[186:187] op_sel_hi:[0,1]
cvt 168 168 169
cvt 169 170 171
cvt 170 184 185
cvt 171 186 187
ds_write_b128 v27, v[168:171] offset:6144
v_pk_mul_f32 v[172:173], v[12:13], v[172:173] op_sel:[1,0] op_sel_hi:[1,1]
v_pk_mul_f32 v[174:175], v[12:13], v[174:175] op_sel:[1,0] op_sel_hi:[1,1]
v_pk_mul_f32 v[188:189], v[12:13], v[188:189] op_sel:[1,0] op_sel_hi:[1,1]
v_pk_mul_f32 v[190:191], v[12:13], v[190:191] op_sel:[1,0] op_sel_hi:[1,1]
cvt 172 172 173
cvt 173 174 175
cvt 174 188 189
cvt 175 190 191
ds_write_b128 v27, v[172:175] offset:7168
wl 15
mzvav 160 136 96
exp 79 79
mzvav 164 136 100
exp 80 80
mzvav 168 136 104
s_waitcnt vmcnt(4)
s_barrier
mzvav 172 136 108
s_add_u32 s80, s80, 8192
s_add_u32 m0, s65, 8192
mzvav 188 140 108
rda 64 16 24576
cvt 112 64 65
mzvav 184 140 104
dma 14 48 80 0
mul 192 10 192
mzvav 180 140 100
exp 81 81
mzvav 176 140 96
mul 193 10 193
mul 194 10 194
mul 195 10 195
mul 208 10 208
mul 209 10 209
v_pk_mul_f32 v[210:211], v[10:11], v[210:211] op_sel_hi:[0,1]
cvt 192 192 193
cvt 193 194 195
cvt 194 208 209
cvt 195 210 211
ds_write_b128 v27, v[192:195] offset:8192
v_pk_mul_f32 v[196:197], v[10:11], v[196:197] op_sel:[1,0] op_sel_hi:[1,1]
v_pk_mul_f32 v[198:199], v[10:11], v[198:199] op_sel:[1,0] op_sel_hi:[1,1]
v_pk_mul_f32 v[212:213], v[10:11], v[212:213] op_sel:[1,0] op_sel_hi:[1,1]
v_pk_mul_f32 v[214:215], v[10:11], v[214:215] op_sel:[1,0] op_sel_hi:[1,1]
cvt 196 196 197
cvt 197 198 199
cvt 198 212 213
cvt 199 214 215
ds_write_b128 v27, v[196:199] offset:9216
v_pk_mul_f32 v[200:201], v[12:13], v[200:201] op_sel_hi:[0,1]
v_pk_mul_f32 v[202:203], v[12:13], v[202:203] op_sel_hi:[0,1]
v_pk_mul_f32 v[216:217], v[12:13], v[216:217] op_sel_hi:[0,1]
v_pk_mul_f32 v[218:219], v[12:13], v[218:219] op_sel_hi:[0,1]
cvt 200 200 201
cvt 201 202 203
cvt 202 216 217
cvt 203 218 219
ds_write_b128 v27, v[200:203] offset:10240
v_pk_mul_f32 v[204:205], v[12:13], v[204:205] op_sel:[1,0] op_sel_hi:[1,1]
v_pk_mul_f32 v[206:207], v[12:13], v[206:207] op_sel:[1,0] op_sel_hi:[1,1]
v_pk_mul_f32 v[220:221], v[12:13], v[220:221] op_sel:[1,0] op_sel_hi:[1,1]
v_pk_mul_f32 v[222:223], v[12:13], v[222:223] op_sel:[1,0] op_sel_hi:[1,1]
cvt 204 204 205
cvt 205 206 207
cvt 206 220 221
cvt 207 222 223
ds_write_b128 v27, v[204:207] offset:11264
wl 15
mzvav 192 144 96
rda 68 17 24576
cvt 113 66 67
mzvav 196 144 100
tra 128 6 8192
cvt 116 68 69
mzvav 200 144 104
tra 130 6 8704
cvt 117 70 71
mzvav 204 144 108
rda 72 18 24576
cvt 120 72 73
mzvav 220 148 108
exp 82 82
mzvav 216 148 104
exp 83 83
mzvav 212 148 100
exp 84 84
mzvav 208 148 96
mul 224 10 224
mul 225 10 225
mul 226 10 226
mul 227 10 227
v_pk_mul_f32 v[240:241], v[10:11], v[240:241] op_sel_hi:[0,1]
v_pk_mul_f32 v[242:243], v[10:11], v[242:243] op_sel_hi:[0,1]
cvt 224 224 225
cvt 225 226 227
cvt 226 240 241
cvt 227 242 243
ds_write_b128 v27, v[224:227] offset:12288
v_pk_mul_f32 v[228:229], v[10:11], v[228:229] op_sel:[1,0] op_sel_hi:[1,1]
v_pk_mul_f32 v[230:231], v[10:11], v[230:231] op_sel:[1,0] op_sel_hi:[1,1]
v_pk_mul_f32 v[244:245], v[10:11], v[244:245] op_sel:[1,0] op_sel_hi:[1,1]
v_pk_mul_f32 v[246:247], v[10:11], v[246:247] op_sel:[1,0] op_sel_hi:[1,1]
cvt 228 228 229
cvt 229 230 231
cvt 230 244 245
cvt 231 246 247
ds_write_b128 v27, v[228:231] offset:13312
v_pk_mul_f32 v[232:233], v[12:13], v[232:233] op_sel_hi:[0,1]
v_pk_mul_f32 v[234:235], v[12:13], v[234:235] op_sel_hi:[0,1]
v_pk_mul_f32 v[248:249], v[12:13], v[248:249] op_sel_hi:[0,1]
v_pk_mul_f32 v[250:251], v[12:13], v[250:251] op_sel_hi:[0,1]
cvt 232 232 233
cvt 233 234 235
cvt 234 248 249
cvt 235 250 251
ds_write_b128 v27, v[232:235] offset:14336
v_pk_mul_f32 v[236:237], v[12:13], v[236:237] op_sel:[1,0] op_sel_hi:[1,1]
v_pk_mul_f32 v[238:239], v[12:13], v[238:239] op_sel:[1,0] op_sel_hi:[1,1]
v_pk_mul_f32 v[252:253], v[12:13], v[252:253] op_sel:[1,0] op_sel_hi:[1,1]
v_pk_mul_f32 v[254:255], v[12:13], v[254:255] op_sel:[1,0] op_sel_hi:[1,1]
cvt 236 236 237
cvt 237 238 239
cvt 238 252 253
cvt 239 254 255
ds_write_b128 v27, v[236:239] offset:15360
wl 15
mzvav 224 152 96
rda 76 19 24576
cvt 121 74 75
mzvav 228 152 100
tra 132 7 8192
cvt 124 76 77
mzvav 232 152 104
dma 15 48 80 1024
cvt 125 78 79
mzvav 236 152 108
tra 134 7 8704
cvt 114 80 81
mzvav 252 156 108
exp 85 85
mzvav 248 156 104
exp 86 86
mzvav 244 156 100
exp 87 87
mzvav 240 156 96
tra 136 8 8192
cvt 115 82 83
mzaav 224 240 96
exp 88 88
mzaav 228 240 100
tra 138 8 8704
cvt 118 84 85
mzaav 232 240 104
exp 89 89
mzaav 236 240 108
cvt 119 86 87
exp 90 90
exp 91 91
cvt 122 88 89
cvt 123 90 91
exp 92 92
exp 93 93
exp 94 94
exp 95 95
cvt 126 92 93
cvt 127 94 95
v_mov_b32 v10, v4
exp 32 32
wl 4
s_mov_b32 s68, 2
.p2align 3
s_mov_b32 s79, 1
s_branch L_att
L_att2_done:
mzvaa 64 64 0
L_alate:
s_add_u32 s81, s81, 8192
s_add_u32 m0, s65, 57344
mvaa 64 68 16
dma 2 56 81 0
mvaa 64 72 32
exp 33 33
mvaa 64 76 48
tra 140 9 8192
v_xor_b32 v11, 32, v10
mvav 128 128 112
exp 34 34
mvav 132 128 116
tra 142 9 8704
v_add_u32 v12, 0x10000, v10
mvav 136 128 120
exp 35 35
mvav 140 128 124
rda 80 16 28672
wl 5
mzvaa 68 76 52
exp 36 36
mvaa 68 72 36
exp 37 37
mvaa 68 68 20
exp 38 38
mvaa 68 64 4
rda 84 17 28672
v_add_u32 v13, 0x10000, v11
mvav 156 132 124
tra 144 6 9216
cvt 96 32 33
mvav 152 132 120
tra 146 6 9728
cvt 97 34 35
mvav 148 132 116
dma 3 56 81 1024
mvav 144 132 112
rda 88 18 28672
wl 7
mzvaa 72 64 8
exp 39 39
mvaa 72 68 24
exp 40 40
mvaa 72 72 40
exp 41 41
mvaa 72 76 56
rda 92 19 28672
cvt 100 36 37
mvav 160 136 112
tra 148 7 9216
cvt 101 38 39
mvav 164 136 116
tra 150 7 9728
cvt 104 40 41
mvav 168 136 120
exp 42 42
mvav 172 136 124
wl 8
mzvaa 76 76 60
exp 43 43
mvaa 76 72 44
exp 44 44
mvaa 76 68 28
exp 45 45
mvaa 76 64 12
tra 152 8 9216
cvt 105 42 43
mvav 188 140 124
exp 46 46
mvav 184 140 120
tra 154 8 9728
cvt 108 44 45
mvav 180 140 116
exp 47 47
mvav 176 140 112
cvt 109 46 47
wl 4
mzvaa 80 80 0
exp 48 48
mvaa 80 84 16
exp 49 49
mvaa 80 88 32
exp 50 50
mvaa 80 92 48
tra 156 9 9216
cvt 98 48 49
mvav 192 144 112
exp 51 51
mvav 196 144 116
tra 158 9 9728
mvav 200 144 120
exp 52 52
mvav 204 144 124
cvt 99 50 51
wl 4
mzvaa 84 92 52
exp 54 54
mvaa 84 88 36
exp 53 53
mvaa 84 84 20
s_waitcnt vmcnt(5)
s_barrier
mvaa 84 80 4
s_mov_b32 s66, 0
s_add_u32 m0, s65, 65536
mvav 220 148 124
tra 128 6 16384
cvt 102 52 53
mvav 216 148 120
dma 30 52 66 0
mvav 212 148 116
tra 130 6 16896
mvav 208 148 112
tra 132 7 16384
wl 5
mzvaa 88 80 8
dma 31 52 66 1024
mvaa 88 84 24
tra 134 7 16896
mvaa 88 88 40
s_mov_b32 s66, 73728
s_add_u32 m0, s65, 73728
mvaa 88 92 56
tra 136 8 16384
exp 55 55
mvav 224 152 112
dma 30 52 66 0
mvav 228 152 116
tra 138 8 16896
cvt 103 54 55
mvav 232 152 120
exp 56 56
mvav 236 152 124
tra 140 9 16384
wl 7
mzvaa 92 92 60
dma 31 52 66 1024
mvaa 92 88 44
tra 142 9 16896
exp 57 57
mvaa 92 84 28
s_mov_b32 s66, 147456
s_add_u32 m0, s65, 81920
mvaa 92 80 12
tra 144 6 17408
exp 58 58
mvav 252 156 124
dma 30 52 66 0
cvt 106 56 57
mvav 248 156 120
tra 146 6 17920
exp 59 59
mvav 244 156 116
exp 60 60
mvav 240 156 112
tra 148 7 17408
cvt 107 58 59
maav 224 240 112
dma 31 52 66 1024
maav 228 240 116
tra 150 7 17920
exp 61 61
maav 232 240 120
exp 62 62
exp 63 63
cvt 110 60 61
cvt 111 62 63
maav 236 240 124
s_mov_b32 s66, 221184
wl 8
mvav 128 128 96
s_add_u32 m0, s65, 16384
tra 152 8 17408
mvav 132 128 100
dma 30 52 66 0
mvav 136 128 104
L_pga9:
s_cbranch_execz L_pga_back
tra 154 8 17920
mvav 140 128 108
rda 0 28 0
mvav 156 132 108
dma 31 52 66 1024
mvav 152 132 104
tra 156 9 17408
exp 64 64
mvav 148 132 100
rda 4 28 1024
exp 65 65
mvav 144 132 96
tra 158 9 17920
wl 10
mvav 160 136 96
rda 8 28 2048
exp 66 66
mvav 164 136 100
rda 12 28 3072
exp 67 67
mvav 168 136 104
rda 16 28 4096
cvt 112 64 65
mvav 172 136 108
rda 20 28 5120
cvt 113 66 67
mvav 188 140 108
exp 68 68
mvav 184 140 104
rda 24 28 6144
exp 69 69
mvav 180 140 100
exp 70 70
mvav 176 140 96
rda 28 28 7168
wl 12
mvav 192 144 96
s_waitcnt vmcnt(8)
s_barrier
mvav 196 144 100
tra 128 6 24576
s_mov_b32 s66, 128
mvav 200 144 104
s_add_u32 m0, s65, 32768
tra 130 6 25088
mvav 204 144 108
dma 30 52 66 0
cvt 116 68 69
mvav 220 148 108
rda 32 28 8192
exp 71 71
mvav 216 148 104
tra 132 7 24576
cvt 117 70 71
mvav 212 148 100
rda 36 28 9216
exp 72 72
mvav 208 148 96
tra 134 7 25088
wl 12
mvav 224 152 96
dma 31 52 66 1024
mvav 228 152 100
rda 40 28 10240
s_mov_b32 s66, 73856
mvav 232 152 104
tra 136 8 24576
s_add_u32 m0, s65, 24576
mvav 236 152 108
rda 44 28 11264
exp 73 73
mvav 252 156 108
tra 138 8 25088
exp 74 74
mvav 248 156 104
rda 48 28 12288
exp 75 75
mvav 244 156 100
dma 30 52 66 0
cvt 120 72 73
mvav 240 156 96
tra 140 9 24576
cvt 121 74 75
maav 224 240 96
rda 52 28 13312
exp 76 76
maav 228 240 100
tra 142 9 25088
exp 77 77
maav 232 240 104
exp 78 78
exp 79 79
cvt 124 76 77
cvt 125 78 79
exp 80 80
exp 81 81
exp 82 82
exp 83 83
cvt 114 80 81
cvt 115 82 83
exp 84 84
exp 85 85
exp 86 86
exp 87 87
cvt 118 84 85
cvt 119 86 87
exp 88 88
exp 89 89
exp 90 90
exp 91 91
cvt 122 88 89
cvt 123 90 91
exp 92 92
exp 93 93
exp 94 94
exp 95 95
cvt 126 92 93
cvt 127 94 95
maav 236 240 108
rda 56 28 14336
wl 13
maav 224 240 112
dma 31 52 66 1024
s_mov_b32 s66, 147584
maav 228 240 116
tra 144 6 25600
s_add_u32 m0, s65, 40960
maav 232 240 120
rda 60 28 15360
maav 236 240 124
tra 146 6 26112
mvav 128 128 112
rda 64 28 32768
mvav 132 128 116
tra 148 7 25600
mvav 136 128 120
rda 68 28 33792
mvav 140 128 124
dma 30 52 66 0
wl 11
mvav 156 132 124
tra 150 7 26112
rda 72 28 34816
mvav 152 132 120
tra 152 8 25600
v_accvgpr_read_b32 v16, a224
mvav 148 132 116
rda 76 28 35840
v_accvgpr_read_b32 v17, a228
mvav 144 132 112
dma 31 52 66 1024
mvav 160 136 112
tra 154 8 26112
rda 80 28 36864
mvav 164 136 116
tra 156 9 25600
v_accvgpr_read_b32 v18, a232
mvav 168 136 120
rda 84 28 37888
v_accvgpr_read_b32 v19, a236
mvav 172 136 124
tra 158 9 26112
wl 12
mvav 188 140 124
rda 88 28 38912
v_max3_f32 v5, v16, v17, v18
mvav 184 140 120
s_waitcnt vmcnt(10)
s_barrier
mvav 180 140 116
rda 92 28 39936
s_mov_b32 s66, 221312
mvav 176 140 112
rda 96 28 40960
s_add_u32 m0, s65, 0
mvav 192 144 112
rda 100 28 41984
v_max_f32 v5, v5, v19
mvav 196 144 116
rda 104 28 43008
v_cmp_nlt_f32 vcc, v5, s77
mvav 200 144 120
trv 32 12 0
s_or_b32 s89, s89, vcc_lo
mvav 204 144 124
dma 30 52 66 0
wl 10
mvav 220 148 124
rda 108 28 44032
s_or_b32 s89, s89, vcc_hi
mvav 216 148 120
trv 34 12 512
add 5 16 17
mvav 212 148 116
rda 112 28 45056
add 5 5 18
mvav 208 148 112
trv 36 12 1024
add 5 5 19
mvav 224 152 112
dma 31 52 66 1024
s_mov_b32 s66, 294912
mvav 228 152 116
rda 116 28 46080
s_add_u32 m0, s65, 8192
mvav 232 152 120
trv 38 12 1536
v_cmp_u_f32 vcc, v5, v5
mvav 236 152 124
rda 120 28 47104
wl 13
mvav 252 156 124
trv 40 13 0
s_or_b32 s89, s89, vcc_lo
mvav 248 156 120
dma 30 52 66 0
s_or_b32 s89, s89, vcc_hi
mvav 244 156 116
rda 124 28 48128
v_min3_f32 v5, v16, v17, v18
mvav 240 156 112
trv 42 13 512
wl 4
mzvva 64 32 0
trv 44 13 1024
v_min_f32 v5, v5, v19
mvva 64 36 16
dma 31 52 66 1024
s_mov_b32 s66, 368640
mzvva 68 36 20
trv 46 13 1536
s_add_u32 m0, s65, 49152
mvva 68 32 4
trv 48 13 8192
v_cmp_ngt_f32 vcc, v5, s84
mzvva 72 32 8
dma 30 52 66 0
s_or_b32 s89, s89, vcc_lo
mvva 72 36 24
trv 50 13 8704
s_or_b32 s89, s89, vcc_hi
mzvva 76 36 28
trv 52 13 9216
rcp 16 16
mvva 76 32 12
dma 31 52 66 1024
wl 3
mzvva 92 40 12
trv 54 13 9728
rcp 17 17
mvva 92 44 28
trv 56 12 8192
rcp 18 18
mzvva 88 44 24
trv 58 12 8704
rcp 19 19
mvva 88 40 8
trv 60 12 9216
mul 128 16 128
mzvva 84 40 4
trv 62 12 9728
mul 129 16 129
mvva 84 44 20
s_waitcnt vmcnt(12)
s_barrier
mzvva 80 44 16
s_mov_b32 s66, 442368
s_add_u32 m0, s65, 57344
mvva 80 40 0
trv 32 12 16384
wl 5
mvva 80 48 32
dma 30 52 66 0
mul 130 16 130
mvva 80 52 48
trv 34 12 16896
mul 131 16 131
mvva 84 52 52
trv 36 12 17408
mul 144 16 144
mvva 84 48 36
mul 145 16 145
mul 146 16 146
mvva 88 48 40
trv 38 12 17920
mul 147 16 147
mvva 88 52 56
cvt 128 128 129
cvt 129 130 131
mvva 92 52 60
trv 40 13 16384
cvt 130 144 145
mvva 92 48 44
cvt 131 146 147
wl 5
mvva 76 56 44
ds_write_b128 v27, v[128:131] offset:0
mvva 76 60 60
trv 42 13 16896
mul 132 17 132
mvva 72 60 56
trv 44 13 17408
mul 133 17 133
mvva 72 56 40
dma 31 52 66 1024
mul 134 17 134
mvva 68 56 36
trv 46 13 17920
mul 135 17 135
mvva 68 60 52
mul 148 17 148
mul 149 17 149
mvva 64 60 48
trv 48 11 16384
mul 150 17 150
mvva 64 56 32
mul 151 17 151
wl 6
mvva 64 32 64
trv 50 11 16896
cvt 132 132 133
mvva 64 36 80
cvt 133 134 135
cvt 134 148 149
mvva 68 36 84
trv 52 11 17408
cvt 135 150 151
mvva 68 32 68
ds_write_b128 v27, v[132:135] offset:1024
mvva 72 32 72
trv 54 11 17920
mul 136 18 136
mvva 72 36 88
mul 137 18 137
mul 138 18 138
mvva 76 36 92
trv 56 10 16384
mul 139 18 139
mvva 76 32 76
mul 152 18 152
wl 6
mvva 92 40 76
trv 58 10 16896
mul 153 18 153
mvva 92 44 92
mul 154 18 154
mul 155 18 155
mvva 88 44 88
trv 60 10 17408
cvt 136 136 137
mvva 88 40 72
cvt 137 138 139
cvt 138 152 153
mvva 84 40 68
trv 62 10 17920
cvt 139 154 155
mvva 84 44 84
s_waitcnt vmcnt(10)
s_barrier
mvva 80 44 80
ds_write_b128 v27, v[136:139] offset:2048
mvva 80 40 64
s_mov_b32 s66, 516096
wl 5
mvva 80 48 96
s_add_u32 m0, s65, 65536
trv 32 10 32768
mvva 80 52 112
dma 30 52 66 0
mul 140 19 140
mvva 84 52 116
trv 34 10 33280
mul 141 19 141
mvva 84 48 100
trv 36 10 33792
mul 142 19 142
mvva 88 48 104
trv 38 10 34304
mul 143 19 143
mvva 88 52 120
dma 31 52 66 1024
mul 156 19 156
mvva 92 52 124
trv 40 11 32768
mul 157 19 157
mvva 92 48 108
mul 158 19 158
wl 6
mvva 76 56 108
trv 42 11 33280
mul 159 19 159
mvva 76 60 124
s_mov_b32 s66, 295040
s_add_u32 m0, s65, 73728
mvva 72 60 120
trv 44 11 33792
cvt 140 140 141
mvva 72 56 104
dma 30 52 66 0
cvt 141 142 143
mvva 68 56 100
trv 46 11 34304
cvt 142 156 157
mvva 68 60 116
cvt 143 158 159
mul 160 16 160
mvva 64 60 112
ds_write_b128 v27, v[140:143] offset:3072
mvva 64 56 96
trv 48 11 24576
wl 6
mzvva 96 32 0
trv 50 11 25088
mul 161 16 161
mvva 96 36 16
dma 31 52 66 1024
mul 162 16 162
mzvva 100 36 20
trv 52 11 25600
mul 163 16 163
mvva 100 32 4
mul 176 16 176
mul 177 16 177
mzvva 104 32 8
trv 54 11 26112
mul 178 16 178
mvva 104 36 24
mul 179 16 179
cvt 160 160 161
mzvva 108 36 28
trv 56 10 24576
cvt 161 162 163
mvva 108 32 12
cvt 162 176 177
wl 6
mzvva 124 40 12
trv 58 10 25088
cvt 163 178 179
mvva 124 44 28
ds_write_b128 v27, v[160:163] offset:4096
mzvva 120 44 24
trv 60 10 25600
mul 164 17 164
mvva 120 40 8
mul 165 17 165
mul 166 17 166
mzvva 116 40 4
trv 62 10 26112
mul 167 17 167
mvva 116 44 20
s_waitcnt vmcnt(10)
s_barrier
mzvva 112 44 16
s_mov_b32 s66, 368768
s_add_u32 m0, s65, 81920
mvva 112 40 0
trv 32 10 40960
wl 6
mvva 112 48 32
dma 30 52 66 0
mul 180 17 180
mvva 112 52 48
trv 34 10 41472
mul 181 17 181
mvva 116 52 52
trv 36 10 41984
mul 182 17 182
mvva 116 48 36
mul 183 17 183
cvt 164 164 165
mvva 120 48 40
trv 38 10 42496
cvt 165 166 167
mvva 120 52 56
dma 31 52 66 1024
cvt 166 180 181
mvva 124 52 60
trv 40 11 40960
cvt 167 182 183
mvva 124 48 44
mul 168 18 168
wl 5
mvva 108 56 44
ds_write_b128 v27, v[164:167] offset:5120
mvva 108 60 60
trv 42 11 41472
s_mov_b32 s66, 442496
mvva 104 60 56
s_add_u32 m0, s65, 16384
trv 44 11 41984
mvva 104 56 40
dma 30 52 66 0
mul 169 18 169
mvva 100 56 36
trv 46 11 42496
mul 170 18 170
mvva 100 60 52
mul 171 18 171
mul 184 18 184
mvva 96 60 48
trv 48 11 0
mul 185 18 185
mvva 96 56 32
mul 186 18 186
wl 6
mvva 96 32 64
trv 50 11 512
mul 187 18 187
mvva 96 36 80
dma 31 52 66 1024
cvt 168 168 169
mvva 100 36 84
trv 52 11 1024
cvt 169 170 171
mvva 100 32 68
cvt 170 184 185
cvt 171 186 187
mvva 104 32 72
ds_write_b128 v27, v[168:171] offset:6144
mvva 104 36 88
trv 54 11 1536
mul 172 19 172
mvva 108 36 92
trv 56 10 0
mul 173 19 173
mvva 108 32 76
mul 174 19 174
wl 6
mvva 124 40 76
trv 58 10 512
mul 175 19 175
mvva 124 44 92
mul 188 19 188
mul 189 19 189
mvva 120 44 88
trv 60 10 1024
mul 190 19 190
mvva 120 40 72
mul 191 19 191
cvt 172 172 173
mvva 116 40 68
trv 62 10 1536
cvt 173 174 175
mvva 116 44 84
s_waitcnt vmcnt(10)
s_barrier
mvva 112 44 80
s_mov_b32 s66, 516224
s_add_u32 m0, s65, 32768
mvva 112 40 64
dma 30 52 66 0
wl 4
mvva 112 48 96
trv 32 10 8192
cvt 174 188 189
mvva 112 52 112
dma 31 52 66 1024
s_sub_u32 s66, s66, 515968
mvva 116 52 116
s_add_u32 m0, s65, 24576
trv 34 10 8704
mvva 116 48 100
dma 30 52 66 0
cvt 175 190 191
mvva 120 48 104
ds_write_b128 v27, v[172:175] offset:7168
mvva 120 52 120
dma 31 52 66 1024
mul 192 16 192
mul 193 16 193
v_pk_mul_f32 v[194:195], v[16:17], v[194:195] op_sel_hi:[0,1]
v_pk_mul_f32 v[208:209], v[16:17], v[208:209] op_sel_hi:[0,1]
v_pk_mul_f32 v[210:211], v[16:17], v[210:211] op_sel_hi:[0,1]
cvt 192 192 193
cvt 193 194 195
cvt 194 208 209
cvt 195 210 211
ds_write_b128 v27, v[192:195] offset:8192
v_pk_mul_f32 v[196:197], v[16:17], v[196:197] op_sel:[1,0] op_sel_hi:[1,1]
v_pk_mul_f32 v[198:199], v[16:17], v[198:199] op_sel:[1,0] op_sel_hi:[1,1]
v_pk_mul_f32 v[212:213], v[16:17], v[212:213] op_sel:[1,0] op_sel_hi:[1,1]
v_pk_mul_f32 v[214:215], v[16:17], v[214:215] op_sel:[1,0] op_sel_hi:[1,1]
cvt 196 196 197
cvt 197 198 199
cvt 198 212 213
cvt 199 214 215
L_pga10:
s_cbranch_execz L_pga_back
ds_write_b128 v27, v[196:199] offset:9216
v_pk_mul_f32 v[200:201], v[18:19], v[200:201] op_sel_hi:[0,1]
v_pk_mul_f32 v[202:203], v[18:19], v[202:203] op_sel_hi:[0,1]
v_pk_mul_f32 v[216:217], v[18:19], v[216:217] op_sel_hi:[0,1]
v_pk_mul_f32 v[218:219], v[18:19], v[218:219] op_sel_hi:[0,1]
cvt 200 200 201
cvt 201 202 203
cvt 202 216 217
cvt 203 218 219
ds_write_b128 v27, v[200:203] offset:10240
v_pk_mul_f32 v[204:205], v[18:19], v[204:205] op_sel:[1,0] op_sel_hi:[1,1]
v_pk_mul_f32 v[206:207], v[18:19], v[206:207] op_sel:[1,0] op_sel_hi:[1,1]
v_pk_mul_f32 v[220:221], v[18:19], v[220:221] op_sel:[1,0] op_sel_hi:[1,1]
v_pk_mul_f32 v[222:223], v[18:19], v[222:223] op_sel:[1,0] op_sel_hi:[1,1]
cvt 204 204 205
cvt 205 206 207
cvt 206 220 221
cvt 207 222 223
ds_write_b128 v27, v[204:207] offset:11264
v_pk_mul_f32 v[224:225], v[16:17], v[224:225] op_sel_hi:[0,1]
v_pk_mul_f32 v[226:227], v[16:17], v[226:227] op_sel_hi:[0,1]
v_pk_mul_f32 v[240:241], v[16:17], v[240:241] op_sel_hi:[0,1]
v_pk_mul_f32 v[242:243], v[16:17], v[242:243] op_sel_hi:[0,1]
cvt 224 224 225
cvt 225 226 227
cvt 226 240 241
cvt 227 242 243
ds_write_b128 v27, v[224:227] offset:12288
v_pk_mul_f32 v[228:229], v[16:17], v[228:229] op_sel:[1,0] op_sel_hi:[1,1]
v_pk_mul_f32 v[230:231], v[16:17], v[230:231] op_sel:[1,0] op_sel_hi:[1,1]
v_pk_mul_f32 v[244:245], v[16:17], v[244:245] op_sel:[1,0] op_sel_hi:[1,1]
v_pk_mul_f32 v[246:247], v[16:17], v[246:247] op_sel:[1,0] op_sel_hi:[1,1]
cvt 228 228 229
cvt 229 230 231
cvt 230 244 245
cvt 231 246 247
ds_write_b128 v27, v[228:231] offset:13312
v_pk_mul_f32 v[232:233], v[18:19], v[232:233] op_sel_hi:[0,1]
v_pk_mul_f32 v[234:235], v[18:19], v[234:235] op_sel_hi:[0,1]
v_pk_mul_f32 v[248:249], v[18:19], v[248:249] op_sel_hi:[0,1]
v_pk_mul_f32 v[250:251], v[18:19], v[250:251] op_sel_hi:[0,1]
cvt 232 232 233
cvt 233 234 235
cvt 234 248 249
cvt 235 250 251
ds_write_b128 v27, v[232:235] offset:14336
v_pk_mul_f32 v[236:237], v[18:19], v[236:237] op_sel:[1,0] op_sel_hi:[1,1]
v_pk_mul_f32 v[238:239], v[18:19], v[238:239] op_sel:[1,0] op_sel_hi:[1,1]
v_pk_mul_f32 v[252:253], v[18:19], v[252:253] op_sel:[1,0] op_sel_hi:[1,1]
v_pk_mul_f32 v[254:255], v[18:19], v[254:255] op_sel:[1,0] op_sel_hi:[1,1]
cvt 236 236 237
cvt 237 238 239
cvt 238 252 253
cvt 239 254 255
ds_write_b128 v27, v[236:239] offset:15360
v_mov_b32 v5, s89
v_mov_b32 v4, s85
ds_write_b32 v4, v5
mvva 124 52 124
wl 0
s_barrier
mvva 124 48 108
trv 36 10 9216
mvva 108 56 108
trv 38 10 9728
v_mov_b32 v4, 98240
mvva 108 60 124
ds_read_b128 v[20:23], v4
s_add_u32 s66, s66, 73728
mvva 104 60 120
rda 128 28 0
s_add_u32 m0, s65, 40960
mvva 104 56 104
rda 132 28 1024
rda 136 28 2048
rda 140 28 3072
rda 144 28 4096
rda 148 28 5120
rda 152 28 6144
rda 156 28 7168
mvva 100 56 100
trv 40 11 8192
mvva 100 60 116
dma 30 52 66 0
mvva 96 60 112
trv 42 11 8704
mvva 96 56 96
trv 44 11 9216
wl 12
wl 10
mvva 64 32 128
trv 46 11 9728
wl 7
mvva 64 36 144
trv 48 11 49152
v_or3_b32 v20, v20, v21, v22
wl 7
mvva 68 36 148
rda 160 28 8192
v_or_b32 v20, v20, v23
mvva 68 32 132
rda 164 28 9216
v_readfirstlane_b32 s89, v20
mvva 72 32 136
dma 31 52 66 1024
wl 8
mvva 72 36 152
trv 50 11 49664
wl 8
mvva 76 36 156
rda 168 28 10240
mvva 76 32 140
s_cmp_lg_u32 s89, 0
s_cbranch_scc1 L_redo
wl 5
mvva 92 40 140
rda 172 28 11264
mvva 92 44 156
trv 52 11 50176
rda 176 28 12288
mvva 88 44 152
trv 54 11 50688
rda 180 28 13312
mvva 88 40 136
rda 184 28 14336
rda 188 28 15360
mvva 84 40 132
rda 192 28 32768
mvva 84 44 148
s_waitcnt vmcnt(12)
s_barrier
trv 56 10 49152
rda 196 28 33792
rda 200 28 34816
trv 58 10 49664
rda 204 28 35840
rda 208 28 36864
trv 60 10 50176
rda 212 28 37888
rda 216 28 38912
trv 62 10 50688
L_merge:
mvva 80 44 144
rda 220 28 39936
s_add_u32 s66, s66, 73728
mvva 80 40 128
s_add_u32 m0, s65, 0
wl 14
mvva 80 48 160
trv 32 10 57344
mvva 80 52 176
rda 224 28 40960
wl 15
mvva 84 52 180
dma 30 52 66 0
mvva 84 48 164
rda 228 28 41984
mvva 88 48 168
trv 34 10 57856
mvva 88 52 184
rda 232 28 43008
wl 15
mvva 92 52 188
rda 236 28 44032
mvva 92 48 172
trv 36 10 58368
wl 8
mvva 76 56 172
rda 240 28 45056
mvva 76 60 188
rda 244 28 46080
mvva 72 60 184
trv 38 10 58880
mvva 72 56 168
rda 248 28 47104
mvva 68 56 164
rda 252 28 48128
mvva 68 60 180
trv 40 11 57344
mvva 64 60 176
trv 42 11 57856
mvva 64 56 160
trv 44 11 58368
wl 5
mvva 64 32 192
dma 31 52 66 1024
mvva 64 36 208
trv 46 11 58880
mvva 68 36 212
trv 48 13 0
mvva 68 32 196
trv 50 13 512
mvva 72 32 200
trv 52 13 1024
mvva 72 36 216
trv 54 13 1536
mvva 76 36 220
trv 56 12 0
mvva 76 32 204
wl 5
mvva 92 40 204
trv 58 12 512
mvva 92 44 220
mvva 88 44 216
trv 60 12 1024
mvva 88 40 200
mvva 84 40 196
trv 62 12 1536
mvva 84 44 212
s_waitcnt vmcnt(10)
s_barrier
mvva 80 44 208
s_add_u32 s66, s66, 73728
s_add_u32 m0, s65, 98304
mvva 80 40 192
trv 32 12 8192
wl 5
mvva 80 48 224
dma 30 52 66 0
mvva 80 52 240
trv 34 12 8704
mvva 84 52 244
trv 36 12 9216
mvva 84 48 228
dma 31 52 66 1024
mvva 88 48 232
trv 38 12 9728
mvva 88 52 248
s_add_u32 s66, s66, 73728
s_add_u32 m0, s65, 106496
mvva 92 52 252
trv 40 13 8192
mvva 92 48 236
dma 30 52 66 0
wl 5
mvva 76 56 236
trv 42 13 8704
mvva 76 60 252
mvva 72 60 248
trv 44 13 9216
mvva 72 56 232
dma 31 52 66 1024
mvva 68 56 228
trv 46 13 9728
mvva 68 60 244
s_add_u32 s66, s66, 73728
s_add_u32 m0, s65, 114688
mvva 64 60 240
trv 48 13 16384
mvva 64 56 224
dma 30 52 66 0
wl 5
mvva 96 32 128
trv 50 13 16896
mvva 96 36 144
mvva 100 36 148
trv 52 13 17408
mvva 100 32 132
dma 31 52 66 1024
mvva 104 32 136
trv 54 13 17920
cvt 128 64 65
mvva 104 36 152
cvt 129 66 67
cvt 131 82 83
mvva 108 36 156
trv 56 12 16384
cvt 130 80 81
mvva 108 32 140
cvt 132 68 69
wl 5
mvva 124 40 140
trv 58 12 16896
cvt 133 70 71
mvva 124 44 156
cvt 134 84 85
cvt 135 86 87
mvva 120 44 152
trv 60 12 17408
mvva 120 40 136
buffer_store_dwordx4 v[128:131], v29, s[60:63], s69 offen offset:0 sc1
mvva 116 40 132
trv 62 12 17920
mvva 116 44 148
s_waitcnt vmcnt(13)
s_barrier
mvva 112 44 144
s_add_u32 s66, s66, 73728
s_add_u32 m0, s65, 122880
mvva 112 40 128
trv 32 10 16384
wl 5
mvva 112 48 160
dma 30 52 66 0
mvva 112 52 176
trv 34 10 16896
cvt 136 72 73
mvva 116 52 180
trv 36 10 17408
cvt 137 74 75
mvva 116 48 164
dma 31 52 66 1024
mvva 120 48 168
trv 38 10 17920
cvt 138 88 89
mvva 120 52 184
s_add_u32 s66, s66, 73728
s_add_u32 m0, s65, 90112
mvva 124 52 188
trv 40 11 16384
cvt 139 90 91
mvva 124 48 172
dma 30 52 66 0
wl 5
mvva 108 56 172
buffer_store_dwordx4 v[132:135], v29, s[60:63], s69 offen offset:1024 sc1
mvva 108 60 188
trv 42 11 16896
mvva 104 60 184
trv 44 11 17408
cvt 140 76 77
mvva 104 56 168
dma 31 52 66 1024
mvva 100 56 164
trv 46 11 17920
cvt 141 78 79
mvva 100 60 180
s_sub_u32 s66, s66, 515968
s_add_u32 m0, s65, 8192
mvva 96 60 176
trv 48 11 32768
cvt 142 92 93
mvva 96 56 160
dma 30 52 66 0
wl 5
mvva 96 32 192
trv 50 11 33280
cvt 143 94 95
mvva 96 36 208
mvva 100 36 212
trv 52 11 33792
mvva 100 32 196
dma 31 52 66 1024
mvva 104 32 200
buffer_store_dwordx4 v[136:139], v29, s[60:63], s69 offen offset:2048 sc1
mvva 104 36 216
trv 54 11 34304
mvva 108 36 220
trv 56 10 32768
mvva 108 32 204
wl 5
mvva 124 40 204
trv 58 10 33280
mvva 124 44 220
mvva 120 44 216
trv 60 10 33792
mvva 120 40 200
mvva 116 40 196
trv 62 10 34304
mvva 116 44 212
s_waitcnt vmcnt(13)
s_barrier
mvva 112 44 208
s_add_u32 s66, s66, 73728
s_add_u32 m0, s65, 49152
mvva 112 40 192
trv 32 10 24576
wl 5
mvva 112 48 224
dma 30 52 66 0
mvva 112 52 240
buffer_store_dwordx4 v[140:143], v29, s[60:63], s69 offen offset:3072 sc1
mvva 116 52 244
trv 34 10 25088
mvva 116 48 228
trv 36 10 25600
s_add_u32 s69, s69, 16384
mvva 120 48 232
trv 38 10 26112
mvva 120 52 248
mvva 124 52 252
trv 40 11 24576
mvva 124 48 236
dma 31 52 66 1024
wl 5
mvva 108 56 236
trv 42 11 25088
mvva 108 60 252
mvva 104 60 248
trv 44 11 25600
mvva 104 56 232
mvva 100 56 228
trv 46 11 26112
mvva 100 60 244
s_add_u32 s66, s66, 73728
s_add_u32 m0, s65, 57344
mvva 96 60 240
trv 48 11 40960
mvva 96 56 224
dma 30 52 66 0
wl 5
mzvva 64 32 0
trv 50 11 41472
mvva 64 36 16
mzvva 68 36 20
trv 52 11 41984
mvva 68 32 4
cvt 144 96 97
cvt 146 112 113
mzvva 72 32 8
trv 54 11 42496
cvt 147 114 115
mvva 72 36 24
cvt 145 98 99
mzvva 76 36 28
trv 56 10 40960
mvva 76 32 12
dma 31 52 66 1024
wl 5
mzvva 92 40 12
trv 58 10 41472
mvva 92 44 28
mzvva 88 44 24
trv 60 10 41984
mvva 88 40 8
mzvva 84 40 4
trv 62 10 42496
cvt 148 100 101
mvva 84 44 20
mzvva 80 44 16
trv 32 10 0
s_add_u32 s66, s66, 73728
mvva 80 40 0
s_add_u32 m0, s65, 65536
wl 5
mvva 80 48 32
dma 30 52 66 0
mvva 80 52 48
trv 34 10 512
cvt 149 102 103
mvva 84 52 52
buffer_store_dwordx4 v[144:147], v29, s[60:63], s69 offen offset:0 sc1
mvva 84 48 36
trv 36 10 1024
mvva 88 48 40
trv 38 10 1536
mvva 88 52 56
mvva 92 52 60
trv 40 11 0
mvva 92 48 44
dma 31 52 66 1024
wl 5
mvva 76 56 44
trv 42 11 512
cvt 151 118 119
mvva 76 60 60
mvva 72 60 56
trv 44 11 1024
mvva 72 56 40
mvva 68 56 36
trv 46 11 1536
mvva 68 60 52
mvva 64 60 48
trv 48 13 32768
mvva 64 56 32
wl 5
mvva 64 32 64
trv 50 13 33280
cvt 150 116 117
mvva 64 36 80
mvva 68 36 84
trv 52 13 33792
mvva 68 32 68
cvt 152 104 105
mvva 72 32 72
trv 54 13 34304
mvva 72 36 88
mvva 76 36 92
trv 56 12 32768
cvt 153 106 107
mvva 76 32 76
wl 5
mvva 92 40 76
trv 58 12 33280
mvva 92 44 92
buffer_store_dwordx4 v[148:151], v29, s[60:63], s69 offen offset:1024 sc1
mvva 88 44 88
trv 60 12 33792
mvva 88 40 72
mvva 84 40 68
trv 62 12 34304
mvva 84 44 84
s_waitcnt vmcnt(12)
s_barrier
mvva 80 44 80
s_add_u32 s66, s66, 73728
s_add_u32 m0, s65, 73728
mvva 80 40 64
trv 32 12 40960
wl 5
mvva 80 48 96
dma 30 52 66 0
mvva 80 52 112
trv 34 12 41472
cvt 155 122 123
mvva 84 52 116
trv 36 12 41984
mvva 84 48 100
mvva 88 48 104
trv 38 12 42496
mvva 88 52 120
dma 31 52 66 1024
mvva 92 52 124
trv 40 13 40960
mvva 92 48 108
cvt 154 120 121
wl 5
mvva 76 56 108
trv 42 13 41472
mvva 76 60 124
s_add_u32 s66, s66, 73728
s_add_u32 m0, s65, 81920
mvva 72 60 120
trv 44 13 41984
cvt 156 108 109
mvva 72 56 104
dma 30 52 66 0
mvva 68 56 100
trv 46 13 42496
mvva 68 60 116
cvt 157 110 111
mvva 64 60 112
trv 48 13 49152
mvva 64 56 96
wl 5
mvva 64 32 128
buffer_store_dwordx4 v[152:155], v29, s[60:63], s69 offen offset:2048 sc1
mvva 64 36 144
L_pga11:
s_cbranch_execz L_pga_back
trv 50 13 49664
mvva 68 36 148
dma 31 52 66 1024
mvva 68 32 132
trv 52 13 50176
mvva 72 32 136
trv 54 13 50688
mvva 72 36 152
cvt 159 126 127
mvva 76 36 156
trv 56 12 49152
s_add_u32 s66, s66, 73728
mvva 76 32 140
s_add_u32 m0, s65, 16384
wl 5
mvva 92 40 140
dma 30 52 66 0
mvva 92 44 156
trv 58 12 49664
mvva 88 44 152
trv 60 12 50176
mvva 88 40 136
mvva 84 40 132
trv 62 12 50688
mvva 84 44 148
dma 31 52 66 1024
mvva 80 44 144
trv 32 12 57344
cvt 158 124 125
mvva 80 40 128
wl 5
mvva 80 48 160
trv 34 12 57856
mvva 80 52 176
mvva 84 52 180
trv 36 12 58368
s_add_u32 s66, s66, 73728
mvva 84 48 164
s_add_u32 m0, s65, 32768
mvva 88 48 168
dma 30 52 66 0
mvva 88 52 184
trv 38 12 58880
mvva 92 52 188
trv 40 13 57344
mvva 92 48 172
wl 5
mvva 76 56 172
buffer_store_dwordx4 v[156:159], v29, s[60:63], s69 offen offset:3072 sc1
mvva 76 60 188
trv 42 13 57856
mvva 72 60 184
dma 31 52 66 1024
mvva 72 56 168
trv 44 13 58368
mvva 68 56 164
trv 46 13 58880
mvva 68 60 180
mvva 64 60 176
trv 48 13 24576
s_add_u32 s69, s69, 16384
mvva 64 56 160
wl 5
mvva 64 32 192
trv 50 13 25088
mvva 64 36 208
mvva 68 36 212
trv 52 13 25600
mvva 68 32 196
mvva 72 32 200
trv 54 13 26112
mvva 72 36 216
mvva 76 36 220
trv 56 12 24576
mvva 76 32 204
wl 5
mvva 92 40 204
trv 58 12 25088
mvva 92 44 220
mvva 88 44 216
trv 60 12 25600
mvva 88 40 200
mvva 84 40 196
trv 62 12 26112
mvva 84 44 212
s_waitcnt vmcnt(11)
s_barrier
mvva 80 44 208
s_sub_u32 s66, s66, 515968
s_add_u32 m0, s65, 24576
mvva 80 40 192
trv 32 10 8192
wl 5
mvva 80 48 224
dma 30 52 66 0
mvva 80 52 240
trv 34 10 8704
mvva 84 52 244
trv 36 10 9216
mvva 84 48 228
mvva 88 48 232
trv 38 10 9728
mvva 88 52 248
dma 31 52 66 1024
mvva 92 52 252
trv 40 11 8192
mvva 92 48 236
wl 5
mvva 76 56 236
trv 42 11 8704
mvva 76 60 252
s_add_u32 s66, s66, 73728
s_add_u32 m0, s65, 40960
mvva 72 60 248
dma 30 52 66 0
mvva 72 56 232
trv 44 11 9216
mvva 68 56 228
trv 46 11 9728
mvva 68 60 244
mvva 64 60 240
trv 48 11 49152
mvva 64 56 224
wl 5
s_mov_b32 s68, 2
.p2align 3
L_att_d:
mzvva 96 32 0
trv 50 11 49664
mvva 96 36 16
dma 31 52 66 1024
mzvva 100 36 20
trv 52 11 50176
mvva 100 32 4
cvt 128 64 65
cvt 130 80 81
mzvva 104 32 8
trv 54 11 50688
cvt 131 82 83
mvva 104 36 24
cvt 129 66 67
mzvva 108 36 28
trv 56 10 49152
s_add_u32 s66, s66, 73728
mvva 108 32 12
s_add_u32 m0, s65, 0
wl 5
mzvva 124 40 12
dma 30 52 66 0
mvva 124 44 28
trv 58 10 49664
mzvva 120 44 24
trv 60 10 50176
mvva 120 40 8
mzvva 116 40 4
trv 62 10 50688
cvt 132 68 69
mvva 116 44 20
dma 31 52 66 1024
mzvva 112 44 16
trv 32 10 57344
mvva 112 40 0
cvt 133 70 71
wl 5
mvva 112 48 32
trv 34 10 57856
mvva 112 52 48
mvva 116 52 52
buffer_store_dwordx4 v[128:131], v29, s[60:63], s69 offen offset:0 sc1
mvva 116 48 36
trv 36 10 58368
s_add_u32 s66, s66, 73728
mvva 120 48 40
s_add_u32 m0, s65, 98304
trv 38 10 58880
mvva 120 52 56
dma 30 52 66 0
mvva 124 52 60
trv 40 11 57344
mvva 124 48 44
cvt 135 86 87
wl 5
mvva 108 56 44
trv 42 11 57856
mvva 108 60 60
dma 31 52 66 1024
mvva 104 60 56
trv 44 11 58368
mvva 104 56 40
mvva 100 56 36
trv 46 11 58880
mvva 100 60 52
mvva 96 60 48
trv 48 13 0
mvva 96 56 32
wl 5
mvva 96 32 64
trv 50 13 512
cvt 134 84 85
mvva 96 36 80
mvva 100 36 84
trv 52 13 1024
mvva 100 32 68
cvt 136 72 73
mvva 104 32 72
trv 54 13 1536
mvva 104 36 88
mvva 108 36 92
trv 56 12 0
cvt 137 74 75
mvva 108 32 76
wl 5
mvva 124 40 76
trv 58 12 512
mvva 124 44 92
buffer_store_dwordx4 v[132:135], v29, s[60:63], s69 offen offset:1024 sc1
mvva 120 44 88
trv 60 12 1024
mvva 120 40 72
mvva 116 40 68
trv 62 12 1536
mvva 116 44 84
s_waitcnt vmcnt(10)
s_barrier
mvva 112 44 80
s_add_u32 s66, s66, 73728
s_add_u32 m0, s65, 106496
mvva 112 40 64
trv 32 12 8192
wl 5
mvva 112 48 96
dma 30 52 66 0
mvva 112 52 112
trv 34 12 8704
v_add_u32 v26, 1, v26
mvva 116 52 116
buffer_store_dword v26, v25, s[40:43], 0 offen sc1
mvva 116 48 100
trv 36 12 9216
cvt 139 90 91
mvva 120 48 104
trv 38 12 9728
mvva 120 52 120
dma 31 52 66 1024
mvva 124 52 124
trv 40 13 8192
mvva 124 48 108
cvt 138 88 89
wl 5
mvva 108 56 108
trv 42 13 8704
mvva 108 60 124
s_add_u32 s66, s66, 73728
s_add_u32 m0, s65, 114688
mvva 104 60 120
trv 44 13 9216
cvt 140 76 77
mvva 104 56 104
dma 30 52 66 0
mvva 100 56 100
trv 46 13 9728
mvva 100 60 116
cvt 141 78 79
mvva 96 60 112
trv 48 13 16384
mvva 96 56 96
wl 5
mvva 96 32 128
buffer_store_dwordx4 v[136:139], v29, s[60:63], s69 offen offset:2048 sc1
mvva 96 36 144
trv 50 13 16896
mvva 100 36 148
dma 31 52 66 1024
mvva 100 32 132
trv 52 13 17408
mvva 104 32 136
trv 54 13 17920
mvva 104 36 152
cvt 143 94 95
mvva 108 36 156
trv 56 12 16384
s_add_u32 s66, s66, 73728
mvva 108 32 140
s_add_u32 m0, s65, 122880
wl 5
mvva 124 40 140
dma 30 52 66 0
mvva 124 44 156
trv 58 12 16896
mvva 120 44 152
trv 60 12 17408
mvva 120 40 136
mvva 116 40 132
trv 62 12 17920
mvva 116 44 148
dma 31 52 66 1024
mvva 112 44 144
trv 32 10 16384
cvt 142 92 93
mvva 112 40 128
wl 5
mvva 112 48 160
trv 34 10 16896
mvva 112 52 176
mvva 116 52 180
trv 36 10 17408
s_add_u32 s66, s66, 73728
mvva 116 48 164
s_add_u32 m0, s65, 90112
mvva 120 48 168
dma 30 52 66 0
mvva 120 52 184
trv 38 10 17920
mvva 124 52 188
trv 40 11 16384
mvva 124 48 172
wl 5
mvva 108 56 172
buffer_store_dwordx4 v[140:143], v29, s[60:63], s69 offen offset:3072 sc1
mvva 108 60 188
trv 42 11 16896
mvva 104 60 184
dma 31 52 66 1024
mvva 104 56 168
trv 44 11 17408
mvva 100 56 164
trv 46 11 17920
mvva 100 60 180
mvva 96 60 176
trv 48 11 32768
s_add_u32 s69, s69, 16384
mvva 96 56 160
wl 5
mvva 96 32 192
trv 50 11 33280
mvva 96 36 208
mvva 100 36 212
trv 52 11 33792
mvva 100 32 196
mvva 104 32 200
trv 54 11 34304
mvva 104 36 216
mvva 108 36 220
trv 56 10 32768
mvva 108 32 204
wl 5
mvva 124 40 204
trv 58 10 33280
mvva 124 44 220
mvva 120 44 216
trv 60 10 33792
mvva 120 40 200
mvva 116 40 196
trv 62 10 34304
mvva 116 44 212
s_waitcnt vmcnt(12)
s_barrier
mvva 112 44 208
s_sub_u32 s66, s66, 515968
s_add_u32 m0, s65, 8192
mvva 112 40 192
trv 32 10 24576
wl 5
mvva 112 48 224
dma 30 52 66 0
mvva 112 52 240
trv 34 10 25088
mvva 116 52 244
trv 36 10 25600
mvva 116 48 228
mvva 120 48 232
trv 38 10 26112
mvva 120 52 248
dma 31 52 66 1024
mvva 124 52 252
trv 40 11 24576
mvva 124 48 236
wl 5
mvva 108 56 236
trv 42 11 25088
mvva 108 60 252
s_add_u32 s66, s66, 73728
s_add_u32 m0, s65, 49152
mvva 104 60 248
trv 44 11 25600
mvva 104 56 232
dma 30 52 66 0
mvva 100 56 228
trv 46 11 26112
mvva 100 60 244
mvva 96 60 240
trv 48 11 40960
mvva 96 56 224
wl 5
mzvva 64 32 0
trv 50 11 41472
mvva 64 36 16
dma 31 52 66 1024
mzvva 68 36 20
trv 52 11 41984
mvva 68 32 4
cvt 144 96 97
cvt 146 112 113
mzvva 72 32 8
trv 54 11 42496
cvt 147 114 115
mvva 72 36 24
cvt 145 98 99
mzvva 76 36 28
trv 56 10 40960
s_add_u32 s66, s66, 73728
mvva 76 32 12
s_add_u32 m0, s65, 57344
wl 5
mzvva 92 40 12
dma 30 52 66 0
mvva 92 44 28
trv 58 10 41472
mzvva 88 44 24
trv 60 10 41984
mvva 88 40 8
mzvva 84 40 4
trv 62 10 42496
cvt 148 100 101
mvva 84 44 20
dma 31 52 66 1024
mzvva 80 44 16
trv 32 10 0
mvva 80 40 0
cvt 149 102 103
wl 5
mvva 80 48 32
trv 34 10 512
mvva 80 52 48
mvva 84 52 52
buffer_store_dwordx4 v[144:147], v29, s[60:63], s69 offen offset:0 sc1
mvva 84 48 36
trv 36 10 1024
s_add_u32 s66, s66, 73728
mvva 88 48 40
s_add_u32 m0, s65, 65536
trv 38 10 1536
mvva 88 52 56
dma 30 52 66 0
mvva 92 52 60
trv 40 11 0
mvva 92 48 44
cvt 151 118 119
wl 5
mvva 76 56 44
trv 42 11 512
mvva 76 60 60
dma 31 52 66 1024
mvva 72 60 56
trv 44 11 1024
mvva 72 56 40
mvva 68 56 36
trv 46 11 1536
mvva 68 60 52
mvva 64 60 48
trv 48 13 32768
mvva 64 56 32
wl 5
mvva 64 32 64
trv 50 13 33280
cvt 150 116 117
mvva 64 36 80
mvva 68 36 84
trv 52 13 33792
mvva 68 32 68
cvt 152 104 105
mvva 72 32 72
trv 54 13 34304
mvva 72 36 88
mvva 76 36 92
trv 56 12 32768
cvt 153 106 107
mvva 76 32 76
wl 5
mvva 92 40 76
trv 58 12 33280
mvva 92 44 92
buffer_store_dwordx4 v[148:151], v29, s[60:63], s69 offen offset:1024 sc1
mvva 88 44 88
trv 60 12 33792
mvva 88 40 72
mvva 84 40 68
trv 62 12 34304
mvva 84 44 84
s_waitcnt vmcnt(10)
s_barrier
mvva 80 44 80
s_add_u32 s66, s66, 73728
s_add_u32 m0, s65, 73728
mvva 80 40 64
trv 32 12 40960
wl 5
mvva 80 48 96
dma 30 52 66 0
mvva 80 52 112
trv 34 12 41472
v_add_u32 v26, 1, v26
mvva 84 52 116
buffer_store_dword v26, v25, s[40:43], 0 offen sc1
mvva 84 48 100
trv 36 12 41984
cvt 155 122 123
mvva 88 48 104
trv 38 12 42496
mvva 88 52 120
dma 31 52 66 1024
mvva 92 52 124
trv 40 13 40960
mvva 92 48 108
cvt 154 120 121
wl 5
mvva 76 56 108
trv 42 13 41472
mvva 76 60 124
s_add_u32 s66, s66, 73728
s_add_u32 m0, s65, 81920
mvva 72 60 120
trv 44 13 41984
cvt 156 108 109
mvva 72 56 104
dma 30 52 66 0
mvva 68 56 100
trv 46 13 42496
mvva 68 60 116
cvt 157 110 111
mvva 64 60 112
trv 48 13 49152
mvva 64 56 96
wl 5
mvva 64 32 128
buffer_store_dwordx4 v[152:155], v29, s[60:63], s69 offen offset:2048 sc1
L_pga12:
s_cbranch_execz L_pga_back
mvva 64 36 144
trv 50 13 49664
mvva 68 36 148
dma 31 52 66 1024
mvva 68 32 132
trv 52 13 50176
mvva 72 32 136
trv 54 13 50688
mvva 72 36 152
cvt 159 126 127
mvva 76 36 156
trv 56 12 49152
s_add_u32 s66, s66, 73728
mvva 76 32 140
s_add_u32 m0, s65, 16384
wl 5
mvva 92 40 140
dma 30 52 66 0
mvva 92 44 156
trv 58 12 49664
mvva 88 44 152
trv 60 12 50176
mvva 88 40 136
mvva 84 40 132
trv 62 12 50688
mvva 84 44 148
dma 31 52 66 1024
mvva 80 44 144
trv 32 12 57344
cvt 158 124 125
mvva 80 40 128
wl 5
mvva 80 48 160
trv 34 12 57856
mvva 80 52 176
mvva 84 52 180
trv 36 12 58368
s_add_u32 s66, s66, 73728
mvva 84 48 164
s_add_u32 m0, s65, 32768
mvva 88 48 168
dma 30 52 66 0
mvva 88 52 184
trv 38 12 58880
mvva 92 52 188
trv 40 13 57344
mvva 92 48 172
wl 5
mvva 76 56 172
buffer_store_dwordx4 v[156:159], v29, s[60:63], s69 offen offset:3072 sc1
mvva 76 60 188
trv 42 13 57856
mvva 72 60 184
dma 31 52 66 1024
mvva 72 56 168
trv 44 13 58368
mvva 68 56 164
trv 46 13 58880
mvva 68 60 180
mvva 64 60 176
trv 48 13 24576
s_add_u32 s69, s69, 16384
mvva 64 56 160
wl 5
mvva 64 32 192
trv 50 13 25088
mvva 64 36 208
mvva 68 36 212
trv 52 13 25600
mvva 68 32 196
mvva 72 32 200
trv 54 13 26112
mvva 72 36 216
mvva 76 36 220
trv 56 12 24576
mvva 76 32 204
wl 5
mvva 92 40 204
trv 58 12 25088
mvva 92 44 220
mvva 88 44 216
trv 60 12 25600
mvva 88 40 200
mvva 84 40 196
trv 62 12 26112
mvva 84 44 212
s_waitcnt vmcnt(12)
s_barrier
mvva 80 44 208
s_sub_u32 s66, s66, 515968
s_add_u32 m0, s65, 24576
mvva 80 40 192
trv 32 10 8192
wl 5
mvva 80 48 224
dma 30 52 66 0
mvva 80 52 240
trv 34 10 8704
mvva 84 52 244
trv 36 10 9216
mvva 84 48 228
mvva 88 48 232
trv 38 10 9728
mvva 88 52 248
dma 31 52 66 1024
mvva 92 52 252
trv 40 11 8192
mvva 92 48 236
wl 5
mvva 76 56 236
trv 42 11 8704
mvva 76 60 252
s_add_u32 s66, s66, 73728
s_add_u32 m0, s65, 40960
mvva 72 60 248
dma 30 52 66 0
mvva 72 56 232
trv 44 11 9216
mvva 68 56 228
trv 46 11 9728
mvva 68 60 244
mvva 64 60 240
trv 48 11 49152
mvva 64 56 224
wl 5
s_sub_u32 s68, s68, 1
s_cbranch_scc0 L_att_d
s_nop 4
cvt 128 64 65
cvt 129 66 67
cvt 130 80 81
cvt 131 82 83
buffer_store_dwordx4 v[128:131], v29, s[60:63], s69 offen offset:0 sc1
cvt 132 68 69
cvt 133 70 71
cvt 134 84 85
cvt 135 86 87
buffer_store_dwordx4 v[132:135], v29, s[60:63], s69 offen offset:1024 sc1
cvt 136 72 73
cvt 137 74 75
cvt 138 88 89
cvt 139 90 91
buffer_store_dwordx4 v[136:139], v29, s[60:63], s69 offen offset:2048 sc1
cvt 140 76 77
cvt 141 78 79
cvt 142 92 93
cvt 143 94 95
buffer_store_dwordx4 v[140:143], v29, s[60:63], s69 offen offset:3072 sc1
s_add_u32 s69, s69, 16384
s_waitcnt vmcnt(0)
s_barrier
v_mov_b32 v26, 9
buffer_store_dword v26, v25, s[40:43], 0 offen sc1
s_endpgm
L_redo:
s_waitcnt vmcnt(0) lgkmcnt(0)
s_barrier
s_mov_b32 s88, 1
v_mbcnt_lo_u32_b32 v0, -1, 0
v_mbcnt_hi_u32_b32 v0, -1, v0
s_lshl_b32 s78, s64, 6
v_or_b32 v0, s78, v0
s_branch L_restart
L_slow:
wl 0
s_nop 5
mul 152 20 152
mul 153 20 153
mul 154 20 154
mul 155 20 155
cvt 152 152 153
cvt 153 154 155
mul 168 20 168
mul 169 20 169
mul 170 20 170
mul 171 20 171
cvt 168 168 169
cvt 169 170 171
ds_write2st64_b64 v0, v[152:153], v[168:169] offset0:16 offset1:17
mul 156 21 156
mul 157 21 157
mul 158 21 158
mul 159 21 159
cvt 156 156 157
cvt 157 158 159
mul 172 21 172
mul 173 21 173
mul 174 21 174
mul 175 21 175
cvt 172 172 173
cvt 173 174 175
ds_write2st64_b64 v0, v[156:157], v[172:173] offset0:18 offset1:19
mul 160 22 160
mul 161 22 161
mul 162 22 162
mul 163 22 163
cvt 160 160 161
cvt 161 162 163
mul 176 22 176
mul 177 22 177
mul 178 22 178
mul 179 22 179
cvt 176 176 177
cvt 177 178 179
ds_write2st64_b64 v0, v[160:161], v[176:177] offset0:20 offset1:21
mul 164 23 164
mul 165 23 165
mul 166 23 166
mul 167 23 167
cvt 164 164 165
cvt 165 166 167
mul 180 23 180
mul 181 23 181
mul 182 23 182
mul 183 23 183
cvt 180 180 181
cvt 181 182 183
ds_write2st64_b64 v0, v[164:165], v[180:181] offset0:22 offset1:23
mul 184 20 184
mul 185 20 185
mul 186 20 186
mul 187 20 187
cvt 184 184 185
cvt 185 186 187
mul 200 20 200
mul 201 20 201
mul 202 20 202
mul 203 20 203
cvt 200 200 201
cvt 201 202 203
ds_write2st64_b64 v0, v[184:185], v[200:201] offset0:24 offset1:25
mul 188 21 188
mul 189 21 189
mul 190 21 190
mul 191 21 191
cvt 188 188 189
cvt 189 190 191
mul 204 21 204
mul 205 21 205
mul 206 21 206
mul 207 21 207
cvt 204 204 205
cvt 205 206 207
ds_write2st64_b64 v0, v[188:189], v[204:205] offset0:26 offset1:27
mul 192 22 192
mul 193 22 193
mul 194 22 194
mul 195 22 195
cvt 192 192 193
cvt 193 194 195
mul 208 22 208
mul 209 22 209
mul 210 22 210
mul 211 22 211
cvt 208 208 209
cvt 209 210 211
ds_write2st64_b64 v0, v[192:193], v[208:209] offset0:28 offset1:29
mul 196 23 196
mul 197 23 197
mul 198 23 198
mul 199 23 199
cvt 196 196 197
cvt 197 198 199
mul 212 23 212
mul 213 23 213
mul 214 23 214
mul 215 23 215
cvt 212 212 213
cvt 213 214 215
ds_write2st64_b64 v0, v[196:197], v[212:213] offset0:30 offset1:31
wl 0
rdv 88 27 0
rdv 92 27 1024
rdv 96 27 2048
rdv 100 27 3072
rdv 104 27 4096
rdv 108 27 5120
rdv 112 27 6144
rdv 116 27 7168
rdv 120 27 8192
rdv 124 27 9216
rdv 128 27 10240
rdv 132 27 11264
rdv 136 27 12288
rdv 140 27 13312
rdv 144 27 14336
rdv 148 27 15360
v_mbcnt_lo_u32_b32 v72, -1, 0
v_mbcnt_hi_u32_b32 v72, -1, v72
v_lshrrev_b32 v73, 4, v72
v_and_b32 v72, 15, v72
v_lshlrev_b32 v72, 8, v72
v_lshl_or_b32 v72, v73, 4, v72
v_mov_b32 v64, 0xff800000
v_mov_b32 v65, 0xff800000
v_mov_b32 v66, 0xff800000
v_mov_b32 v67, 0xff800000
s_mov_b32 s67, 0
s_mov_b32 s68, 31
L_max0:
buffer_load_dwordx4 v[32:35], v72, s[48:51], s67 offen offset:0
buffer_load_dwordx4 v[36:39], v72, s[48:51], s67 offen offset:64
buffer_load_dwordx4 v[40:43], v72, s[48:51], s67 offen offset:128
buffer_load_dwordx4 v[44:47], v72, s[48:51], s67 offen offset:192
s_add_u32 s67, s67, 4096
s_waitcnt vmcnt(3)
mzvva 48 32 0
mzvva 52 32 4
mzvva 56 32 8
mzvva 60 32 12
s_waitcnt vmcnt(2)
mvva 48 36 16
mvva 52 36 20
mvva 56 36 24
mvva 60 36 28
s_waitcnt vmcnt(1)
mvva 48 40 32
mvva 52 40 36
mvva 56 40 40
mvva 60 40 44
s_waitcnt vmcnt(0)
mvva 48 44 48
mvva 52 44 52
mvva 56 44 56
mvva 60 44 60
s_nop 4
v_max3_f32 v64, v64, v48, v49
v_max3_f32 v64, v64, v50, v51
v_max3_f32 v65, v65, v52, v53
v_max3_f32 v65, v65, v54, v55
v_max3_f32 v66, v66, v56, v57
v_max3_f32 v66, v66, v58, v59
v_max3_f32 v67, v67, v60, v61
v_max3_f32 v67, v67, v62, v63
s_sub_u32 s68, s68, 1
s_cbranch_scc0 L_max0
v_mov_b32 v68, v64
v_mov_b32 v69, v65
v_mov_b32 v70, v66
v_mov_b32 v71, v67
v_permlane32_swap_b32 v64, v68
v_permlane32_swap_b32 v65, v69
v_permlane32_swap_b32 v66, v70
v_permlane32_swap_b32 v67, v71
v_max_f32 v64, v64, v68
v_max_f32 v65, v65, v69
v_max_f32 v66, v66, v70
v_max_f32 v67, v67, v71
v_mov_b32 v68, v64
v_mov_b32 v69, v65
v_mov_b32 v70, v66
v_mov_b32 v71, v67
v_permlane16_swap_b32 v64, v68
v_permlane16_swap_b32 v65, v69
v_permlane16_swap_b32 v66, v70
v_permlane16_swap_b32 v67, v71
v_max_f32 v64, v64, v68
v_max_f32 v65, v65, v69
v_max_f32 v66, v66, v70
v_max_f32 v67, v67, v71
v_sub_f32 v20, 0, v64
v_sub_f32 v21, 0, v65
v_sub_f32 v22, 0, v66
v_sub_f32 v23, 0, v67
v_mov_b32 v64, 0xff800000
v_mov_b32 v65, 0xff800000
v_mov_b32 v66, 0xff800000
v_mov_b32 v67, 0xff800000
s_mov_b32 s67, 524288
s_mov_b32 s68, 31
L_max1:
buffer_load_dwordx4 v[32:35], v72, s[48:51], s67 offen offset:0
buffer_load_dwordx4 v[36:39], v72, s[48:51], s67 offen offset:64
buffer_load_dwordx4 v[40:43], v72, s[48:51], s67 offen offset:128
buffer_load_dwordx4 v[44:47], v72, s[48:51], s67 offen offset:192
s_add_u32 s67, s67, 4096
s_waitcnt vmcnt(3) lgkmcnt(15)
mzvvv 48 32 88
wl 14
mzvvv 52 32 92
wl 13
mzvvv 56 32 96
wl 12
mzvvv 60 32 100
s_waitcnt vmcnt(2) lgkmcnt(11)
mvvv 48 36 104
wl 10
mvvv 52 36 108
wl 9
mvvv 56 36 112
wl 8
mvvv 60 36 116
s_waitcnt vmcnt(1) lgkmcnt(7)
mvvv 48 40 120
wl 6
mvvv 52 40 124
wl 5
mvvv 56 40 128
wl 4
mvvv 60 40 132
s_waitcnt vmcnt(0) lgkmcnt(3)
mvvv 48 44 136
wl 2
mvvv 52 44 140
wl 1
mvvv 56 44 144
wl 0
mvvv 60 44 148
s_nop 1
v_max3_f32 v64, v64, v48, v49
v_max3_f32 v64, v64, v50, v51
v_max3_f32 v65, v65, v52, v53
v_max3_f32 v65, v65, v54, v55
v_max3_f32 v66, v66, v56, v57
v_max3_f32 v66, v66, v58, v59
v_max3_f32 v67, v67, v60, v61
v_max3_f32 v67, v67, v62, v63
s_sub_u32 s68, s68, 1
s_cbranch_scc0 L_max1
v_mov_b32 v68, v64
v_mov_b32 v69, v65
v_mov_b32 v70, v66
v_mov_b32 v71, v67
v_permlane32_swap_b32 v64, v68
v_permlane32_swap_b32 v65, v69
v_permlane32_swap_b32 v66, v70
v_permlane32_swap_b32 v67, v71
v_max_f32 v64, v64, v68
v_max_f32 v65, v65, v69
v_max_f32 v66, v66, v70
v_max_f32 v67, v67, v71
v_mov_b32 v68, v64
v_mov_b32 v69, v65
v_mov_b32 v70, v66
v_mov_b32 v71, v67
v_permlane16_swap_b32 v64, v68
v_permlane16_swap_b32 v65, v69
v_permlane16_swap_b32 v66, v70
v_permlane16_swap_b32 v67, v71
v_max_f32 v64, v64, v68
v_max_f32 v65, v65, v69
v_max_f32 v66, v66, v70
v_max_f32 v67, v67, v71
v_sub_f32 v64, 0, v64
aw 96 64
v_sub_f32 v65, 0, v65
aw 97 65
v_sub_f32 v66, 0, v66
aw 98 66
v_sub_f32 v67, 0, v67
aw 99 67
mzvaa 32 64 0
rda 88 18 4096
mvaa 32 68 16
mvaa 32 72 32
mvaa 32 76 48
rda 92 19 4096
mzvaa 36 76 52
mvaa 36 72 36
mvaa 36 68 20
mvaa 36 64 4
mzvaa 40 64 8
mvaa 40 68 24
mvaa 40 72 40
mvaa 40 76 56
mzvaa 44 76 60
s_barrier
mvaa 44 72 44
mvaa 44 68 28
mvaa 44 64 12
rda 64 16 8192
wl 1
mzvaa 48 80 0
rda 68 17 8192
mvaa 48 84 16
rda 72 18 8192
mvaa 48 88 32
mvaa 48 92 48
rda 76 19 8192
mzvaa 52 92 52
mvaa 52 88 36
mvaa 52 84 20
mvaa 52 80 4
mzvaa 56 80 8
mvaa 56 84 24
mvaa 56 88 40
mvaa 56 92 56
mzvaa 60 92 60
mvaa 60 88 44
v_accvgpr_write_b32 a240, s76
mvaa 60 84 28
v_accvgpr_write_b32 a241, s76
mvaa 60 80 12
rda 80 16 12288
wl 1
mzvaa 64 64 0
rda 84 17 12288
add 32 20 32
mvaa 64 68 16
rda 88 18 12288
add 33 20 33
mvaa 64 72 32
exp 32 32
mvaa 64 76 48
rda 92 19 12288
add 34 20 34
mzvaa 68 76 52
exp 33 33
mvaa 68 72 36
exp 34 34
mvaa 68 68 20
s_barrier
mvaa 68 64 4
s_add_u32 s80, s80, 8192
mzvaa 72 64 8
s_add_u32 m0, s65, 0
add 35 20 35
mvaa 72 68 24
dma 14 48 80 0
v_accvgpr_write_b32 a242, s76
mvaa 72 72 40
exp 35 35
mvaa 72 76 56
tra 128 6 0
v_accvgpr_write_b32 a243, s76
mzvaa 76 76 60
cvt 96 32 33
cvt 97 34 35
mvaa 76 72 44
tra 130 6 512
add 36 21 36
mvaa 76 68 28
exp 36 36
mvaa 76 64 12
rda 64 16 16384
wl 3
mzvaa 80 80 0
rda 68 17 16384
add 37 21 37
mvaa 80 84 16
rda 72 18 16384
add 38 21 38
mvaa 80 88 32
exp 37 37
mvaa 80 92 48
rda 76 19 16384
add 39 21 39
mzvaa 84 92 52
tra 132 7 0
exp 38 38
mvaa 84 88 36
dma 15 48 80 1024
cvt 100 36 37
mvaa 84 84 20
tra 134 7 512
exp 39 39
mvaa 84 80 4
cvt 101 38 39
mzvaa 88 80 8
add 40 22 40
add 41 22 41
mvaa 88 84 24
exp 40 40
mvaa 88 88 40
exp 41 41
mvaa 88 92 56
tra 136 8 0
add 42 22 42
mzvaa 92 92 60
exp 42 42
mvaa 92 88 44
tra 138 8 512
add 43 22 43
mvaa 92 84 28
exp 43 43
mvaa 92 80 12
cvt 104 40 41
cvt 105 42 43
add 44 23 44
add 45 23 45
add 46 23 46
add 47 23 47
exp 44 44
exp 45 45
exp 46 46
exp 47 47
cvt 108 44 45
cvt 109 46 47
add 48 20 48
add 49 20 49
add 50 20 50
add 51 20 51
exp 48 48
exp 49 49
exp 50 50
exp 51 51
cvt 98 48 49
cvt 99 50 51
add 52 21 52
add 53 21 53
add 54 21 54
add 55 21 55
exp 52 52
exp 53 53
exp 54 54
exp 55 55
cvt 102 52 53
cvt 103 54 55
add 56 22 56
add 57 22 57
add 58 22 58
add 59 22 59
exp 56 56
exp 57 57
exp 58 58
exp 59 59
cvt 106 56 57
cvt 107 58 59
add 60 23 60
add 61 23 61
add 62 23 62
add 63 23 63
exp 60 60
exp 61 61
exp 62 62
exp 63 63
cvt 110 60 61
cvt 111 62 63
wl 4
mzvaa 32 64 0
s_add_u32 s81, s81, 8192
s_add_u32 m0, s65, 49152
mvaa 32 68 16
dma 2 56 81 0
mvaa 32 72 32
add 64 20 64
add 65 20 65
mvaa 32 76 48
tra 140 9 0
add 66 20 66
mzvav 128 128 96
exp 64 64
mzvav 132 128 100
tra 142 9 512
add 67 20 67
mzvav 136 128 104
exp 65 65
mzvav 140 128 108
rda 80 16 20480
wl 5
mzvaa 36 76 52
exp 66 66
mvaa 36 72 36
exp 67 67
mvaa 36 68 20
cvt 112 64 65
cvt 113 66 67
mvaa 36 64 4
rda 84 17 20480
add 68 21 68
mzvav 156 132 108
tra 144 6 1024
add 69 21 69
mzvav 152 132 104
tra 146 6 1536
add 70 21 70
mzvav 148 132 100
dma 3 56 81 1024
mzvav 144 132 96
rda 88 18 20480
wl 7
mzvaa 40 64 8
exp 68 68
mvaa 40 68 24
exp 69 69
mvaa 40 72 40
exp 70 70
mvaa 40 76 56
rda 92 19 20480
add 71 21 71
mzvav 160 136 96
tra 148 7 1024
exp 71 71
mzvav 164 136 100
tra 150 7 1536
cvt 116 68 69
mzvav 168 136 104
cvt 117 70 71
add 72 22 72
mzvav 172 136 108
add 73 22 73
wl 8
mzvaa 44 76 60
exp 72 72
mvaa 44 72 44
exp 73 73
mvaa 44 68 28
add 74 22 74
add 75 22 75
mvaa 44 64 12
tra 152 8 1024
exp 74 74
mzvav 188 140 108
exp 75 75
mzvav 184 140 104
tra 154 8 1536
cvt 120 72 73
mzvav 180 140 100
cvt 121 74 75
add 76 23 76
mzvav 176 140 96
add 77 23 77
wl 4
mzvaa 48 80 0
exp 76 76
mvaa 48 84 16
exp 77 77
mvaa 48 88 32
add 78 23 78
add 79 23 79
mvaa 48 92 48
tra 156 9 1024
exp 78 78
mzvav 192 144 96
exp 79 79
mzvav 196 144 100
tra 158 9 1536
cvt 124 76 77
mzvav 200 144 104
cvt 125 78 79
add 80 20 80
mzvav 204 144 108
add 81 20 81
wl 4
mzvaa 52 92 52
exp 80 80
mvaa 52 88 36
exp 81 81
mvaa 52 84 20
s_barrier
mvaa 52 80 4
s_add_u32 s80, s80, 8192
s_add_u32 m0, s65, 8192
mzvav 220 148 108
rda 64 16 24576
add 82 20 82
mzvav 216 148 104
dma 14 48 80 0
add 83 20 83
mzvav 212 148 100
exp 82 82
mzvav 208 148 96
rda 68 17 24576
wl 4
mzvaa 56 80 8
tra 128 6 8192
exp 83 83
mvaa 56 84 24
tra 130 6 8704
cvt 114 80 81
mvaa 56 88 40
cvt 115 82 83
add 84 21 84
mvaa 56 92 56
rda 72 18 24576
add 85 21 85
mzvav 224 152 96
exp 84 84
mzvav 228 152 100
exp 85 85
mzvav 232 152 104
add 86 21 86
add 87 21 87
mzvav 236 152 108
rda 76 19 24576
wl 6
mzvaa 60 92 60
tra 132 7 8192
exp 86 86
mvaa 60 88 44
dma 15 48 80 1024
cvt 118 84 85
mvaa 60 84 28
tra 134 7 8704
exp 87 87
mvaa 60 80 12
cvt 119 86 87
add 88 22 88
mzvav 252 156 108
exp 88 88
mzvav 248 156 104
add 89 22 89
add 90 22 90
mzvav 244 156 100
exp 89 89
mzvav 240 156 96
tra 136 8 8192
add 91 22 91
mzaav 224 240 96
exp 90 90
mzaav 228 240 100
tra 138 8 8704
exp 91 91
mzaav 232 240 104
cvt 122 88 89
cvt 123 90 91
mzaav 236 240 108
add 92 23 92
add 93 23 93
add 94 23 94
add 95 23 95
exp 92 92
exp 93 93
exp 94 94
exp 95 95
cvt 126 92 93
cvt 127 94 95
add 32 20 32
add 33 20 33
wl 4
s_mov_b32 s68, 2
.p2align 3
L_att_s:
mzvaa 64 64 0
s_add_u32 s81, s81, 8192
s_add_u32 m0, s65, 57344
mvaa 64 68 16
dma 2 56 81 0
mvaa 64 72 32
exp 32 32
mvaa 64 76 48
tra 140 9 8192
add 34 20 34
mvav 128 128 112
exp 33 33
mvav 132 128 116
tra 142 9 8704
add 35 20 35
mvav 136 128 120
exp 34 34
mvav 140 128 124
rda 80 16 28672
wl 5
mzvaa 68 76 52
exp 35 35
mvaa 68 72 36
s_cmp_eq_u32 s68, 0
s_cselect_b32 s82, 401408, s87
mvaa 68 68 20
cvt 96 32 33
cvt 97 34 35
mvaa 68 64 4
rda 84 17 28672
add 36 21 36
mvav 156 132 124
tra 144 6 9216
add 37 21 37
mvav 152 132 120
tra 146 6 9728
add 38 21 38
mvav 148 132 116
dma 3 56 81 1024
mvav 144 132 112
rda 88 18 28672
wl 7
mzvaa 72 64 8
exp 36 36
mvaa 72 68 24
exp 37 37
mvaa 72 72 40
exp 38 38
mvaa 72 76 56
rda 92 19 28672
add 39 21 39
mvav 160 136 112
tra 148 7 9216
exp 39 39
mvav 164 136 116
buffer_load_dword v0, v24, s[52:55], s86 offen
cvt 100 36 37
mvav 168 136 120
tra 150 7 9728
cvt 101 38 39
mvav 172 136 124
add 40 22 40
wl 8
mzvaa 76 76 60
exp 40 40
mvaa 76 72 44
add 41 22 41
add 42 22 42
mvaa 76 68 28
exp 41 41
mvaa 76 64 12
tra 152 8 9216
add 43 22 43
mvav 188 140 124
exp 42 42
mvav 184 140 120
tra 154 8 9728
s_add_u32 s86, s86, 24576
mvav 180 140 116
exp 43 43
mvav 176 140 112
cvt 104 40 41
wl 4
mzvaa 80 80 0
cvt 105 42 43
add 44 23 44
mvaa 80 84 16
exp 44 44
mvaa 80 88 32
add 45 23 45
add 46 23 46
mvaa 80 92 48
tra 156 9 9216
add 47 23 47
mvav 192 144 112
exp 45 45
mvav 196 144 116
tra 158 9 9728
exp 46 46
mvav 200 144 120
exp 47 47
mvav 204 144 124
cvt 108 44 45
wl 4
mzvaa 84 92 52
cvt 109 46 47
add 48 20 48
mvaa 84 88 36
exp 48 48
mvaa 84 84 20
s_waitcnt vmcnt(5)
s_barrier
mvaa 84 80 4
s_add_u32 s80, s80, 8192
s_add_u32 m0, s65, 16384
mvav 220 148 124
rda 64 16 0
add 49 20 49
mvav 216 148 120
dma 14 48 80 0
add 50 20 50
mvav 212 148 116
exp 49 49
mvav 208 148 112
rda 68 17 0
wl 4
mzvaa 88 80 8
tra 128 6 16384
add 51 20 51
mvaa 88 84 24
tra 130 6 16896
exp 50 50
mvaa 88 88 40
exp 51 51
mvaa 88 92 56
rda 72 18 0
cvt 98 48 49
mvav 224 152 112
cvt 99 50 51
add 52 21 52
mvav 228 152 116
exp 52 52
mvav 232 152 120
add 53 21 53
add 54 21 54
mvav 236 152 124
rda 76 19 0
wl 6
mzvaa 92 92 60
tra 132 7 16384
add 55 21 55
mvaa 92 88 44
dma 15 48 80 1024
add 56 22 56
mvaa 92 84 28
tra 134 7 16896
exp 53 53
mvaa 92 80 12
exp 54 54
mvav 252 156 124
exp 55 55
mvav 248 156 120
exp 56 56
mvav 244 156 116
cvt 102 52 53
cvt 103 54 55
mvav 240 156 112
tra 136 8 16384
add 57 22 57
maav 224 240 112
exp 57 57
maav 228 240 116
tra 138 8 16896
add 58 22 58
maav 232 240 120
exp 58 58
maav 236 240 124
add 59 22 59
exp 59 59
cvt 106 56 57
cvt 107 58 59
add 60 23 60
add 61 23 61
add 62 23 62
add 63 23 63
exp 60 60
exp 61 61
exp 62 62
exp 63 63
cvt 110 60 61
cvt 111 62 63
wl 4
mzvaa 32 64 0
s_add_u32 s81, s81, 8192
s_add_u32 m0, s65, 32768
mvaa 32 68 16
dma 2 56 81 0
mvaa 32 72 32
add 64 20 64
add 65 20 65
mvaa 32 76 48
tra 140 9 16384
add 66 20 66
mvav 128 128 96
exp 64 64
mvav 132 128 100
tra 142 9 16896
add 67 20 67
mvav 136 128 104
exp 65 65
mvav 140 128 108
rda 80 16 4096
wl 5
mzvaa 36 76 52
exp 66 66
mvaa 36 72 36
exp 67 67
mvaa 36 68 20
cvt 112 64 65
cvt 113 66 67
mvaa 36 64 4
rda 84 17 4096
add 68 21 68
mvav 156 132 108
tra 144 6 17408
add 69 21 69
mvav 152 132 104
tra 146 6 17920
add 70 21 70
mvav 148 132 100
dma 3 56 81 1024
mvav 144 132 96
rda 88 18 4096
wl 7
mzvaa 40 64 8
exp 68 68
mvaa 40 68 24
exp 69 69
mvaa 40 72 40
exp 70 70
mvaa 40 76 56
rda 92 19 4096
add 71 21 71
mvav 160 136 96
tra 148 7 17408
exp 71 71
mvav 164 136 100
buffer_load_dword v0, v24, s[52:55], s86 offen
cvt 116 68 69
mvav 168 136 104
tra 150 7 17920
cvt 117 70 71
mvav 172 136 108
add 72 22 72
wl 8
mzvaa 44 76 60
exp 72 72
mvaa 44 72 44
add 73 22 73
add 74 22 74
mvaa 44 68 28
exp 73 73
mvaa 44 64 12
tra 152 8 17408
add 75 22 75
mvav 188 140 108
exp 74 74
mvav 184 140 104
tra 154 8 17920
s_add_u32 s86, s86, 24576
mvav 180 140 100
exp 75 75
mvav 176 140 96
cvt 120 72 73
wl 4
mzvaa 48 80 0
cvt 121 74 75
add 76 23 76
mvaa 48 84 16
exp 76 76
mvaa 48 88 32
add 77 23 77
add 78 23 78
mvaa 48 92 48
tra 156 9 17408
add 79 23 79
mvav 192 144 96
exp 77 77
mvav 196 144 100
tra 158 9 17920
exp 78 78
mvav 200 144 104
exp 79 79
mvav 204 144 108
cvt 124 76 77
wl 4
mzvaa 52 92 52
cvt 125 78 79
add 80 20 80
mvaa 52 88 36
exp 80 80
mvaa 52 84 20
s_waitcnt vmcnt(6)
s_barrier
mvaa 52 80 4
s_add_u32 s80, s80, 8192
s_add_u32 m0, s65, 24576
mvav 220 148 108
rda 64 16 8192
add 81 20 81
mvav 216 148 104
dma 14 48 80 0
add 82 20 82
mvav 212 148 100
exp 81 81
mvav 208 148 96
rda 68 17 8192
wl 4
mzvaa 56 80 8
tra 128 6 24576
add 83 20 83
mvaa 56 84 24
tra 130 6 25088
exp 82 82
mvaa 56 88 40
exp 83 83
mvaa 56 92 56
rda 72 18 8192
cvt 114 80 81
mvav 224 152 96
cvt 115 82 83
add 84 21 84
mvav 228 152 100
exp 84 84
mvav 232 152 104
add 85 21 85
add 86 21 86
mvav 236 152 108
rda 76 19 8192
wl 6
mzvaa 60 92 60
tra 132 7 24576
add 87 21 87
mvaa 60 88 44
dma 15 48 80 1024
add 88 22 88
mvaa 60 84 28
tra 134 7 25088
exp 85 85
mvaa 60 80 12
exp 86 86
mvav 252 156 108
exp 87 87
mvav 248 156 104
exp 88 88
mvav 244 156 100
cvt 118 84 85
cvt 119 86 87
mvav 240 156 96
tra 136 8 24576
add 89 22 89
maav 224 240 96
exp 89 89
maav 228 240 100
tra 138 8 25088
add 90 22 90
maav 232 240 104
exp 90 90
maav 236 240 108
add 91 22 91
exp 91 91
cvt 122 88 89
cvt 123 90 91
add 92 23 92
add 93 23 93
add 94 23 94
add 95 23 95
exp 92 92
exp 93 93
exp 94 94
exp 95 95
cvt 126 92 93
cvt 127 94 95
wl 4
mzvaa 64 64 0
s_add_u32 s81, s81, 8192
s_add_u32 m0, s65, 40960
mvaa 64 68 16
dma 2 56 81 0
mvaa 64 72 32
add 32 20 32
add 33 20 33
mvaa 64 76 48
tra 140 9 24576
add 34 20 34
mvav 128 128 112
exp 32 32
mvav 132 128 116
tra 142 9 25088
add 35 20 35
mvav 136 128 120
exp 33 33
mvav 140 128 124
rda 80 16 12288
wl 5
mzvaa 68 76 52
exp 34 34
mvaa 68 72 36
exp 35 35
mvaa 68 68 20
cvt 96 32 33
cvt 97 34 35
mvaa 68 64 4
rda 84 17 12288
add 36 21 36
mvav 156 132 124
tra 144 6 25600
add 37 21 37
mvav 152 132 120
tra 146 6 26112
add 38 21 38
mvav 148 132 116
dma 3 56 81 1024
mvav 144 132 112
rda 88 18 12288
wl 7
mzvaa 72 64 8
exp 36 36
mvaa 72 68 24
exp 37 37
mvaa 72 72 40
exp 38 38
mvaa 72 76 56
rda 92 19 12288
add 39 21 39
mvav 160 136 112
tra 148 7 25600
exp 39 39
mvav 164 136 116
buffer_load_dword v0, v24, s[52:55], s86 offen
cvt 100 36 37
mvav 168 136 120
tra 150 7 26112
cvt 101 38 39
mvav 172 136 124
add 40 22 40
wl 8
mzvaa 76 76 60
exp 40 40
mvaa 76 72 44
add 41 22 41
add 42 22 42
mvaa 76 68 28
exp 41 41
mvaa 76 64 12
tra 152 8 25600
add 43 22 43
mvav 188 140 124
exp 42 42
mvav 184 140 120
tra 154 8 26112
s_add_u32 s86, s86, 24576
mvav 180 140 116
exp 43 43
mvav 176 140 112
cvt 104 40 41
wl 4
mzvaa 80 80 0
cvt 105 42 43
add 44 23 44
mvaa 80 84 16
exp 44 44
mvaa 80 88 32
add 45 23 45
add 46 23 46
mvaa 80 92 48
tra 156 9 25600
add 47 23 47
mvav 192 144 112
exp 45 45
mvav 196 144 116
tra 158 9 26112
exp 46 46
mvav 200 144 120
exp 47 47
mvav 204 144 124
cvt 108 44 45
wl 4
mzvaa 84 92 52
cvt 109 46 47
add 48 20 48
mvaa 84 88 36
exp 48 48
mvaa 84 84 20
s_waitcnt vmcnt(6)
s_barrier
mvaa 84 80 4
s_add_u32 s80, s80, s82
s_add_u32 m0, s65, 0
mvav 220 148 124
rda 64 16 16384
add 49 20 49
mvav 216 148 120
dma 14 48 80 0
add 50 20 50
mvav 212 148 116
exp 49 49
mvav 208 148 112
rda 68 17 16384
wl 4
mzvaa 88 80 8
tra 128 6 0
add 51 20 51
mvaa 88 84 24
tra 130 6 512
exp 50 50
mvaa 88 88 40
exp 51 51
mvaa 88 92 56
rda 72 18 16384
cvt 98 48 49
mvav 224 152 112
cvt 99 50 51
add 52 21 52
mvav 228 152 116
exp 52 52
mvav 232 152 120
add 53 21 53
add 54 21 54
mvav 236 152 124
rda 76 19 16384
wl 6
mzvaa 92 92 60
tra 132 7 0
add 55 21 55
mvaa 92 88 44
dma 15 48 80 1024
add 56 22 56
mvaa 92 84 28
tra 134 7 512
exp 53 53
mvaa 92 80 12
exp 54 54
mvav 252 156 124
exp 55 55
mvav 248 156 120
exp 56 56
mvav 244 156 116
cvt 102 52 53
cvt 103 54 55
mvav 240 156 112
tra 136 8 0
add 57 22 57
maav 224 240 112
exp 57 57
maav 228 240 116
tra 138 8 512
add 58 22 58
maav 232 240 120
exp 58 58
maav 236 240 124
add 59 22 59
exp 59 59
cvt 106 56 57
cvt 107 58 59
add 60 23 60
add 61 23 61
add 62 23 62
add 63 23 63
exp 60 60
exp 61 61
exp 62 62
exp 63 63
cvt 110 60 61
cvt 111 62 63
wl 4
mzvaa 32 64 0
s_add_u32 s81, s81, 8192
s_add_u32 m0, s65, 49152
mvaa 32 68 16
dma 2 56 81 0
mvaa 32 72 32
add 64 20 64
add 65 20 65
mvaa 32 76 48
tra 140 9 0
add 66 20 66
mvav 128 128 96
exp 64 64
mvav 132 128 100
tra 142 9 512
add 67 20 67
mvav 136 128 104
exp 65 65
mvav 140 128 108
rda 80 16 20480
wl 5
mzvaa 36 76 52
exp 66 66
mvaa 36 72 36
exp 67 67
mvaa 36 68 20
cvt 112 64 65
cvt 113 66 67
mvaa 36 64 4
rda 84 17 20480
add 68 21 68
mvav 156 132 108
tra 144 6 1024
add 69 21 69
mvav 152 132 104
tra 146 6 1536
add 70 21 70
mvav 148 132 100
dma 3 56 81 1024
mvav 144 132 96
rda 88 18 20480
wl 7
mzvaa 40 64 8
exp 68 68
mvaa 40 68 24
exp 69 69
mvaa 40 72 40
exp 70 70
mvaa 40 76 56
rda 92 19 20480
add 71 21 71
mvav 160 136 96
tra 148 7 1024
exp 71 71
mvav 164 136 100
buffer_load_dword v0, v24, s[52:55], s86 offen
cvt 116 68 69
mvav 168 136 104
tra 150 7 1536
cvt 117 70 71
mvav 172 136 108
add 72 22 72
wl 8
mzvaa 44 76 60
exp 72 72
mvaa 44 72 44
add 73 22 73
add 74 22 74
mvaa 44 68 28
exp 73 73
mvaa 44 64 12
tra 152 8 1024
add 75 22 75
mvav 188 140 108
exp 74 74
mvav 184 140 104
tra 154 8 1536
s_add_u32 s86, s86, 24576
mvav 180 140 100
exp 75 75
mvav 176 140 96
cvt 120 72 73
wl 4
mzvaa 48 80 0
cvt 121 74 75
add 76 23 76
mvaa 48 84 16
exp 76 76
mvaa 48 88 32
add 77 23 77
add 78 23 78
mvaa 48 92 48
tra 156 9 1024
add 79 23 79
mvav 192 144 96
exp 77 77
mvav 196 144 100
tra 158 9 1536
exp 78 78
mvav 200 144 104
exp 79 79
mvav 204 144 108
cvt 124 76 77
wl 4
mzvaa 52 92 52
cvt 125 78 79
add 80 20 80
mvaa 52 88 36
exp 80 80
mvaa 52 84 20
s_waitcnt vmcnt(6)
s_barrier
mvaa 52 80 4
s_add_u32 s80, s80, 8192
s_add_u32 m0, s65, 8192
mvav 220 148 108
rda 64 16 24576
add 81 20 81
mvav 216 148 104
dma 14 48 80 0
add 82 20 82
mvav 212 148 100
exp 81 81
mvav 208 148 96
rda 68 17 24576
wl 4
mzvaa 56 80 8
tra 128 6 8192
add 83 20 83
mvaa 56 84 24
tra 130 6 8704
exp 82 82
mvaa 56 88 40
exp 83 83
mvaa 56 92 56
rda 72 18 24576
cvt 114 80 81
mvav 224 152 96
cvt 115 82 83
add 84 21 84
mvav 228 152 100
exp 84 84
mvav 232 152 104
add 85 21 85
add 86 21 86
mvav 236 152 108
rda 76 19 24576
wl 6
mzvaa 60 92 60
tra 132 7 8192
add 87 21 87
mvaa 60 88 44
dma 15 48 80 1024
add 88 22 88
mvaa 60 84 28
tra 134 7 8704
exp 85 85
mvaa 60 80 12
exp 86 86
mvav 252 156 108
exp 87 87
mvav 248 156 104
exp 88 88
mvav 244 156 100
cvt 118 84 85
cvt 119 86 87
mvav 240 156 96
tra 136 8 8192
add 89 22 89
maav 224 240 96
exp 89 89
maav 228 240 100
tra 138 8 8704
add 90 22 90
maav 232 240 104
exp 90 90
maav 236 240 108
add 91 22 91
exp 91 91
cvt 122 88 89
cvt 123 90 91
add 92 23 92
add 93 23 93
add 94 23 94
add 95 23 95
exp 92 92
exp 93 93
exp 94 94
exp 95 95
cvt 126 92 93
cvt 127 94 95
add 32 20 32
add 33 20 33
wl 4
s_sub_u32 s68, s68, 1
s_cbranch_scc0 L_att_s
mzvaa 64 64 0
s_add_u32 s81, s81, 8192
s_add_u32 m0, s65, 57344
mvaa 64 68 16
dma 2 56 81 0
s_mov_b32 s82, 8192
mvaa 64 72 32
exp 32 32
mvaa 64 76 48
tra 140 9 8192
add 34 20 34
mvav 128 128 112
exp 33 33
mvav 132 128 116
tra 142 9 8704
add 35 20 35
mvav 136 128 120
exp 34 34
mvav 140 128 124
rda 80 16 28672
wl 5
mzvaa 68 76 52
exp 35 35
mvaa 68 72 36
s_mov_b32 s77, 0x4e800000
s_mov_b32 s84, 0x30800000
mvaa 68 68 20
s_lshl_b32 s85, s64, 2
s_add_u32 s85, s85, 98240
mvaa 68 64 4
rda 84 17 28672
cvt 96 32 33
mvav 156 132 124
tra 144 6 9216
cvt 97 34 35
mvav 152 132 120
tra 146 6 9728
add 36 21 36
mvav 148 132 116
dma 3 56 81 1024
add 37 21 37
mvav 144 132 112
rda 88 18 28672
wl 7
mzvaa 72 64 8
exp 36 36
mvaa 72 68 24
exp 37 37
mvaa 72 72 40
add 38 21 38
add 39 21 39
mvaa 72 76 56
rda 92 19 28672
exp 38 38
mvav 160 136 112
tra 148 7 9216
exp 39 39
mvav 164 136 116
tra 150 7 9728
cvt 100 36 37
mvav 168 136 120
cvt 101 38 39
add 40 22 40
mvav 172 136 124
add 41 22 41
wl 8
mzvaa 76 76 60
exp 40 40
mvaa 76 72 44
exp 41 41
mvaa 76 68 28
add 42 22 42
add 43 22 43
mvaa 76 64 12
tra 152 8 9216
exp 42 42
mvav 188 140 124
exp 43 43
mvav 184 140 120
tra 154 8 9728
cvt 104 40 41
mvav 180 140 116
cvt 105 42 43
add 44 23 44
mvav 176 140 112
add 45 23 45
wl 4
mzvaa 80 80 0
exp 44 44
mvaa 80 84 16
exp 45 45
mvaa 80 88 32
add 46 23 46
add 47 23 47
mvaa 80 92 48
rda 0 27 0
exp 46 46
mvav 192 144 112
tra 156 9 9216
exp 47 47
mvav 196 144 116
rda 16 27 4096
cvt 108 44 45
mvav 200 144 120
tra 158 9 9728
cvt 109 46 47
mvav 204 144 124
rda 32 27 8192
wl 7
mzvaa 84 92 52
rda 48 27 12288
add 48 20 48
mvaa 84 88 36
exp 48 48
mvaa 84 84 20
s_waitcnt vmcnt(5)
s_barrier
mvaa 84 80 4
rda 4 27 1024
s_add_u32 s80, s80, 8192
mvav 220 148 124
s_add_u32 m0, s65, 16384
rda 64 16 0
mvav 216 148 120
dma 14 48 80 0
add 49 20 49
mvav 212 148 116
rda 20 27 5120
add 50 20 50
mvav 208 148 112
rda 36 27 9216
wl 10
mzvaa 88 80 8
rda 68 17 0
add 51 20 51
mvaa 88 84 24
tra 128 6 16384
exp 49 49
mvaa 88 88 40
rda 52 27 13312
exp 50 50
mvaa 88 92 56
tra 130 6 16896
exp 51 51
mvav 224 152 112
rda 8 27 2048
cvt 98 48 49
mvav 228 152 116
rda 72 18 0
cvt 99 50 51
mvav 232 152 120
rda 24 27 6144
add 52 21 52
mvav 236 152 124
rda 40 27 10240
wl 14
mzvaa 92 92 60
rda 76 19 0
add 53 21 53
mvaa 92 88 44
tra 132 7 16384
add 54 21 54
mvaa 92 84 28
rda 56 27 14336
add 55 21 55
mvaa 92 80 12
dma 15 48 80 1024
add 56 22 56
mvav 252 156 124
tra 134 7 16896
exp 52 52
mvav 248 156 120
rda 12 27 3072
exp 53 53
mvav 244 156 116
rda 28 27 7168
exp 54 54
mvav 240 156 112
rda 44 27 11264
exp 55 55
maav 224 240 112
tra 136 8 16384
cvt 102 52 53
maav 228 240 116
rda 60 27 15360
cvt 103 54 55
maav 232 240 120
tra 138 8 16896
add 57 22 57
maav 236 240 124
add 58 22 58
add 59 22 59
exp 56 56
exp 57 57
exp 58 58
exp 59 59
cvt 106 56 57
cvt 107 58 59
add 60 23 60
add 61 23 61
add 62 23 62
add 63 23 63
exp 60 60
exp 61 61
exp 62 62
exp 63 63
cvt 110 60 61
cvt 111 62 63
wl 9
mzvaa 32 64 0
s_add_u32 s81, s81, 401408
s_add_u32 m0, s65, 32768
mvaa 32 68 16
dma 2 56 81 0
mvaa 32 72 32
add 64 20 64
add 65 20 65
mvaa 32 76 48
tra 140 9 16384
add 66 20 66
mvav 128 128 96
exp 64 64
mvav 132 128 100
tra 142 9 16896
add 67 20 67
mvav 136 128 104
exp 65 65
mvav 140 128 108
rda 80 16 4096
wl 9
mzvaa 36 76 52
exp 66 66
mvaa 36 72 36
exp 67 67
mvaa 36 68 20
cvt 112 64 65
cvt 113 66 67
mvaa 36 64 4
rda 84 17 4096
add 68 21 68
mvav 156 132 108
tra 144 6 17408
add 69 21 69
mvav 152 132 104
tra 146 6 17920
add 70 21 70
mvav 148 132 100
dma 3 56 81 1024
mvav 144 132 96
rda 88 18 4096
wl 7
mzvaa 40 64 8
exp 68 68
mvaa 40 68 24
exp 69 69
mvaa 40 72 40
exp 70 70
mvaa 40 76 56
rda 92 19 4096
add 71 21 71
mvav 160 136 96
tra 148 7 17408
exp 71 71
mvav 164 136 100
tra 150 7 17920
cvt 116 68 69
mvav 168 136 104
cvt 117 70 71
add 72 22 72
mvav 172 136 108
add 73 22 73
wl 8
mzvaa 44 76 60
exp 72 72
mvaa 44 72 44
exp 73 73
mvaa 44 68 28
add 74 22 74
add 75 22 75
mvaa 44 64 12
tra 152 8 17408
exp 74 74
mvav 188 140 108
exp 75 75
mvav 184 140 104
tra 154 8 17920
cvt 120 72 73
mvav 180 140 100
cvt 121 74 75
add 76 23 76
mvav 176 140 96
add 77 23 77
wl 4
mzvaa 48 80 0
exp 76 76
mvaa 48 84 16
exp 77 77
mvaa 48 88 32
add 78 23 78
add 79 23 79
mvaa 48 92 48
tra 156 9 17408
exp 78 78
mvav 192 144 96
exp 79 79
mvav 196 144 100
tra 158 9 17920
cvt 124 76 77
mvav 200 144 104
cvt 125 78 79
add 80 20 80
mvav 204 144 108
add 81 20 81
wl 4
mzvaa 52 92 52
exp 80 80
mvaa 52 88 36
exp 81 81
mvaa 52 84 20
s_waitcnt vmcnt(4)
s_barrier
mvaa 52 80 4
s_add_u32 s80, s80, 8192
s_add_u32 m0, s65, 24576
mvav 220 148 108
dma 14 48 80 0
add 82 20 82
mvav 216 148 104
exp 82 82
mvav 212 148 100
add 83 20 83
exp 83 83
mvav 208 148 96
tra 128 6 24576
wl 3
mzvaa 56 80 8
cvt 114 80 81
cvt 115 82 83
mvaa 56 84 24
tra 130 6 25088
add 84 21 84
mvaa 56 88 40
exp 84 84
mvaa 56 92 56
tra 132 7 24576
add 85 21 85
mvav 224 152 96
exp 85 85
mvav 228 152 100
tra 134 7 25088
add 86 21 86
mvav 232 152 104
exp 86 86
mvav 236 152 108
tra 136 8 24576
wl 5
mzvaa 60 92 60
dma 15 48 80 1024
add 87 21 87
mvaa 60 88 44
tra 138 8 25088
exp 87 87
mvaa 60 84 28
cvt 118 84 85
cvt 119 86 87
mvaa 60 80 12
tra 140 9 24576
add 88 22 88
mvav 252 156 108
exp 88 88
mvav 248 156 104
tra 142 9 25088
add 89 22 89
mvav 244 156 100
exp 89 89
mvav 240 156 96
tra 144 6 25600
add 90 22 90
maav 224 240 96
exp 90 90
maav 228 240 100
add 91 22 91
exp 91 91
cvt 122 88 89
cvt 123 90 91
add 92 23 92
add 93 23 93
add 94 23 94
add 95 23 95
exp 92 92
exp 93 93
exp 94 94
exp 95 95
cvt 126 92 93
cvt 127 94 95
maav 232 240 104
tra 146 6 26112
maav 236 240 108
v_accvgpr_read_b32 v20, a96
v_accvgpr_read_b32 v21, a97
v_accvgpr_read_b32 v22, a98
v_accvgpr_read_b32 v23, a99
wl 8
maav 224 240 112
tra 148 7 25600
s_add_u32 s81, s81, 8192
maav 228 240 116
s_add_u32 m0, s65, 40960
tra 150 7 26112
maav 232 240 120
dma 2 56 81 0
maav 236 240 124
tra 152 8 25600
add 32 20 32
mvav 128 128 112
exp 32 32
mvav 132 128 116
tra 154 8 26112
add 33 20 33
mvav 136 128 120
exp 33 33
mvav 140 128 124
tra 156 9 25600
wl 9
mvav 156 132 124
add 34 20 34
add 35 20 35
mvav 152 132 120
tra 158 9 26112
cvt 96 32 33
mvav 148 132 116
exp 34 34
mvav 144 132 112
rda 64 16 8192
exp 35 35
mvav 160 136 112
cvt 97 34 35
v_accvgpr_read_b32 v10, a224
mvav 164 136 116
rcp 10 10
mvav 168 136 120
dma 3 56 81 1024
v_accvgpr_read_b32 v11, a228
mvav 172 136 124
rda 68 17 8192
wl 8
mvav 188 140 124
rcp 11 11
mvav 184 140 120
v_accvgpr_read_b32 v12, a232
add 36 21 36
mvav 180 140 116
exp 36 36
mvav 176 140 112
rda 72 18 8192
add 37 21 37
mvav 192 144 112
rcp 12 12
mvav 196 144 116
exp 37 37
mvav 200 144 120
v_accvgpr_read_b32 v13, a236
add 38 21 38
mvav 204 144 124
rda 76 19 8192
wl 6
mvav 220 148 124
rcp 13 13
mvav 216 148 120
exp 38 38
mvav 212 148 116
add 39 21 39
exp 39 39
mvav 208 148 112
rda 80 16 12288
cvt 100 36 37
mvav 224 152 112
mul 128 10 128
mul 129 10 129
mvav 228 152 116
mul 130 10 130
mul 131 10 131
mvav 232 152 120
mul 144 10 144
mul 145 10 145
mvav 236 152 124
rda 84 17 12288
wl 2
mvav 252 156 124
mul 146 10 146
mul 147 10 147
mvav 248 156 120
cvt 128 128 129
cvt 101 38 39
mvav 244 156 116
add 40 22 40
cvt 129 130 131
mvav 240 156 112
rda 88 18 12288
cvt 130 144 145
mzvaa 64 64 0
exp 40 40
mvaa 64 68 16
add 41 22 41
add 42 22 42
mvaa 64 72 32
exp 41 41
mvaa 64 76 48
rda 92 19 12288
mzvaa 68 76 52
exp 42 42
mvaa 68 72 36
cvt 131 146 147
add 43 22 43
mvaa 68 68 20
s_waitcnt vmcnt(4)
s_barrier
mvaa 68 64 4
ds_write_b128 v27, v[128:131] offset:0
mzvaa 72 64 8
s_add_u32 s80, s80, s82
s_add_u32 m0, s65, 0
mvaa 72 68 24
dma 14 48 80 0
mul 132 11 132
mvaa 72 72 40
exp 43 43
mvaa 72 76 56
mul 133 11 133
wl 1
mzvaa 76 76 60
mul 134 11 134
mul 135 11 135
mvaa 76 72 44
mul 148 11 148
mul 149 11 149
mvaa 76 68 28
mul 150 11 150
mul 151 11 151
mvaa 76 64 12
rda 64 16 16384
cvt 104 40 41
mzvaa 80 80 0
rda 68 17 16384
cvt 132 132 133
mvaa 80 84 16
rda 72 18 16384
cvt 133 134 135
mvaa 80 88 32
cvt 105 42 43
cvt 134 148 149
mvaa 80 92 48
rda 76 19 16384
mzvaa 84 92 52
dma 15 48 80 1024
cvt 135 150 151
mvaa 84 88 36
ds_write_b128 v27, v[132:135] offset:1024
mvaa 84 84 20
add 44 23 44
add 45 23 45
mvaa 84 80 4
exp 44 44
mzvaa 88 80 8
exp 45 45
mvaa 88 84 24
add 46 23 46
add 47 23 47
mvaa 88 88 40
exp 46 46
mvaa 88 92 56
mul 136 12 136
mzvaa 92 92 60
exp 47 47
mvaa 92 88 44
mul 137 12 137
mul 138 12 138
mvaa 92 84 28
mul 139 12 139
mul 152 12 152
mvaa 92 80 12
cvt 108 44 45
cvt 109 46 47
add 48 20 48
add 49 20 49
add 50 20 50
add 51 20 51
exp 48 48
exp 49 49
exp 50 50
exp 51 51
cvt 98 48 49
cvt 99 50 51
add 52 21 52
add 53 21 53
add 54 21 54
add 55 21 55
exp 52 52
exp 53 53
exp 54 54
exp 55 55
cvt 102 52 53
cvt 103 54 55
add 56 22 56
add 57 22 57
add 58 22 58
add 59 22 59
exp 56 56
exp 57 57
exp 58 58
exp 59 59
cvt 106 56 57
cvt 107 58 59
add 60 23 60
add 61 23 61
add 62 23 62
add 63 23 63
exp 60 60
exp 61 61
exp 62 62
exp 63 63
cvt 110 60 61
cvt 111 62 63
wl 1
mzvaa 32 64 0
rda 80 16 20480
s_add_u32 s81, s81, 8192
mvaa 32 68 16
rda 84 17 20480
s_add_u32 m0, s65, 49152
mvaa 32 72 32
rda 88 18 20480
mul 153 12 153
mvaa 32 76 48
dma 2 56 81 0
mul 154 12 154
mzvaa 36 76 52
rda 92 19 20480
mul 155 12 155
mvaa 36 72 36
cvt 136 136 137
cvt 137 138 139
mvaa 36 68 20
cvt 138 152 153
cvt 139 154 155
mvaa 36 64 4
tra 128 6 0
mzvaa 40 64 8
ds_write_b128 v27, v[136:139] offset:2048
mvaa 40 68 24
tra 130 6 512
mul 140 13 140
mvaa 40 72 40
mul 141 13 141
mul 142 13 142
mvaa 40 76 56
tra 132 7 0
mul 143 13 143
mzvaa 44 76 60
mul 156 13 156
mul 157 13 157
mvaa 44 72 44
tra 134 7 512
mul 158 13 158
mvaa 44 68 28
dma 3 56 81 1024
mul 159 13 159
mvaa 44 64 12
tra 136 8 0
wl 6
mzvaa 48 80 0
cvt 140 140 141
cvt 141 142 143
mvaa 48 84 16
tra 138 8 512
cvt 142 156 157
mvaa 48 88 32
cvt 143 158 159
mul 160 10 160
mvaa 48 92 48
ds_write_b128 v27, v[140:143] offset:3072
mzvaa 52 92 52
tra 140 9 0
mul 161 10 161
mvaa 52 88 36
tra 142 9 512
mul 162 10 162
mvaa 52 84 20
mul 163 10 163
mul 176 10 176
mvaa 52 80 4
tra 144 6 1024
mzvaa 56 80 8
mul 177 10 177
mul 178 10 178
mvaa 56 84 24
tra 146 6 1536
mul 179 10 179
mvaa 56 88 40
cvt 160 160 161
cvt 161 162 163
mvaa 56 92 56
tra 148 7 1024
cvt 162 176 177
mzvaa 60 92 60
cvt 163 178 179
mul 164 11 164
mvaa 60 88 44
ds_write_b128 v27, v[160:163] offset:4096
mvaa 60 84 28
tra 150 7 1536
mul 165 11 165
mvaa 60 80 12
tra 152 8 1024
wl 11
mzvav 128 128 96
mul 166 11 166
mul 167 11 167
mzvav 132 128 100
tra 154 8 1536
mul 180 11 180
mzvav 136 128 104
mul 181 11 181
mul 182 11 182
mzvav 140 128 108
tra 156 9 1024
mul 183 11 183
mzvav 156 132 108
cvt 164 164 165
cvt 165 166 167
mzvav 152 132 104
tra 158 9 1536
cvt 166 180 181
mzvav 148 132 100
cvt 167 182 183
mul 168 12 168
mzvav 144 132 96
ds_write_b128 v27, v[164:167] offset:5120
mul 169 12 169
v_pk_mul_f32 v[170:171], v[12:13], v[170:171] op_sel_hi:[0,1]
v_pk_mul_f32 v[184:185], v[12:13], v[184:185] op_sel_hi:[0,1]
v_pk_mul_f32 v[186:187], v[12:13], v[186:187] op_sel_hi:[0,1]
cvt 168 168 169
cvt 169 170 171
cvt 170 184 185
cvt 171 186 187
ds_write_b128 v27, v[168:171] offset:6144
v_pk_mul_f32 v[172:173], v[12:13], v[172:173] op_sel:[1,0] op_sel_hi:[1,1]
v_pk_mul_f32 v[174:175], v[12:13], v[174:175] op_sel:[1,0] op_sel_hi:[1,1]
v_pk_mul_f32 v[188:189], v[12:13], v[188:189] op_sel:[1,0] op_sel_hi:[1,1]
v_pk_mul_f32 v[190:191], v[12:13], v[190:191] op_sel:[1,0] op_sel_hi:[1,1]
cvt 172 172 173
cvt 173 174 175
cvt 174 188 189
cvt 175 190 191
ds_write_b128 v27, v[172:175] offset:7168
wl 12
mzvav 160 136 96
add 64 20 64
add 65 20 65
mzvav 164 136 100
exp 64 64
mzvav 168 136 104
s_waitcnt vmcnt(4)
s_barrier
mzvav 172 136 108
s_add_u32 s80, s80, 8192
s_add_u32 m0, s65, 8192
mzvav 188 140 108
rda 64 16 24576
add 66 20 66
mzvav 184 140 104
dma 14 48 80 0
add 67 20 67
mzvav 180 140 100
exp 65 65
mzvav 176 140 96
mul 192 10 192
mul 193 10 193
mul 194 10 194
mul 195 10 195
v_pk_mul_f32 v[208:209], v[10:11], v[208:209] op_sel_hi:[0,1]
v_pk_mul_f32 v[210:211], v[10:11], v[210:211] op_sel_hi:[0,1]
cvt 192 192 193
cvt 193 194 195
cvt 194 208 209
cvt 195 210 211
ds_write_b128 v27, v[192:195] offset:8192
v_pk_mul_f32 v[196:197], v[10:11], v[196:197] op_sel:[1,0] op_sel_hi:[1,1]
v_pk_mul_f32 v[198:199], v[10:11], v[198:199] op_sel:[1,0] op_sel_hi:[1,1]
v_pk_mul_f32 v[212:213], v[10:11], v[212:213] op_sel:[1,0] op_sel_hi:[1,1]
v_pk_mul_f32 v[214:215], v[10:11], v[214:215] op_sel:[1,0] op_sel_hi:[1,1]
cvt 196 196 197
cvt 197 198 199
cvt 198 212 213
cvt 199 214 215
ds_write_b128 v27, v[196:199] offset:9216
v_pk_mul_f32 v[200:201], v[12:13], v[200:201] op_sel_hi:[0,1]
v_pk_mul_f32 v[202:203], v[12:13], v[202:203] op_sel_hi:[0,1]
v_pk_mul_f32 v[216:217], v[12:13], v[216:217] op_sel_hi:[0,1]
v_pk_mul_f32 v[218:219], v[12:13], v[218:219] op_sel_hi:[0,1]
cvt 200 200 201
cvt 201 202 203
cvt 202 216 217
cvt 203 218 219
ds_write_b128 v27, v[200:203] offset:10240
v_pk_mul_f32 v[204:205], v[12:13], v[204:205] op_sel:[1,0] op_sel_hi:[1,1]
v_pk_mul_f32 v[206:207], v[12:13], v[206:207] op_sel:[1,0] op_sel_hi:[1,1]
v_pk_mul_f32 v[220:221], v[12:13], v[220:221] op_sel:[1,0] op_sel_hi:[1,1]
v_pk_mul_f32 v[222:223], v[12:13], v[222:223] op_sel:[1,0] op_sel_hi:[1,1]
cvt 204 204 205
cvt 205 206 207
cvt 206 220 221
cvt 207 222 223
ds_write_b128 v27, v[204:207] offset:11264
wl 12
mzvav 192 144 96
rda 68 17 24576
exp 66 66
mzvav 196 144 100
tra 128 6 8192
exp 67 67
mzvav 200 144 104
tra 130 6 8704
cvt 112 64 65
mzvav 204 144 108
rda 72 18 24576
cvt 113 66 67
mzvav 220 148 108
add 68 21 68
add 69 21 69
mzvav 216 148 104
exp 68 68
mzvav 212 148 100
exp 69 69
mzvav 208 148 96
mul 224 10 224
mul 225 10 225
mul 226 10 226
mul 227 10 227
v_pk_mul_f32 v[240:241], v[10:11], v[240:241] op_sel_hi:[0,1]
v_pk_mul_f32 v[242:243], v[10:11], v[242:243] op_sel_hi:[0,1]
cvt 224 224 225
cvt 225 226 227
cvt 226 240 241
cvt 227 242 243
ds_write_b128 v27, v[224:227] offset:12288
v_pk_mul_f32 v[228:229], v[10:11], v[228:229] op_sel:[1,0] op_sel_hi:[1,1]
v_pk_mul_f32 v[230:231], v[10:11], v[230:231] op_sel:[1,0] op_sel_hi:[1,1]
v_pk_mul_f32 v[244:245], v[10:11], v[244:245] op_sel:[1,0] op_sel_hi:[1,1]
v_pk_mul_f32 v[246:247], v[10:11], v[246:247] op_sel:[1,0] op_sel_hi:[1,1]
cvt 228 228 229
cvt 229 230 231
cvt 230 244 245
cvt 231 246 247
ds_write_b128 v27, v[228:231] offset:13312
v_pk_mul_f32 v[232:233], v[12:13], v[232:233] op_sel_hi:[0,1]
v_pk_mul_f32 v[234:235], v[12:13], v[234:235] op_sel_hi:[0,1]
v_pk_mul_f32 v[248:249], v[12:13], v[248:249] op_sel_hi:[0,1]
v_pk_mul_f32 v[250:251], v[12:13], v[250:251] op_sel_hi:[0,1]
cvt 232 232 233
cvt 233 234 235
cvt 234 248 249
cvt 235 250 251
ds_write_b128 v27, v[232:235] offset:14336
v_pk_mul_f32 v[236:237], v[12:13], v[236:237] op_sel:[1,0] op_sel_hi:[1,1]
v_pk_mul_f32 v[238:239], v[12:13], v[238:239] op_sel:[1,0] op_sel_hi:[1,1]
v_pk_mul_f32 v[252:253], v[12:13], v[252:253] op_sel:[1,0] op_sel_hi:[1,1]
v_pk_mul_f32 v[254:255], v[12:13], v[254:255] op_sel:[1,0] op_sel_hi:[1,1]
cvt 236 236 237
cvt 237 238 239
cvt 238 252 253
cvt 239 254 255
ds_write_b128 v27, v[236:239] offset:15360
wl 15
mzvav 224 152 96
rda 76 19 24576
add 70 21 70
mzvav 228 152 100
tra 132 7 8192
add 71 21 71
mzvav 232 152 104
dma 15 48 80 1024
cvt 116 68 69
mzvav 236 152 108
tra 134 7 8704
exp 70 70
mzvav 252 156 108
exp 71 71
mzvav 248 156 104
cvt 117 70 71
add 72 22 72
mzvav 244 156 100
exp 72 72
mzvav 240 156 96
tra 136 8 8192
add 73 22 73
mzaav 224 240 96
exp 73 73
mzaav 228 240 100
tra 138 8 8704
add 74 22 74
mzaav 232 240 104
exp 74 74
mzaav 236 240 108
add 75 22 75
exp 75 75
cvt 120 72 73
cvt 121 74 75
add 76 23 76
add 77 23 77
add 78 23 78
add 79 23 79
exp 76 76
exp 77 77
exp 78 78
exp 79 79
cvt 124 76 77
cvt 125 78 79
add 80 20 80
add 81 20 81
add 82 20 82
add 83 20 83
exp 80 80
exp 81 81
exp 82 82
exp 83 83
cvt 114 80 81
cvt 115 82 83
add 84 21 84
add 85 21 85
add 86 21 86
add 87 21 87
exp 84 84
exp 85 85
exp 86 86
exp 87 87
cvt 118 84 85
cvt 119 86 87
add 88 22 88
add 89 22 89
add 90 22 90
add 91 22 91
exp 88 88
exp 89 89
exp 90 90
exp 91 91
cvt 122 88 89
cvt 123 90 91
add 92 23 92
add 93 23 93
add 94 23 94
add 95 23 95
exp 92 92
exp 93 93
exp 94 94
exp 95 95
cvt 126 92 93
cvt 127 94 95
v_mov_b32 v10, v4
add 32 20 32
add 33 20 33
wl 4
s_mov_b32 s68, 2
.p2align 3
L_att2_s:
mzvaa 64 64 0
s_add_u32 s81, s81, 8192
s_add_u32 m0, s65, 57344
mvaa 64 68 16
dma 2 56 81 0
mvaa 64 72 32
exp 32 32
mvaa 64 76 48
tra 140 9 8192
add 34 20 34
mvav 128 128 112
exp 33 33
mvav 132 128 116
tra 142 9 8704
add 35 20 35
mvav 136 128 120
exp 34 34
mvav 140 128 124
rda 80 16 28672
wl 5
mzvaa 68 76 52
exp 35 35
mvaa 68 72 36
s_cmp_eq_u32 s68, 0
s_cselect_b32 s82, 401408, s87
mvaa 68 68 20
cvt 96 32 33
cvt 97 34 35
mvaa 68 64 4
rda 84 17 28672
add 36 21 36
mvav 156 132 124
tra 144 6 9216
add 37 21 37
mvav 152 132 120
tra 146 6 9728
add 38 21 38
mvav 148 132 116
dma 3 56 81 1024
mvav 144 132 112
rda 88 18 28672
wl 7
mzvaa 72 64 8
exp 36 36
mvaa 72 68 24
exp 37 37
mvaa 72 72 40
exp 38 38
mvaa 72 76 56
rda 92 19 28672
add 39 21 39
mvav 160 136 112
tra 148 7 9216
exp 39 39
mvav 164 136 116
buffer_load_dword v0, v24, s[52:55], s86 offen
cvt 100 36 37
mvav 168 136 120
tra 150 7 9728
cvt 101 38 39
mvav 172 136 124
add 40 22 40
wl 8
mzvaa 76 76 60
exp 40 40
mvaa 76 72 44
add 41 22 41
add 42 22 42
mvaa 76 68 28
exp 41 41
mvaa 76 64 12
tra 152 8 9216
add 43 22 43
mvav 188 140 124
exp 42 42
mvav 184 140 120
tra 154 8 9728
s_add_u32 s86, s86, 24576
mvav 180 140 116
exp 43 43
mvav 176 140 112
cvt 104 40 41
wl 4
mzvaa 80 80 0
cvt 105 42 43
add 44 23 44
mvaa 80 84 16
exp 44 44
mvaa 80 88 32
add 45 23 45
add 46 23 46
mvaa 80 92 48
tra 156 9 9216
add 47 23 47
mvav 192 144 112
exp 45 45
mvav 196 144 116
tra 158 9 9728
exp 46 46
mvav 200 144 120
exp 47 47
mvav 204 144 124
cvt 108 44 45
wl 4
mzvaa 84 92 52
cvt 109 46 47
add 48 20 48
mvaa 84 88 36
exp 48 48
mvaa 84 84 20
s_waitcnt vmcnt(5)
s_barrier
mvaa 84 80 4
s_add_u32 s80, s80, 8192
s_add_u32 m0, s65, 16384
mvav 220 148 124
rda 64 16 0
add 49 20 49
mvav 216 148 120
dma 14 48 80 0
add 50 20 50
mvav 212 148 116
exp 49 49
mvav 208 148 112
rda 68 17 0
wl 4
mzvaa 88 80 8
tra 128 6 16384
add 51 20 51
mvaa 88 84 24
tra 130 6 16896
exp 50 50
mvaa 88 88 40
exp 51 51
mvaa 88 92 56
rda 72 18 0
cvt 98 48 49
mvav 224 152 112
cvt 99 50 51
add 52 21 52
mvav 228 152 116
exp 52 52
mvav 232 152 120
add 53 21 53
add 54 21 54
mvav 236 152 124
rda 76 19 0
wl 6
mzvaa 92 92 60
tra 132 7 16384
add 55 21 55
mvaa 92 88 44
dma 15 48 80 1024
add 56 22 56
mvaa 92 84 28
tra 134 7 16896
exp 53 53
mvaa 92 80 12
exp 54 54
mvav 252 156 124
exp 55 55
mvav 248 156 120
exp 56 56
mvav 244 156 116
cvt 102 52 53
cvt 103 54 55
mvav 240 156 112
tra 136 8 16384
add 57 22 57
maav 224 240 112
exp 57 57
maav 228 240 116
tra 138 8 16896
add 58 22 58
maav 232 240 120
exp 58 58
maav 236 240 124
add 59 22 59
exp 59 59
cvt 106 56 57
cvt 107 58 59
add 60 23 60
add 61 23 61
add 62 23 62
add 63 23 63
exp 60 60
exp 61 61
exp 62 62
exp 63 63
cvt 110 60 61
cvt 111 62 63
wl 4
mzvaa 32 64 0
s_add_u32 s81, s81, 8192
s_add_u32 m0, s65, 32768
mvaa 32 68 16
dma 2 56 81 0
mvaa 32 72 32
add 64 20 64
add 65 20 65
mvaa 32 76 48
tra 140 9 16384
add 66 20 66
mvav 128 128 96
exp 64 64
mvav 132 128 100
tra 142 9 16896
add 67 20 67
mvav 136 128 104
exp 65 65
mvav 140 128 108
rda 80 16 4096
wl 5
mzvaa 36 76 52
exp 66 66
mvaa 36 72 36
exp 67 67
mvaa 36 68 20
cvt 112 64 65
cvt 113 66 67
mvaa 36 64 4
rda 84 17 4096
add 68 21 68
mvav 156 132 108
tra 144 6 17408
add 69 21 69
mvav 152 132 104
tra 146 6 17920
add 70 21 70
mvav 148 132 100
dma 3 56 81 1024
mvav 144 132 96
rda 88 18 4096
wl 7
mzvaa 40 64 8
exp 68 68
mvaa 40 68 24
exp 69 69
mvaa 40 72 40
exp 70 70
mvaa 40 76 56
rda 92 19 4096
add 71 21 71
mvav 160 136 96
tra 148 7 17408
exp 71 71
mvav 164 136 100
buffer_load_dword v0, v24, s[52:55], s86 offen
cvt 116 68 69
mvav 168 136 104
tra 150 7 17920
cvt 117 70 71
mvav 172 136 108
add 72 22 72
wl 8
mzvaa 44 76 60
exp 72 72
mvaa 44 72 44
add 73 22 73
add 74 22 74
mvaa 44 68 28
exp 73 73
mvaa 44 64 12
tra 152 8 17408
add 75 22 75
mvav 188 140 108
exp 74 74
mvav 184 140 104
tra 154 8 17920
s_add_u32 s86, s86, 24576
mvav 180 140 100
exp 75 75
mvav 176 140 96
cvt 120 72 73
wl 4
mzvaa 48 80 0
cvt 121 74 75
add 76 23 76
mvaa 48 84 16
exp 76 76
mvaa 48 88 32
add 77 23 77
add 78 23 78
mvaa 48 92 48
tra 156 9 17408
add 79 23 79
mvav 192 144 96
exp 77 77
mvav 196 144 100
tra 158 9 17920
exp 78 78
mvav 200 144 104
exp 79 79
mvav 204 144 108
cvt 124 76 77
wl 4
mzvaa 52 92 52
cvt 125 78 79
add 80 20 80
mvaa 52 88 36
exp 80 80
mvaa 52 84 20
s_waitcnt vmcnt(6)
s_barrier
mvaa 52 80 4
s_add_u32 s80, s80, 8192
s_add_u32 m0, s65, 24576
mvav 220 148 108
rda 64 16 8192
add 81 20 81
mvav 216 148 104
dma 14 48 80 0
add 82 20 82
mvav 212 148 100
exp 81 81
mvav 208 148 96
rda 68 17 8192
wl 4
mzvaa 56 80 8
tra 128 6 24576
add 83 20 83
mvaa 56 84 24
tra 130 6 25088
exp 82 82
mvaa 56 88 40
exp 83 83
mvaa 56 92 56
rda 72 18 8192
cvt 114 80 81
mvav 224 152 96
cvt 115 82 83
add 84 21 84
mvav 228 152 100
exp 84 84
mvav 232 152 104
add 85 21 85
add 86 21 86
mvav 236 152 108
rda 76 19 8192
wl 6
mzvaa 60 92 60
tra 132 7 24576
add 87 21 87
mvaa 60 88 44
dma 15 48 80 1024
add 88 22 88
mvaa 60 84 28
tra 134 7 25088
exp 85 85
mvaa 60 80 12
exp 86 86
mvav 252 156 108
exp 87 87
mvav 248 156 104
exp 88 88
mvav 244 156 100
cvt 118 84 85
cvt 119 86 87
mvav 240 156 96
tra 136 8 24576
add 89 22 89
maav 224 240 96
exp 89 89
maav 228 240 100
tra 138 8 25088
add 90 22 90
maav 232 240 104
exp 90 90
maav 236 240 108
add 91 22 91
exp 91 91
cvt 122 88 89
cvt 123 90 91
add 92 23 92
add 93 23 93
add 94 23 94
add 95 23 95
exp 92 92
exp 93 93
exp 94 94
exp 95 95
cvt 126 92 93
cvt 127 94 95
wl 4
mzvaa 64 64 0
s_add_u32 s81, s81, 8192
s_add_u32 m0, s65, 40960
mvaa 64 68 16
dma 2 56 81 0
mvaa 64 72 32
add 32 20 32
add 33 20 33
mvaa 64 76 48
tra 140 9 24576
add 34 20 34
mvav 128 128 112
exp 32 32
mvav 132 128 116
tra 142 9 25088
add 35 20 35
mvav 136 128 120
exp 33 33
mvav 140 128 124
rda 80 16 12288
wl 5
mzvaa 68 76 52
exp 34 34
mvaa 68 72 36
exp 35 35
mvaa 68 68 20
cvt 96 32 33
cvt 97 34 35
mvaa 68 64 4
rda 84 17 12288
add 36 21 36
mvav 156 132 124
tra 144 6 25600
add 37 21 37
mvav 152 132 120
tra 146 6 26112
add 38 21 38
mvav 148 132 116
dma 3 56 81 1024
mvav 144 132 112
rda 88 18 12288
wl 7
mzvaa 72 64 8
exp 36 36
mvaa 72 68 24
exp 37 37
mvaa 72 72 40
exp 38 38
mvaa 72 76 56
rda 92 19 12288
add 39 21 39
mvav 160 136 112
tra 148 7 25600
exp 39 39
mvav 164 136 116
buffer_load_dword v0, v24, s[52:55], s86 offen
cvt 100 36 37
mvav 168 136 120
tra 150 7 26112
cvt 101 38 39
mvav 172 136 124
add 40 22 40
wl 8
mzvaa 76 76 60
exp 40 40
mvaa 76 72 44
add 41 22 41
add 42 22 42
mvaa 76 68 28
exp 41 41
mvaa 76 64 12
tra 152 8 25600
add 43 22 43
mvav 188 140 124
exp 42 42
mvav 184 140 120
tra 154 8 26112
s_add_u32 s86, s86, 24576
mvav 180 140 116
exp 43 43
mvav 176 140 112
cvt 104 40 41
wl 4
mzvaa 80 80 0
cvt 105 42 43
add 44 23 44
mvaa 80 84 16
exp 44 44
mvaa 80 88 32
add 45 23 45
add 46 23 46
mvaa 80 92 48
tra 156 9 25600
add 47 23 47
mvav 192 144 112
exp 45 45
mvav 196 144 116
tra 158 9 26112
exp 46 46
mvav 200 144 120
exp 47 47
mvav 204 144 124
cvt 108 44 45
wl 4
mzvaa 84 92 52
cvt 109 46 47
add 48 20 48
mvaa 84 88 36
exp 48 48
mvaa 84 84 20
s_waitcnt vmcnt(6)
s_barrier
mvaa 84 80 4
s_add_u32 s80, s80, s82
s_add_u32 m0, s65, 0
mvav 220 148 124
rda 64 16 16384
add 49 20 49
mvav 216 148 120
dma 14 48 80 0
add 50 20 50
mvav 212 148 116
exp 49 49
mvav 208 148 112
rda 68 17 16384
wl 4
mzvaa 88 80 8
tra 128 6 0
add 51 20 51
mvaa 88 84 24
tra 130 6 512
exp 50 50
mvaa 88 88 40
exp 51 51
mvaa 88 92 56
rda 72 18 16384
cvt 98 48 49
mvav 224 152 112
cvt 99 50 51
add 52 21 52
mvav 228 152 116
exp 52 52
mvav 232 152 120
add 53 21 53
add 54 21 54
mvav 236 152 124
rda 76 19 16384
wl 6
mzvaa 92 92 60
tra 132 7 0
add 55 21 55
mvaa 92 88 44
dma 15 48 80 1024
add 56 22 56
mvaa 92 84 28
tra 134 7 512
exp 53 53
mvaa 92 80 12
exp 54 54
mvav 252 156 124
exp 55 55
mvav 248 156 120
exp 56 56
mvav 244 156 116
cvt 102 52 53
cvt 103 54 55
mvav 240 156 112
tra 136 8 0
add 57 22 57
maav 224 240 112
exp 57 57
maav 228 240 116
tra 138 8 512
add 58 22 58
maav 232 240 120
exp 58 58
maav 236 240 124
add 59 22 59
exp 59 59
cvt 106 56 57
cvt 107 58 59
add 60 23 60
add 61 23 61
add 62 23 62
add 63 23 63
exp 60 60
exp 61 61
exp 62 62
exp 63 63
cvt 110 60 61
cvt 111 62 63
wl 4
mzvaa 32 64 0
s_add_u32 s81, s81, 8192
s_add_u32 m0, s65, 49152
mvaa 32 68 16
dma 2 56 81 0
mvaa 32 72 32
add 64 20 64
add 65 20 65
mvaa 32 76 48
tra 140 9 0
add 66 20 66
mvav 128 128 96
exp 64 64
mvav 132 128 100
tra 142 9 512
add 67 20 67
mvav 136 128 104
exp 65 65
mvav 140 128 108
rda 80 16 20480
wl 5
mzvaa 36 76 52
exp 66 66
mvaa 36 72 36
exp 67 67
mvaa 36 68 20
cvt 112 64 65
cvt 113 66 67
mvaa 36 64 4
rda 84 17 20480
add 68 21 68
mvav 156 132 108
tra 144 6 1024
add 69 21 69
mvav 152 132 104
tra 146 6 1536
add 70 21 70
mvav 148 132 100
dma 3 56 81 1024
mvav 144 132 96
rda 88 18 20480
wl 7
mzvaa 40 64 8
exp 68 68
mvaa 40 68 24
exp 69 69
mvaa 40 72 40
exp 70 70
mvaa 40 76 56
rda 92 19 20480
add 71 21 71
mvav 160 136 96
tra 148 7 1024
exp 71 71
mvav 164 136 100
buffer_load_dword v0, v24, s[52:55], s86 offen
cvt 116 68 69
mvav 168 136 104
tra 150 7 1536
cvt 117 70 71
mvav 172 136 108
add 72 22 72
wl 8
mzvaa 44 76 60
exp 72 72
mvaa 44 72 44
add 73 22 73
add 74 22 74
mvaa 44 68 28
exp 73 73
mvaa 44 64 12
tra 152 8 1024
add 75 22 75
mvav 188 140 108
exp 74 74
mvav 184 140 104
tra 154 8 1536
s_add_u32 s86, s86, 24576
mvav 180 140 100
exp 75 75
mvav 176 140 96
cvt 120 72 73
wl 4
mzvaa 48 80 0
cvt 121 74 75
add 76 23 76
mvaa 48 84 16
exp 76 76
mvaa 48 88 32
add 77 23 77
add 78 23 78
mvaa 48 92 48
tra 156 9 1024
add 79 23 79
mvav 192 144 96
exp 77 77
mvav 196 144 100
tra 158 9 1536
exp 78 78
mvav 200 144 104
exp 79 79
mvav 204 144 108
cvt 124 76 77
wl 4
mzvaa 52 92 52
cvt 125 78 79
add 80 20 80
mvaa 52 88 36
exp 80 80
mvaa 52 84 20
s_waitcnt vmcnt(6)
s_barrier
mvaa 52 80 4
s_add_u32 s80, s80, 8192
s_add_u32 m0, s65, 8192
mvav 220 148 108
rda 64 16 24576
add 81 20 81
mvav 216 148 104
dma 14 48 80 0
add 82 20 82
mvav 212 148 100
exp 81 81
mvav 208 148 96
rda 68 17 24576
wl 4
mzvaa 56 80 8
tra 128 6 8192
add 83 20 83
mvaa 56 84 24
tra 130 6 8704
exp 82 82
mvaa 56 88 40
exp 83 83
mvaa 56 92 56
rda 72 18 24576
cvt 114 80 81
mvav 224 152 96
cvt 115 82 83
add 84 21 84
mvav 228 152 100
exp 84 84
mvav 232 152 104
add 85 21 85
add 86 21 86
mvav 236 152 108
rda 76 19 24576
wl 6
mzvaa 60 92 60
tra 132 7 8192
add 87 21 87
mvaa 60 88 44
dma 15 48 80 1024
add 88 22 88
mvaa 60 84 28
tra 134 7 8704
exp 85 85
mvaa 60 80 12
exp 86 86
mvav 252 156 108
exp 87 87
mvav 248 156 104
exp 88 88
mvav 244 156 100
cvt 118 84 85
cvt 119 86 87
mvav 240 156 96
tra 136 8 8192
add 89 22 89
maav 224 240 96
exp 89 89
maav 228 240 100
tra 138 8 8704
add 90 22 90
maav 232 240 104
exp 90 90
maav 236 240 108
add 91 22 91
exp 91 91
cvt 122 88 89
cvt 123 90 91
add 92 23 92
add 93 23 93
add 94 23 94
add 95 23 95
exp 92 92
exp 93 93
exp 94 94
exp 95 95
cvt 126 92 93
cvt 127 94 95
add 32 20 32
add 33 20 33
wl 4
s_sub_u32 s68, s68, 1
s_cbranch_scc0 L_att2_s
mzvaa 64 64 0
s_add_u32 s81, s81, 8192
s_add_u32 m0, s65, 57344
mvaa 64 68 16
dma 2 56 81 0
mvaa 64 72 32
exp 32 32
mvaa 64 76 48
tra 140 9 8192
add 34 20 34
mvav 128 128 112
exp 33 33
mvav 132 128 116
tra 142 9 8704
add 35 20 35
mvav 136 128 120
exp 34 34
mvav 140 128 124
rda 80 16 28672
wl 5
mzvaa 68 76 52
exp 35 35
mvaa 68 72 36
v_xor_b32 v11, 32, v10
v_add_u32 v12, 0x10000, v10
mvaa 68 68 20
v_add_u32 v13, 0x10000, v11
cvt 96 32 33
mvaa 68 64 4
rda 84 17 28672
cvt 97 34 35
mvav 156 132 124
tra 144 6 9216
add 36 21 36
mvav 152 132 120
tra 146 6 9728
add 37 21 37
mvav 148 132 116
dma 3 56 81 1024
add 38 21 38
mvav 144 132 112
rda 88 18 28672
wl 7
mzvaa 72 64 8
exp 36 36
mvaa 72 68 24
exp 37 37
mvaa 72 72 40
exp 38 38
mvaa 72 76 56
rda 92 19 28672
add 39 21 39
mvav 160 136 112
tra 148 7 9216
exp 39 39
mvav 164 136 116
tra 150 7 9728
cvt 100 36 37
mvav 168 136 120
cvt 101 38 39
add 40 22 40
mvav 172 136 124
add 41 22 41
wl 8
mzvaa 76 76 60
exp 40 40
mvaa 76 72 44
exp 41 41
mvaa 76 68 28
add 42 22 42
add 43 22 43
mvaa 76 64 12
tra 152 8 9216
exp 42 42
mvav 188 140 124
exp 43 43
mvav 184 140 120
tra 154 8 9728
cvt 104 40 41
mvav 180 140 116
cvt 105 42 43
add 44 23 44
mvav 176 140 112
add 45 23 45
wl 4
mzvaa 80 80 0
exp 44 44
mvaa 80 84 16
exp 45 45
mvaa 80 88 32
add 46 23 46
add 47 23 47
mvaa 80 92 48
tra 156 9 9216
exp 46 46
mvav 192 144 112
exp 47 47
mvav 196 144 116
tra 158 9 9728
cvt 108 44 45
mvav 200 144 120
cvt 109 46 47
add 48 20 48
mvav 204 144 124
add 49 20 49
wl 4
mzvaa 84 92 52
exp 48 48
mvaa 84 88 36
exp 49 49
mvaa 84 84 20
s_waitcnt vmcnt(5)
s_barrier
mvaa 84 80 4
s_mov_b32 s66, 0
s_add_u32 m0, s65, 65536
mvav 220 148 124
tra 128 6 16384
add 50 20 50
mvav 216 148 120
dma 30 52 66 0
add 51 20 51
mvav 212 148 116
tra 130 6 16896
exp 50 50
mvav 208 148 112
tra 132 7 16384
wl 5
mzvaa 88 80 8
dma 31 52 66 1024
cvt 98 48 49
mvaa 88 84 24
tra 134 7 16896
exp 51 51
mvaa 88 88 40
s_mov_b32 s66, 73728
s_add_u32 m0, s65, 73728
mvaa 88 92 56
tra 136 8 16384
cvt 99 50 51
mvav 224 152 112
dma 30 52 66 0
add 52 21 52
mvav 228 152 116
tra 138 8 16896
add 53 21 53
mvav 232 152 120
exp 52 52
mvav 236 152 124
tra 140 9 16384
wl 7
mzvaa 92 92 60
dma 31 52 66 1024
add 54 21 54
mvaa 92 88 44
tra 142 9 16896
add 55 21 55
mvaa 92 84 28
s_mov_b32 s66, 147456
s_add_u32 m0, s65, 81920
mvaa 92 80 12
tra 144 6 17408
exp 53 53
mvav 252 156 124
dma 30 52 66 0
cvt 102 52 53
mvav 248 156 120
tra 146 6 17920
exp 54 54
mvav 244 156 116
exp 55 55
mvav 240 156 112
tra 148 7 17408
cvt 103 54 55
maav 224 240 112
dma 31 52 66 1024
add 56 22 56
maav 228 240 116
tra 150 7 17920
add 57 22 57
maav 232 240 120
add 58 22 58
add 59 22 59
exp 56 56
exp 57 57
exp 58 58
exp 59 59
cvt 106 56 57
cvt 107 58 59
add 60 23 60
add 61 23 61
add 62 23 62
add 63 23 63
exp 60 60
exp 61 61
exp 62 62
exp 63 63
cvt 110 60 61
cvt 111 62 63
maav 236 240 124
s_mov_b32 s66, 221184
wl 8
mvav 128 128 96
s_add_u32 m0, s65, 16384
tra 152 8 17408
mvav 132 128 100
dma 30 52 66 0
mvav 136 128 104
tra 154 8 17920
add 64 20 64
mvav 140 128 108
rda 0 28 0
add 65 20 65
mvav 156 132 108
dma 31 52 66 1024
mvav 152 132 104
tra 156 9 17408
add 66 20 66
mvav 148 132 100
rda 4 28 1024
add 67 20 67
mvav 144 132 96
tra 158 9 17920
wl 10
mvav 160 136 96
rda 8 28 2048
exp 64 64
mvav 164 136 100
rda 12 28 3072
exp 65 65
mvav 168 136 104
rda 16 28 4096
exp 66 66
mvav 172 136 108
rda 20 28 5120
exp 67 67
mvav 188 140 108
cvt 112 64 65
cvt 113 66 67
mvav 184 140 104
rda 24 28 6144
add 68 21 68
mvav 180 140 100
exp 68 68
mvav 176 140 96
rda 28 28 7168
wl 12
mvav 192 144 96
s_waitcnt vmcnt(8)
s_barrier
mvav 196 144 100
tra 128 6 24576
s_mov_b32 s66, 128
mvav 200 144 104
s_add_u32 m0, s65, 32768
tra 130 6 25088
mvav 204 144 108
dma 30 52 66 0
add 69 21 69
mvav 220 148 108
rda 32 28 8192
add 70 21 70
mvav 216 148 104
tra 132 7 24576
add 71 21 71
mvav 212 148 100
rda 36 28 9216
exp 69 69
mvav 208 148 96
tra 134 7 25088
wl 12
mvav 224 152 96
dma 31 52 66 1024
cvt 116 68 69
mvav 228 152 100
rda 40 28 10240
s_mov_b32 s66, 73856
mvav 232 152 104
tra 136 8 24576
s_add_u32 m0, s65, 24576
mvav 236 152 108
rda 44 28 11264
exp 70 70
mvav 252 156 108
tra 138 8 25088
exp 71 71
mvav 248 156 104
rda 48 28 12288
cvt 117 70 71
mvav 244 156 100
dma 30 52 66 0
add 72 22 72
mvav 240 156 96
tra 140 9 24576
add 73 22 73
maav 224 240 96
rda 52 28 13312
add 74 22 74
maav 228 240 100
tra 142 9 25088
add 75 22 75
maav 232 240 104
exp 72 72
exp 73 73
exp 74 74
exp 75 75
cvt 120 72 73
cvt 121 74 75
add 76 23 76
add 77 23 77
add 78 23 78
add 79 23 79
exp 76 76
exp 77 77
exp 78 78
exp 79 79
cvt 124 76 77
cvt 125 78 79
add 80 20 80
add 81 20 81
add 82 20 82
add 83 20 83
exp 80 80
exp 81 81
exp 82 82
exp 83 83
cvt 114 80 81
cvt 115 82 83
add 84 21 84
add 85 21 85
add 86 21 86
add 87 21 87
exp 84 84
exp 85 85
exp 86 86
exp 87 87
cvt 118 84 85
cvt 119 86 87
add 88 22 88
add 89 22 89
add 90 22 90
add 91 22 91
exp 88 88
exp 89 89
exp 90 90
exp 91 91
cvt 122 88 89
cvt 123 90 91
add 92 23 92
add 93 23 93
add 94 23 94
add 95 23 95
exp 92 92
exp 93 93
exp 94 94
exp 95 95
cvt 126 92 93
cvt 127 94 95
maav 236 240 108
rda 56 28 14336
wl 13
maav 224 240 112
dma 31 52 66 1024
s_mov_b32 s66, 147584
maav 228 240 116
tra 144 6 25600
s_add_u32 m0, s65, 40960
maav 232 240 120
rda 60 28 15360
maav 236 240 124
tra 146 6 26112
mvav 128 128 112
rda 64 28 32768
mvav 132 128 116
tra 148 7 25600
mvav 136 128 120
rda 68 28 33792
mvav 140 128 124
dma 30 52 66 0
wl 11
mvav 156 132 124
tra 150 7 26112
rda 72 28 34816
mvav 152 132 120
tra 152 8 25600
v_accvgpr_read_b32 v16, a224
mvav 148 132 116
rda 76 28 35840
v_accvgpr_read_b32 v17, a228
mvav 144 132 112
dma 31 52 66 1024
mvav 160 136 112
tra 154 8 26112
rda 80 28 36864
mvav 164 136 116
tra 156 9 25600
v_accvgpr_read_b32 v18, a232
mvav 168 136 120
rda 84 28 37888
v_accvgpr_read_b32 v19, a236
mvav 172 136 124
tra 158 9 26112
wl 12
mvav 188 140 124
rda 88 28 38912
rcp 16 16
mvav 184 140 120
s_waitcnt vmcnt(10)
s_barrier
mvav 180 140 116
rda 92 28 39936
s_mov_b32 s66, 221312
mvav 176 140 112
rda 96 28 40960
s_add_u32 m0, s65, 0
mvav 192 144 112
rda 100 28 41984
rcp 17 17
mvav 196 144 116
rda 104 28 43008
rcp 18 18
mvav 200 144 120
trv 32 12 0
rcp 19 19
mvav 204 144 124
dma 30 52 66 0
wl 10
mvav 220 148 124
rda 108 28 44032
mul 128 16 128
mvav 216 148 120
trv 34 12 512
mul 129 16 129
mvav 212 148 116
rda 112 28 45056
mul 130 16 130
mvav 208 148 112
trv 36 12 1024
mul 131 16 131
mvav 224 152 112
dma 31 52 66 1024
s_mov_b32 s66, 294912
mvav 228 152 116
rda 116 28 46080
s_add_u32 m0, s65, 8192
mvav 232 152 120
trv 38 12 1536
mul 144 16 144
mvav 236 152 124
rda 120 28 47104
wl 13
mvav 252 156 124
trv 40 13 0
mul 145 16 145
mvav 248 156 120
dma 30 52 66 0
mul 146 16 146
mvav 244 156 116
rda 124 28 48128
mul 147 16 147
mvav 240 156 112
trv 42 13 512
wl 4
mzvva 64 32 0
trv 44 13 1024
cvt 128 128 129
mvva 64 36 16
dma 31 52 66 1024
s_mov_b32 s66, 368640
mzvva 68 36 20
trv 46 13 1536
s_add_u32 m0, s65, 49152
mvva 68 32 4
trv 48 13 8192
cvt 129 130 131
mzvva 72 32 8
dma 30 52 66 0
cvt 130 144 145
mvva 72 36 24
trv 50 13 8704
cvt 131 146 147
mzvva 76 36 28
trv 52 13 9216
mul 132 17 132
mvva 76 32 12
dma 31 52 66 1024
wl 3
mzvva 92 40 12
trv 54 13 9728
mul 133 17 133
mvva 92 44 28
trv 56 12 8192
mul 134 17 134
mzvva 88 44 24
trv 58 12 8704
mul 135 17 135
mvva 88 40 8
trv 60 12 9216
mul 148 17 148
mzvva 84 40 4
trv 62 12 9728
mul 149 17 149
mvva 84 44 20
s_waitcnt vmcnt(12)
s_barrier
mzvva 80 44 16
ds_write_b128 v27, v[128:131] offset:0
mvva 80 40 0
s_mov_b32 s66, 442368
wl 5
mvva 80 48 32
s_add_u32 m0, s65, 57344
trv 32 12 16384
mvva 80 52 48
dma 30 52 66 0
mul 150 17 150
mvva 84 52 52
trv 34 12 16896
mul 151 17 151
mvva 84 48 36
trv 36 12 17408
cvt 132 132 133
mvva 88 48 40
trv 38 12 17920
cvt 133 134 135
mvva 88 52 56
cvt 134 148 149
cvt 135 150 151
mvva 92 52 60
ds_write_b128 v27, v[132:135] offset:1024
mvva 92 48 44
trv 40 13 16384
wl 7
mvva 76 56 44
trv 42 13 16896
mul 136 18 136
mvva 76 60 60
mul 137 18 137
mul 138 18 138
mvva 72 60 56
trv 44 13 17408
mul 139 18 139
mvva 72 56 40
dma 31 52 66 1024
mul 152 18 152
mvva 68 56 36
trv 46 13 17920
mul 153 18 153
mvva 68 60 52
mul 154 18 154
mul 155 18 155
mvva 64 60 48
trv 48 11 16384
cvt 136 136 137
mvva 64 56 32
cvt 137 138 139
wl 6
mvva 64 32 64
trv 50 11 16896
cvt 138 152 153
mvva 64 36 80
cvt 139 154 155
mul 140 19 140
mvva 68 36 84
ds_write_b128 v27, v[136:139] offset:2048
mvva 68 32 68
trv 52 11 17408
mul 141 19 141
mvva 72 32 72
trv 54 11 17920
mul 142 19 142
mvva 72 36 88
mul 143 19 143
mul 156 19 156
mvva 76 36 92
trv 56 10 16384
mul 157 19 157
mvva 76 32 76
mul 158 19 158
wl 6
mvva 92 40 76
trv 58 10 16896
mul 159 19 159
mvva 92 44 92
cvt 140 140 141
cvt 141 142 143
mvva 88 44 88
trv 60 10 17408
cvt 142 156 157
mvva 88 40 72
cvt 143 158 159
mul 160 16 160
mvva 84 40 68
ds_write_b128 v27, v[140:143] offset:3072
mvva 84 44 84
s_waitcnt vmcnt(10)
s_barrier
mvva 80 44 80
trv 62 10 17920
s_mov_b32 s66, 516096
mvva 80 40 64
s_add_u32 m0, s65, 65536
wl 5
mvva 80 48 96
trv 32 10 32768
mul 161 16 161
mvva 80 52 112
dma 30 52 66 0
mul 162 16 162
mvva 84 52 116
trv 34 10 33280
mul 163 16 163
mvva 84 48 100
trv 36 10 33792
mul 176 16 176
mvva 88 48 104
trv 38 10 34304
mul 177 16 177
mvva 88 52 120
dma 31 52 66 1024
mul 178 16 178
mvva 92 52 124
trv 40 11 32768
mul 179 16 179
mvva 92 48 108
cvt 160 160 161
wl 5
mvva 76 56 108
trv 42 11 33280
cvt 161 162 163
mvva 76 60 124
s_mov_b32 s66, 295040
s_add_u32 m0, s65, 73728
mvva 72 60 120
trv 44 11 33792
cvt 162 176 177
mvva 72 56 104
dma 30 52 66 0
cvt 163 178 179
mvva 68 56 100
ds_write_b128 v27, v[160:163] offset:4096
mvva 68 60 116
trv 46 11 34304
mul 164 17 164
mvva 64 60 112
trv 48 11 24576
mul 165 17 165
mvva 64 56 96
mul 166 17 166
wl 6
mzvva 96 32 0
trv 50 11 25088
mul 167 17 167
mvva 96 36 16
dma 31 52 66 1024
mul 180 17 180
mzvva 100 36 20
trv 52 11 25600
mul 181 17 181
mvva 100 32 4
mul 182 17 182
mul 183 17 183
mzvva 104 32 8
trv 54 11 26112
cvt 164 164 165
mvva 104 36 24
cvt 165 166 167
cvt 166 180 181
mzvva 108 36 28
trv 56 10 24576
cvt 167 182 183
mvva 108 32 12
mul 168 18 168
wl 5
mzvva 124 40 12
ds_write_b128 v27, v[164:167] offset:5120
mvva 124 44 28
trv 58 10 25088
mul 169 18 169
mzvva 120 44 24
trv 60 10 25600
mul 170 18 170
mvva 120 40 8
mul 171 18 171
mul 184 18 184
mzvva 116 40 4
trv 62 10 26112
mul 185 18 185
mvva 116 44 20
s_waitcnt vmcnt(10)
s_barrier
mzvva 112 44 16
s_mov_b32 s66, 368768
s_add_u32 m0, s65, 81920
mvva 112 40 0
trv 32 10 40960
wl 6
mvva 112 48 32
dma 30 52 66 0
mul 186 18 186
mvva 112 52 48
trv 34 10 41472
mul 187 18 187
mvva 116 52 52
trv 36 10 41984
cvt 168 168 169
mvva 116 48 36
cvt 169 170 171
cvt 170 184 185
mvva 120 48 40
trv 38 10 42496
cvt 171 186 187
mvva 120 52 56
ds_write_b128 v27, v[168:171] offset:6144
mvva 124 52 60
dma 31 52 66 1024
mul 172 19 172
mvva 124 48 44
trv 40 11 40960
wl 6
mvva 108 56 44
trv 42 11 41472
mul 173 19 173
mvva 108 60 60
s_mov_b32 s66, 442496
s_add_u32 m0, s65, 16384
mvva 104 60 56
trv 44 11 41984
mul 174 19 174
mvva 104 56 40
dma 30 52 66 0
mul 175 19 175
mvva 100 56 36
trv 46 11 42496
mul 188 19 188
mvva 100 60 52
mul 189 19 189
mul 190 19 190
mvva 96 60 48
trv 48 11 0
mul 191 19 191
mvva 96 56 32
cvt 172 172 173
wl 6
mvva 96 32 64
trv 50 11 512
cvt 173 174 175
mvva 96 36 80
dma 31 52 66 1024
cvt 174 188 189
mvva 100 36 84
trv 52 11 1024
cvt 175 190 191
mvva 100 32 68
ds_write_b128 v27, v[172:175] offset:7168
mvva 104 32 72
trv 54 11 1536
mul 192 16 192
mvva 104 36 88
mul 193 16 193
mul 194 16 194
mvva 108 36 92
trv 56 10 0
mul 195 16 195
mvva 108 32 76
mul 208 16 208
wl 6
mvva 124 40 76
trv 58 10 512
mul 209 16 209
mvva 124 44 92
mul 210 16 210
mul 211 16 211
mvva 120 44 88
trv 60 10 1024
cvt 192 192 193
mvva 120 40 72
cvt 193 194 195
cvt 194 208 209
mvva 116 40 68
trv 62 10 1536
cvt 195 210 211
mvva 116 44 84
s_waitcnt vmcnt(10)
s_barrier
mvva 112 44 80
ds_write_b128 v27, v[192:195] offset:8192
mvva 112 40 64
s_mov_b32 s66, 516224
wl 5
mvva 112 48 96
s_add_u32 m0, s65, 32768
trv 32 10 8192
mvva 112 52 112
dma 30 52 66 0
mul 196 17 196
mvva 116 52 116
dma 31 52 66 1024
s_sub_u32 s66, s66, 515968
mvva 116 48 100
s_add_u32 m0, s65, 24576
trv 34 10 8704
mvva 120 48 104
dma 30 52 66 0
mul 197 17 197
mvva 120 52 120
dma 31 52 66 1024
mul 198 17 198
mul 199 17 199
v_pk_mul_f32 v[212:213], v[16:17], v[212:213] op_sel:[1,0] op_sel_hi:[1,1]
v_pk_mul_f32 v[214:215], v[16:17], v[214:215] op_sel:[1,0] op_sel_hi:[1,1]
cvt 196 196 197
cvt 197 198 199
cvt 198 212 213
cvt 199 214 215
ds_write_b128 v27, v[196:199] offset:9216
v_pk_mul_f32 v[200:201], v[18:19], v[200:201] op_sel_hi:[0,1]
v_pk_mul_f32 v[202:203], v[18:19], v[202:203] op_sel_hi:[0,1]
v_pk_mul_f32 v[216:217], v[18:19], v[216:217] op_sel_hi:[0,1]
v_pk_mul_f32 v[218:219], v[18:19], v[218:219] op_sel_hi:[0,1]
cvt 200 200 201
cvt 201 202 203
cvt 202 216 217
cvt 203 218 219
ds_write_b128 v27, v[200:203] offset:10240
v_pk_mul_f32 v[204:205], v[18:19], v[204:205] op_sel:[1,0] op_sel_hi:[1,1]
v_pk_mul_f32 v[206:207], v[18:19], v[206:207] op_sel:[1,0] op_sel_hi:[1,1]
v_pk_mul_f32 v[220:221], v[18:19], v[220:221] op_sel:[1,0] op_sel_hi:[1,1]
v_pk_mul_f32 v[222:223], v[18:19], v[222:223] op_sel:[1,0] op_sel_hi:[1,1]
cvt 204 204 205
cvt 205 206 207
cvt 206 220 221
cvt 207 222 223
ds_write_b128 v27, v[204:207] offset:11264
v_pk_mul_f32 v[224:225], v[16:17], v[224:225] op_sel_hi:[0,1]
v_pk_mul_f32 v[226:227], v[16:17], v[226:227] op_sel_hi:[0,1]
v_pk_mul_f32 v[240:241], v[16:17], v[240:241] op_sel_hi:[0,1]
v_pk_mul_f32 v[242:243], v[16:17], v[242:243] op_sel_hi:[0,1]
cvt 224 224 225
cvt 225 226 227
cvt 226 240 241
cvt 227 242 243
ds_write_b128 v27, v[224:227] offset:12288
v_pk_mul_f32 v[228:229], v[16:17], v[228:229] op_sel:[1,0] op_sel_hi:[1,1]
v_pk_mul_f32 v[230:231], v[16:17], v[230:231] op_sel:[1,0] op_sel_hi:[1,1]
v_pk_mul_f32 v[244:245], v[16:17], v[244:245] op_sel:[1,0] op_sel_hi:[1,1]
v_pk_mul_f32 v[246:247], v[16:17], v[246:247] op_sel:[1,0] op_sel_hi:[1,1]
cvt 228 228 229
cvt 229 230 231
cvt 230 244 245
cvt 231 246 247
ds_write_b128 v27, v[228:231] offset:13312
v_pk_mul_f32 v[232:233], v[18:19], v[232:233] op_sel_hi:[0,1]
v_pk_mul_f32 v[234:235], v[18:19], v[234:235] op_sel_hi:[0,1]
v_pk_mul_f32 v[248:249], v[18:19], v[248:249] op_sel_hi:[0,1]
v_pk_mul_f32 v[250:251], v[18:19], v[250:251] op_sel_hi:[0,1]
cvt 232 232 233
cvt 233 234 235
cvt 234 248 249
cvt 235 250 251
ds_write_b128 v27, v[232:235] offset:14336
v_pk_mul_f32 v[236:237], v[18:19], v[236:237] op_sel:[1,0] op_sel_hi:[1,1]
v_pk_mul_f32 v[238:239], v[18:19], v[238:239] op_sel:[1,0] op_sel_hi:[1,1]
v_pk_mul_f32 v[252:253], v[18:19], v[252:253] op_sel:[1,0] op_sel_hi:[1,1]
v_pk_mul_f32 v[254:255], v[18:19], v[254:255] op_sel:[1,0] op_sel_hi:[1,1]
cvt 236 236 237
cvt 237 238 239
cvt 238 252 253
cvt 239 254 255
ds_write_b128 v27, v[236:239] offset:15360
mvva 124 52 124
wl 0
s_barrier
mvva 124 48 108
trv 36 10 9216
mvva 108 56 108
trv 38 10 9728
s_add_u32 s66, s66, 73728
mvva 108 60 124
rda 128 28 0
s_add_u32 m0, s65, 40960
mvva 104 60 120
trv 40 11 8192
mvva 104 56 104
rda 132 28 1024
rda 136 28 2048
rda 140 28 3072
rda 144 28 4096
rda 148 28 5120
rda 152 28 6144
rda 156 28 7168
mvva 100 56 100
dma 30 52 66 0
mvva 100 60 116
trv 42 11 8704
mvva 96 60 112
trv 44 11 9216
mvva 96 56 96
trv 46 11 9728
wl 12
wl 11
mvva 64 32 128
trv 48 11 49152
wl 7
mvva 64 36 144
rda 160 28 8192
wl 7
mvva 68 36 148
rda 164 28 9216
mvva 68 32 132
dma 31 52 66 1024
mvva 72 32 136
trv 50 11 49664
wl 8
mvva 72 36 152
rda 168 28 10240
wl 8
mvva 76 36 156
rda 172 28 11264
mvva 76 32 140
trv 52 11 50176
wl 7
mvva 92 40 140
rda 176 28 12288
mvva 92 44 156
rda 180 28 13312
mvva 88 44 152
trv 54 11 50688
mvva 88 40 136
rda 184 28 14336
rda 188 28 15360
mvva 84 40 132
rda 192 28 32768
mvva 84 44 148
s_waitcnt vmcnt(12)
s_barrier
trv 56 10 49152
rda 196 28 33792
rda 200 28 34816
trv 58 10 49664
rda 204 28 35840
rda 208 28 36864
trv 60 10 50176
rda 212 28 37888
rda 216 28 38912
trv 62 10 50688
s_branch L_merge
.p2align 6
L_ffn:
s_mul_i32 s80, s70, 1152
s_add_u32 s44, s28, s80
s_addc_u32 s45, s29, 0
s_sub_u32 s46, 5308416, s80
s_mov_b32 s47, 0x20000
s_add_u32 s48, s30, s80
s_addc_u32 s49, s31, 0
s_sub_u32 s50, 5308416, s80
s_mov_b32 s51, 0x20000
s_mul_i32 s80, s70, 663552
s_add_u32 s52, s32, s80
s_addc_u32 s53, s33, 0
s_mov_b32 s54, 663552
s_mov_b32 s55, 0x20000
v_lshrrev_b32 v24, 3, v1
v_and_b32 v25, 7, v1
v_bfe_u32 v26, v24, 1, 1
s_and_b32 s78, s64, 1
s_lshl_b32 s78, s78, 1
v_or_b32 v26, s78, v26
v_lshlrev_b32 v26, 1, v26
v_xor_b32 v25, v25, v26
s_lshl_b32 s78, s64, 3
v_add_u32 v27, s78, v24
v_mul_u32_u24 v27, 9216, v27
v_lshl_add_u32 v4, v25, 4, v27
v_add_u32 v5, 293888, v4
v_lshrrev_b32 v24, 3, v1
v_and_b32 v25, 7, v1
v_bfe_u32 v26, v24, 1, 1
s_and_b32 s78, s64, 1
s_lshl_b32 s78, s78, 1
v_or_b32 v26, s78, v26
v_lshlrev_b32 v26, 1, v26
v_xor_b32 v25, v25, v26
s_lshl_b32 s78, s64, 2
v_and_b32 v27, 3, v24
v_add_u32 v27, s78, v27
v_lshrrev_b32 v24, 2, v24
v_lshl_add_u32 v27, v24, 4, v27
v_mul_u32_u24 v27, 1152, v27
v_lshl_add_u32 v250, v25, 4, v27
v_add_u32 v251, 35840, v250
v_lshrrev_b32 v24, 4, v1
v_bfe_u32 v25, v1, 2, 2
v_lshrrev_b32 v26, 1, v25
v_and_b32 v6, 1, v24
v_lshl_or_b32 v26, v6, 1, v26
v_lshlrev_b32 v6, 11, v24
v_lshl_or_b32 v6, v25, 7, v6
v_lshl_or_b32 v6, v26, 5, v6
v_and_b32 v24, 3, v1
v_lshl_or_b32 v6, v24, 3, v6
s_lshl_b32 s78, s75, 6
v_xor_b32 v6, s78, v6
v_xor_b32 v7, 32, v6
v_add_u32 v8, 0x10000, v6
v_add_u32 v9, 0x10000, v7
v_add_u32 v10, 0x20000, v6
v_add_u32 v11, 0x20000, v7
s_lshl_b32 s78, s74, 12
s_add_u32 s78, s78, 98304
v_lshlrev_b32 v13, 4, v1
v_add_u32 v13, s78, v13
s_lshl_b32 s78, s75, 13
v_add_u32 v12, s78, v13
v_subrev_u32 v14, 16384, v12
v_subrev_u32 v15, 16384, v13
v_subrev_u32 v248, 98304, v12
s_mov_b32 s69, 0
s_and_b32 s78, s72, 15
s_lshl_b32 s78, s78, 2
s_add_u32 s78, s78, s64
s_mul_i32 s78, s78, 9
v_add_u32 v3, s78, v1
v_mul_u32_u24 v3, 9216, v3
v_mov_b32 v24, 0x7fffffff
v_cmp_gt_u32 vcc, 9, v1
s_nop 1
v_cndmask_b32 v3, v24, v3, vcc
s_lshl_b32 s78, s73, 3
s_add_u32 s78, s78, s70
s_lshl_b32 s78, s78, 7
v_mov_b32 v252, 0x10000
v_mov_b32 v253, s78
v_cmp_eq_u32 vcc, 0, v0
s_cmp_eq_u32 s88, 0
s_cselect_b64 s[80:81], vcc, 0
v_cndmask_b32 v53, v252, v253, s[80:81]
v_cndmask_b32 v252, v252, v253, vcc
v_mov_b32 v253, 0
s_lshl_b32 s78, s72, 2
v_mov_b32 v54, s78
v_cndmask_b32 v54, v53, v54, s[80:81]
s_lshl_b32 s98, s72, 11
s_add_u32 s98, s98, 41943040
v_mov_b32 v254, v54
v_lshrrev_b32 v242, 4, v1
v_bfe_u32 v240, v1, 2, 2
v_cmp_eq_u32 s[96:97], v240, v242
v_and_b32 v240, 1, v1
v_lshlrev_b32 v240, 4, v240
v_mov_b32 v241, 0x3f80
v_lshlrev_b32 v241, v240, v241
v_cndmask_b32 v241, 0, v241, s[96:97]
v_and_b32 v240, 2, v1
v_cmp_eq_u32 vcc, 0, v240
s_nop 1
v_cndmask_b32 v38, 0, v241, vcc
v_cndmask_b32 v39, v241, 0, vcc
v_mov_b32 v36, 0
v_mov_b32 v37, 0
v_mov_b32 v40, 0
v_mov_b32 v41, 0
v_mov_b32 v240, 0x3f803f80
v_cndmask_b32 v32, 0, v240, s[96:97]
v_cndmask_b32 v33, 0, v240, s[96:97]
v_cndmask_b32 v34, 0, v240, s[96:97]
v_cndmask_b32 v35, 0, v240, s[96:97]
s_mul_i32 s78, s64, 18432
s_add_u32 s78, s78, 90112
v_and_b32 v240, 7, v1
v_lshrrev_b32 v241, 3, v1
v_xor_b32 v55, v240, v241
v_lshlrev_b32 v55, 4, v55
v_and_b32 v242, 3, v240
v_lshl_or_b32 v55, v242, 8, v55
v_lshrrev_b32 v242, 2, v240
v_lshl_or_b32 v55, v242, 10, v55
v_add_u32 v55, s78, v55
s_lshl_b32 s78, s74, 8
s_add_u32 s78, s78, 89088
s_lshl_b32 s79, s75, 7
s_add_u32 s79, s79, s78
v_lshlrev_b32 v243, 2, v241
v_add_u32 v243, s79, v243
v_and_b32 v240, 15, v1
v_lshlrev_b32 v242, 2, v240
v_add_u32 v242, s78, v242
v_lshrrev_b32 v241, 4, v1
v_xor_b32 v240, v240, v241
v_lshl_or_b32 v240, v241, 4, v240
v_lshlrev_b32 v240, 4, v240
s_mul_i32 s78, s74, 18432
s_add_u32 s78, s78, 90112
v_xor_b32 v241, 64, v240
v_add_u32 v240, s78, v240
v_add_u32 v241, s78, v241
v_and_b32 v244, 3, v1
v_cmp_eq_u32 s[82:83], 1, v244
v_cmp_eq_u32 s[84:85], 2, v244
v_cmp_eq_u32 s[86:87], 3, v244
s_waitcnt vmcnt(18)
s_mov_b64 exec, 0
s_cmp_eq_u32 s64, 0
s_cbranch_scc1 L_pgf0
s_cmp_eq_u32 s64, 1
s_cbranch_scc1 L_pgf1
s_cmp_eq_u32 s64, 2
s_cbranch_scc1 L_pgf2
s_branch L_pgf3
L_pgf_back:
s_mov_b64 exec, -1
buffer_load_dwordx4 v[160:163], v52, s[40:43], s92 offen offset:0
s_waitcnt vmcnt(18)
mzvvv 44 32 88
s_waitcnt vmcnt(17)
mvvv 44 32 92
s_waitcnt vmcnt(16)
mvvv 44 32 96
buffer_load_dwordx4 v[164:167], v52, s[40:43], s92 offen offset:128
s_waitcnt vmcnt(16)
mvvv 44 32 100
s_waitcnt vmcnt(15)
mvvv 44 32 104
s_waitcnt vmcnt(14)
mvvv 44 32 108
buffer_load_dwordx4 v[168:171], v52, s[40:43], s92 offen offset:256
s_waitcnt vmcnt(14)
mvvv 44 32 112
s_waitcnt vmcnt(13)
mvvv 44 32 116
s_waitcnt vmcnt(12)
mvvv 44 32 120
buffer_load_dwordx4 v[172:175], v52, s[40:43], s92 offen offset:384
s_waitcnt vmcnt(12)
mzvvv 232 32 124
s_waitcnt vmcnt(11)
mvvv 232 32 128
s_waitcnt vmcnt(10)
mvvv 232 32 132
buffer_load_dwordx4 v[176:179], v52, s[40:43], s92 offen offset:512
s_waitcnt vmcnt(10)
mvvv 232 32 136
v_add_f32_dpp v44, v44, v44 quad_perm:[1,0,3,2] row_mask:0xf bank_mask:0xf
s_nop 1
v_add_f32_dpp v44, v44, v44 quad_perm:[2,3,0,1] row_mask:0xf bank_mask:0xf
s_waitcnt vmcnt(9)
mvvv 232 32 140
v_add_f32_dpp v44, v44, v44 row_half_mirror row_mask:0xf bank_mask:0xf
v_mul_f32 v48, 0xbae38e39, v44
v_mul_f32 v49, 0xbae38e39, v44
v_mul_f32 v50, 0xbae38e39, v44
v_mul_f32 v51, 0xbae38e39, v44
v_mfma_f32_4x4x4_16b_bf16 v[56:59], v[88:89], v[88:89], 0
buffer_load_dwordx4 v[180:183], v52, s[40:43], s92 offen offset:640
mcvvv 60 38 88 48
v_mfma_f32_4x4x4_16b_bf16 v[56:59], v[90:91], v[90:91], v[56:59]
mcvvv 68 36 88 48
buffer_load_dwordx4 v[184:187], v52, s[40:43], s92 offen offset:768
s_waitcnt vmcnt(10)
mvvv 232 32 144
v_mfma_f32_4x4x4_16b_bf16 v[56:59], v[92:93], v[92:93], v[56:59]
mcvvv 76 38 92 48
buffer_load_dwordx4 v[188:191], v52, s[40:43], s92 offen offset:896
v_mfma_f32_4x4x4_16b_bf16 v[56:59], v[94:95], v[94:95], v[56:59]
cvt 88 60 61
cvt 89 62 63
mcvvv 84 36 92 48
cvt 90 68 69
cvt 91 70 71
s_waitcnt vmcnt(10)
mvvv 232 32 148
ds_write_b128 v55, v[88:91] offset:0
v_mfma_f32_4x4x4_16b_bf16 v[56:59], v[96:97], v[96:97], v[56:59]
buffer_load_dwordx4 v[192:195], v52, s[40:43], s92 offen offset:1024
mcvvv 244 38 96 48
cvt 92 76 77
cvt 93 78 79
v_mfma_f32_4x4x4_16b_bf16 v[56:59], v[98:99], v[98:99], v[56:59]
buffer_load_dwordx4 v[196:199], v52, s[40:43], s93 offen offset:0
mcvvv 20 36 96 48
cvt 94 84 85
cvt 95 86 87
s_waitcnt vmcnt(11)
mvvv 232 32 152
ds_write_b128 v55, v[92:95] offset:2048
v_mfma_f32_4x4x4_16b_bf16 v[56:59], v[100:101], v[100:101], v[56:59]
buffer_load_dwordx4 v[200:203], v52, s[40:43], s93 offen offset:128
mcvvv 60 38 100 48
cvt 96 244 245
cvt 97 246 247
v_mfma_f32_4x4x4_16b_bf16 v[56:59], v[102:103], v[102:103], v[56:59]
cvt 98 20 21
cvt 99 22 23
mcvvv 68 36 100 48
ds_write_b128 v55, v[96:99] offset:4096
s_waitcnt vmcnt(11)
mvvv 232 32 156
buffer_load_dwordx4 v[204:207], v52, s[40:43], s93 offen offset:256
v_mfma_f32_4x4x4_16b_bf16 v[56:59], v[104:105], v[104:105], v[56:59]
mcvvv 76 38 104 48
buffer_load_dwordx4 v[208:211], v52, s[40:43], s93 offen offset:384
v_mfma_f32_4x4x4_16b_bf16 v[56:59], v[106:107], v[106:107], v[56:59]
cvt 100 60 61
cvt 101 62 63
mcvvv 84 36 104 48
cvt 102 68 69
cvt 103 70 71
v_mfma_f32_4x4x4_16b_bf16 v[56:59], v[108:109], v[108:109], v[56:59]
ds_write_b128 v55, v[100:103] offset:6144
mcvvv 244 38 108 48
buffer_load_dwordx4 v[212:215], v52, s[40:43], s93 offen offset:512
v_mfma_f32_4x4x4_16b_bf16 v[56:59], v[110:111], v[110:111], v[56:59]
v_add_f32_dpp v232, v232, v232 quad_perm:[1,0,3,2] row_mask:0xf bank_mask:0xf
s_nop 1
v_add_f32_dpp v232, v232, v232 quad_perm:[2,3,0,1] row_mask:0xf bank_mask:0xf
mcvvv 20 36 108 48
buffer_load_dwordx4 v[216:219], v52, s[40:43], s93 offen offset:640
v_mfma_f32_4x4x4_16b_bf16 v[56:59], v[112:113], v[112:113], v[56:59]
v_add_f32_dpp v232, v232, v232 row_half_mirror row_mask:0xf bank_mask:0xf
v_mul_f32 v236, 0xbae38e39, v232
mcvvv 60 38 112 48
v_mul_f32 v237, 0xbae38e39, v232
v_mul_f32 v238, 0xbae38e39, v232
v_mfma_f32_4x4x4_16b_bf16 v[56:59], v[114:115], v[114:115], v[56:59]
buffer_load_dwordx4 v[220:223], v52, s[40:43], s93 offen offset:768
mcvvv 68 36 112 48
v_mul_f32 v239, 0xbae38e39, v232
cvt 104 76 77
v_mfma_f32_4x4x4_16b_bf16 v[56:59], v[116:117], v[116:117], v[56:59]
cvt 105 78 79
cvt 106 84 85
cvt 107 86 87
mcvvv 76 38 116 48
ds_write_b128 v55, v[104:107] offset:8192
v_mfma_f32_4x4x4_16b_bf16 v[56:59], v[118:119], v[118:119], v[56:59]
buffer_load_dwordx4 v[224:227], v52, s[40:43], s93 offen offset:896
mcvvv 84 36 116 48
cvt 108 244 245
cvt 109 246 247
v_mfma_f32_4x4x4_16b_bf16 v[56:59], v[120:121], v[120:121], v[56:59]
cvt 110 20 21
cvt 111 22 23
mcvvv 244 38 120 48
ds_write_b128 v55, v[108:111] offset:10240
v_mfma_f32_4x4x4_16b_bf16 v[56:59], v[122:123], v[122:123], v[56:59]
buffer_load_dwordx4 v[228:231], v52, s[40:43], s93 offen offset:1024
mcvvv 20 36 120 48
s_mov_b32 s66, 0
s_add_u32 m0, s65, 0
v_mfma_f32_4x4x4_16b_bf16 v[64:67], v[124:125], v[124:125], 0
cvt 112 60 61
cvt 113 62 63
cvt 114 68 69
cvt 115 70 71
mcvvv 60 38 124 236
ds_write_b128 v55, v[112:115] offset:12288
v_mfma_f32_4x4x4_16b_bf16 v[64:67], v[126:127], v[126:127], v[64:67]
dma 4 44 66 0
mcvvv 68 36 124 236
cvt 116 76 77
cvt 117 78 79
s_waitcnt vmcnt(18)
mzvvv 44 32 160
cvt 118 84 85
cvt 119 86 87
s_waitcnt vmcnt(17)
mvvv 44 32 164
ds_write_b128 v55, v[116:119] offset:14336
v_mfma_f32_4x4x4_16b_bf16 v[64:67], v[128:129], v[128:129], v[64:67]
dma 5 44 66 1024
mcvvv 76 38 128 236
v_cndmask_b32 v56, v56, v57, s[82:83]
cvt 120 244 245
v_mfma_f32_4x4x4_16b_bf16 v[64:67], v[130:131], v[130:131], v[64:67]
cvt 121 246 247
cvt 122 20 21
mcvvv 84 36 128 236
cvt 123 22 23
v_cndmask_b32 v56, v56, v58, s[84:85]
s_waitcnt vmcnt(17)
mvvv 44 32 168
ds_write_b128 v55, v[120:123] offset:16384
s_waitcnt vmcnt(16)
mvvv 44 32 172
s_mov_b32 s66, 589824
s_add_u32 m0, s65, 8192
v_mfma_f32_4x4x4_16b_bf16 v[64:67], v[132:133], v[132:133], v[64:67]
dma 4 44 66 0
v_cndmask_b32 v56, v56, v59, s[86:87]
mcvvv 244 38 132 236
s_nop 0
v_add_f32_dpp v56, v56, v56 quad_perm:[1,0,3,2] row_mask:0xf bank_mask:0xf
s_nop 1
v_add_f32_dpp v56, v56, v56 quad_perm:[2,3,0,1] row_mask:0xf bank_mask:0xf
s_nop 1
v_add_f32_dpp v56, v56, v56 row_half_mirror row_mask:0xf bank_mask:0xf
v_mul_f32 v56, 0x3ae38e39, v56
v_fma_f32 v56, -v48, v48, v56
v_max_f32 v56, 0, v56
v_add_f32 v56, 0x3727c5ac, v56
ds_write_b32 v243, v56 offset:0
v_mfma_f32_4x4x4_16b_bf16 v[64:67], v[134:135], v[134:135], v[64:67]
cvt 124 60 61
cvt 125 62 63
mcvvv 20 36 132 236
cvt 126 68 69
cvt 127 70 71
s_waitcnt vmcnt(16)
mvvv 44 32 176
ds_write_b128 v55, v[124:127] offset:128
s_waitcnt vmcnt(15)
mvvv 44 32 180
dma 5 44 66 1024
v_mfma_f32_4x4x4_16b_bf16 v[64:67], v[136:137], v[136:137], v[64:67]
cvt 128 76 77
cvt 129 78 79
mcvvv 60 38 136 236
cvt 130 84 85
cvt 131 86 87
v_mfma_f32_4x4x4_16b_bf16 v[64:67], v[138:139], v[138:139], v[64:67]
ds_write_b128 v55, v[128:131] offset:2176
mcvvv 68 36 136 236
cvt 132 244 245
cvt 133 246 247
s_waitcnt vmcnt(15)
mvvv 44 32 184
cvt 134 20 21
cvt 135 22 23
s_waitcnt vmcnt(14)
mvvv 44 32 188
ds_write_b128 v55, v[132:135] offset:4224
v_mfma_f32_4x4x4_16b_bf16 v[64:67], v[140:141], v[140:141], v[64:67]
s_mov_b32 s66, 1179648
s_add_u32 m0, s65, 16384
mcvvv 76 38 140 236
dma 4 44 66 0
v_mfma_f32_4x4x4_16b_bf16 v[64:67], v[142:143], v[142:143], v[64:67]
cvt 136 60 61
cvt 137 62 63
mcvvv 84 36 140 236
cvt 138 68 69
cvt 139 70 71
s_waitcnt vmcnt(14)
mvvv 44 32 192
ds_write_b128 v55, v[136:139] offset:6272
v_mfma_f32_4x4x4_16b_bf16 v[64:67], v[144:145], v[144:145], v[64:67]
dma 5 44 66 1024
mcvvv 244 38 144 236
cvt 140 76 77
cvt 141 78 79
v_mfma_f32_4x4x4_16b_bf16 v[64:67], v[146:147], v[146:147], v[64:67]
cvt 142 84 85
cvt 143 86 87
mcvvv 20 36 144 236
ds_write_b128 v55, v[140:143] offset:8320
v_mfma_f32_4x4x4_16b_bf16 v[64:67], v[148:149], v[148:149], v[64:67]
v_add_f32_dpp v44, v44, v44 quad_perm:[1,0,3,2] row_mask:0xf bank_mask:0xf
s_nop 1
v_add_f32_dpp v44, v44, v44 quad_perm:[2,3,0,1] row_mask:0xf bank_mask:0xf
mcvvv 60 38 148 236
s_nop 0
v_add_f32_dpp v44, v44, v44 row_half_mirror row_mask:0xf bank_mask:0xf
v_mul_f32 v48, 0xbae38e39, v44
v_mfma_f32_4x4x4_16b_bf16 v[64:67], v[150:151], v[150:151], v[64:67]
s_mov_b32 s66, 1769472
s_add_u32 m0, s65, 24576
mcvvv 68 36 148 236
dma 4 44 66 0
v_mfma_f32_4x4x4_16b_bf16 v[64:67], v[152:153], v[152:153], v[64:67]
v_mul_f32 v49, 0xbae38e39, v44
v_mul_f32 v50, 0xbae38e39, v44
mcvvv 76 38 152 236
v_mul_f32 v51, 0xbae38e39, v44
cvt 144 244 245
v_mfma_f32_4x4x4_16b_bf16 v[64:67], v[154:155], v[154:155], v[64:67]
cvt 145 246 247
cvt 146 20 21
mcvvv 84 36 152 236
cvt 147 22 23
cvt 148 60 61
v_mfma_f32_4x4x4_16b_bf16 v[64:67], v[156:157], v[156:157], v[64:67]
ds_write_b128 v55, v[144:147] offset:10368
mcvvv 244 38 156 236
dma 5 44 66 1024
v_mfma_f32_4x4x4_16b_bf16 v[64:67], v[158:159], v[158:159], v[64:67]
cvt 149 62 63
cvt 150 68 69
mcvvv 20 36 156 236
cvt 151 70 71
cvt 152 76 77
v_mfma_f32_4x4x4_16b_bf16 v[88:91], v[160:161], v[160:161], 0
ds_write_b128 v55, v[148:151] offset:12416
mcvvv 60 38 160 48
cvt 153 78 79
cvt 154 84 85
v_mfma_f32_4x4x4_16b_bf16 v[88:91], v[162:163], v[162:163], v[88:91]
cvt 155 86 87
ds_write_b128 v55, v[152:155] offset:14464
cvt 156 244 245
cvt 157 246 247
cvt 158 20 21
cvt 159 22 23
ds_write_b128 v55, v[156:159] offset:16512
mcvvv 68 36 160 48
wl 0
s_barrier
rda 0 240 0
rda 8 240 36864
s_waitcnt vmcnt(16)
mzvvv 232 32 196
rda 16 241 1024
s_mov_b32 s66, 2359296
s_waitcnt vmcnt(15)
mvvv 232 32 200
rda 24 241 37888
rda 32 240 2048
v_mfma_f32_4x4x4_16b_bf16 v[88:91], v[164:165], v[164:165], v[88:91]
rda 40 240 38912
s_add_u32 m0, s65, 32768
mcvvv 76 38 164 48
rda 48 241 3072
v_cndmask_b32 v64, v64, v65, s[82:83]
v_mfma_f32_4x4x4_16b_bf16 v[88:91], v[166:167], v[166:167], v[88:91]
rda 56 241 39936
rda 64 240 4096
mcvvv 84 36 164 48
rda 72 240 40960
dma 4 44 66 0
s_waitcnt vmcnt(15)
mvvv 232 32 204
rda 80 241 5120
rda 88 241 41984
s_waitcnt vmcnt(14)
mvvv 232 32 208
rda 96 240 6144
v_cndmask_b32 v64, v64, v66, s[84:85]
v_mfma_f32_4x4x4_16b_bf16 v[88:91], v[168:169], v[168:169], v[88:91]
rda 104 240 43008
v_cndmask_b32 v64, v64, v67, s[86:87]
mcvvv 244 38 168 48
rda 112 241 7168
rda 120 241 44032
v_add_f32_dpp v64, v64, v64 quad_perm:[1,0,3,2] row_mask:0xf bank_mask:0xf
s_nop 1
v_add_f32_dpp v64, v64, v64 quad_perm:[2,3,0,1] row_mask:0xf bank_mask:0xf
s_nop 1
v_add_f32_dpp v64, v64, v64 row_half_mirror row_mask:0xf bank_mask:0xf
v_mul_f32 v64, 0x3ae38e39, v64
v_fma_f32 v64, -v236, v236, v64
v_max_f32 v64, 0, v64
v_add_f32 v64, 0x3727c5ac, v64
ds_write_b32 v243, v64 offset:32
v_mfma_f32_4x4x4_16b_bf16 v[88:91], v[170:171], v[170:171], v[88:91]
rda 128 240 8192
cvt 160 60 61
mcvvv 20 36 168 48
rda 136 240 45056
dma 5 44 66 1024
s_waitcnt vmcnt(14)
mvvv 232 32 212
rda 144 241 9216
rda 152 241 46080
s_waitcnt vmcnt(13)
mvvv 232 32 216
rda 160 240 10240
s_mov_b32 s66, 2949120
v_mfma_f32_4x4x4_16b_bf16 v[88:91], v[172:173], v[172:173], v[88:91]
rda 168 240 47104
rda 176 241 11264
cvt 161 62 63
cvt 162 68 69
cvt 163 70 71
mcvvv 60 38 172 48
rda 184 241 48128
s_add_u32 m0, s65, 40960
v_mfma_f32_4x4x4_16b_bf16 v[88:91], v[174:175], v[174:175], v[88:91]
rda 192 240 12288
cvt 164 76 77
mcvvv 68 36 172 48
rda 200 240 49152
rda 208 241 13312
s_waitcnt vmcnt(12)
mvvv 232 32 220
rda 216 241 50176
dma 4 44 66 0
s_waitcnt vmcnt(12)
mvvv 232 32 224
rda 224 240 14336
rda 232 240 51200
v_mfma_f32_4x4x4_16b_bf16 v[88:91], v[176:177], v[176:177], v[88:91]
rda 240 241 15360
cvt 165 78 79
cvt 166 84 85
cvt 167 86 87
mcvvv 76 38 176 48
rda 248 241 52224
cvt 168 244 245
v_mfma_f32_4x4x4_16b_bf16 v[88:91], v[178:179], v[178:179], v[88:91]
rdv 56 240 16384
rdv 64 240 53248
mcvvv 84 36 176 48
rdv 72 241 17408
dma 5 44 66 1024
s_waitcnt vmcnt(12)
mvvv 232 32 228
rdv 80 241 54272
s_mov_b32 s66, 3538944
v_mfma_f32_4x4x4_16b_bf16 v[88:91], v[180:181], v[180:181], v[88:91]
cvt 169 246 247
cvt 170 20 21
cvt 171 22 23
mcvvv 244 38 180 48
s_add_u32 m0, s65, 49152
cvt 172 60 61
v_mfma_f32_4x4x4_16b_bf16 v[88:91], v[182:183], v[182:183], v[88:91]
wl 0
s_barrier
mcvvv 20 36 180 48
dma 4 44 66 0
cvt 173 62 63
v_mfma_f32_4x4x4_16b_bf16 v[88:91], v[184:185], v[184:185], v[88:91]
cvt 174 68 69
cvt 175 70 71
mcvvv 60 38 184 48
ds_write_b128 v55, v[160:163] offset:0
v_mfma_f32_4x4x4_16b_bf16 v[88:91], v[186:187], v[186:187], v[88:91]
dma 5 44 66 1024
mcvvv 68 36 184 48
ds_write_b128 v55, v[164:167] offset:2048
v_mfma_f32_4x4x4_16b_bf16 v[88:91], v[188:189], v[188:189], v[88:91]
cvt 176 76 77
cvt 177 78 79
cvt 178 84 85
cvt 179 86 87
mcvvv 76 38 188 48
ds_write_b128 v55, v[168:171] offset:4096
v_mfma_f32_4x4x4_16b_bf16 v[88:91], v[190:191], v[190:191], v[88:91]
s_mov_b32 s66, 4128768
s_add_u32 m0, s65, 57344
mcvvv 84 36 188 48
dma 4 44 66 0
v_add_f32_dpp v232, v232, v232 quad_perm:[1,0,3,2] row_mask:0xf bank_mask:0xf
v_mfma_f32_4x4x4_16b_bf16 v[88:91], v[192:193], v[192:193], v[88:91]
cvt 180 244 245
cvt 181 246 247
cvt 182 20 21
cvt 183 22 23
mcvvv 244 38 192 48
ds_write_b128 v55, v[172:175] offset:6144
v_mfma_f32_4x4x4_16b_bf16 v[88:91], v[194:195], v[194:195], v[88:91]
ds_write_b128 v55, v[176:179] offset:8192
mcvvv 20 36 192 48
v_add_f32_dpp v232, v232, v232 quad_perm:[2,3,0,1] row_mask:0xf bank_mask:0xf
s_nop 1
v_add_f32_dpp v232, v232, v232 row_half_mirror row_mask:0xf bank_mask:0xf
v_mul_f32 v236, 0xbae38e39, v232
v_mul_f32 v237, 0xbae38e39, v232
v_mul_f32 v238, 0xbae38e39, v232
v_mul_f32 v239, 0xbae38e39, v232
v_mfma_f32_4x4x4_16b_bf16 v[92:95], v[196:197], v[196:197], 0
cvt 184 60 61
cvt 185 62 63
cvt 186 68 69
cvt 187 70 71
mcvvv 60 38 196 236
dma 5 44 66 1024
v_mfma_f32_4x4x4_16b_bf16 v[92:95], v[198:199], v[198:199], v[92:95]
ds_write_b128 v55, v[180:183] offset:10240
mcvvv 68 36 196 236
cvt 188 76 77
cvt 189 78 79
v_mfma_f32_4x4x4_16b_bf16 v[92:95], v[200:201], v[200:201], v[92:95]
cvt 190 84 85
cvt 191 86 87
mcvvv 76 38 200 236
ds_write_b128 v55, v[184:187] offset:12288
v_mfma_f32_4x4x4_16b_bf16 v[92:95], v[202:203], v[202:203], v[92:95]
buffer_load_dword v249, v3, s[44:47], 0 offen
mcvvv 84 36 200 236
ds_write_b128 v55, v[188:191] offset:14336
v_mfma_f32_4x4x4_16b_bf16 v[92:95], v[204:205], v[204:205], v[92:95]
cvt 192 244 245
cvt 193 246 247
cvt 194 20 21
cvt 195 22 23
mcvvv 244 38 204 236
v_cndmask_b32 v88, v88, v89, s[82:83]
v_cndmask_b32 v88, v88, v90, s[84:85]
v_mfma_f32_4x4x4_16b_bf16 v[92:95], v[206:207], v[206:207], v[92:95]
ds_write_b128 v55, v[192:195] offset:16384
mcvvv 20 36 204 236
buffer_load_dword v249, v3, s[48:51], 0 offen
v_cndmask_b32 v88, v88, v91, s[86:87]
v_mfma_f32_4x4x4_16b_bf16 v[92:95], v[208:209], v[208:209], v[92:95]
cvt 196 60 61
cvt 197 62 63
cvt 198 68 69
cvt 199 70 71
mcvvv 60 38 208 236
ds_write_b128 v55, v[196:199] offset:128
v_mfma_f32_4x4x4_16b_bf16 v[92:95], v[210:211], v[210:211], v[92:95]
v_add_f32_dpp v88, v88, v88 quad_perm:[1,0,3,2] row_mask:0xf bank_mask:0xf
s_nop 1
v_add_f32_dpp v88, v88, v88 quad_perm:[2,3,0,1] row_mask:0xf bank_mask:0xf
mcvvv 68 36 208 236
s_nop 0
v_add_f32_dpp v88, v88, v88 row_half_mirror row_mask:0xf bank_mask:0xf
v_mul_f32 v88, 0x3ae38e39, v88
v_mfma_f32_4x4x4_16b_bf16 v[92:95], v[212:213], v[212:213], v[92:95]
cvt 200 76 77
cvt 201 78 79
cvt 202 84 85
cvt 203 86 87
mcvvv 76 38 212 236
ds_write_b128 v55, v[200:203] offset:2176
v_mfma_f32_4x4x4_16b_bf16 v[92:95], v[214:215], v[214:215], v[92:95]
s_add_u32 s40, s38, s98
s_addc_u32 s41, s39, 0
mcvvv 84 36 212 236
s_mov_b32 s42, 2048
v_fma_f32 v88, -v48, v48, v88
v_mfma_f32_4x4x4_16b_bf16 v[92:95], v[216:217], v[216:217], v[92:95]
cvt 204 244 245
L_pgf0:
s_cbranch_execz L_pgf4
cvt 205 246 247
cvt 206 20 21
cvt 207 22 23
mcvvv 244 38 216 236
buffer_store_dword v253, v53, s[40:43], 0 offen sc1
v_mfma_f32_4x4x4_16b_bf16 v[92:95], v[218:219], v[218:219], v[92:95]
ds_write_b128 v55, v[204:207] offset:4224
mcvvv 20 36 216 236
v_max_f32 v88, 0, v88
v_add_f32 v88, 0x3727c5ac, v88
v_mfma_f32_4x4x4_16b_bf16 v[92:95], v[220:221], v[220:221], v[92:95]
cvt 208 60 61
cvt 209 62 63
cvt 210 68 69
cvt 211 70 71
mcvvv 60 38 220 236
ds_write_b32 v243, v88 offset:64
v_mfma_f32_4x4x4_16b_bf16 v[92:95], v[222:223], v[222:223], v[92:95]
ds_write_b128 v55, v[208:211] offset:6272
mcvvv 68 36 220 236
cvt 212 76 77
cvt 213 78 79
v_mfma_f32_4x4x4_16b_bf16 v[92:95], v[224:225], v[224:225], v[92:95]
cvt 214 84 85
cvt 215 86 87
mcvvv 76 38 224 236
ds_write_b128 v55, v[212:215] offset:8320
v_mfma_f32_4x4x4_16b_bf16 v[92:95], v[226:227], v[226:227], v[92:95]
cvt 216 244 245
cvt 217 246 247
mcvvv 84 36 224 236
cvt 218 20 21
cvt 219 22 23
v_mfma_f32_4x4x4_16b_bf16 v[92:95], v[228:229], v[228:229], v[92:95]
cvt 220 60 61
cvt 221 62 63
mcvvv 244 38 228 236
ds_write_b128 v55, v[216:219] offset:10368
v_mfma_f32_4x4x4_16b_bf16 v[92:95], v[230:231], v[230:231], v[92:95]
cvt 222 68 69
cvt 223 70 71
mcvvv 20 36 228 236
ds_write_b128 v55, v[220:223] offset:12416
cvt 224 76 77
cvt 225 78 79
cvt 226 84 85
cvt 227 86 87
ds_write_b128 v55, v[224:227] offset:14464
cvt 228 244 245
cvt 229 246 247
cvt 230 20 21
cvt 231 22 23
ds_write_b128 v55, v[228:231] offset:16512
v_cndmask_b32 v92, v92, v93, s[82:83]
v_cndmask_b32 v92, v92, v94, s[84:85]
v_cndmask_b32 v92, v92, v95, s[86:87]
s_nop 1
v_add_f32_dpp v92, v92, v92 quad_perm:[1,0,3,2] row_mask:0xf bank_mask:0xf
s_nop 1
v_add_f32_dpp v92, v92, v92 quad_perm:[2,3,0,1] row_mask:0xf bank_mask:0xf
s_nop 1
v_add_f32_dpp v92, v92, v92 row_half_mirror row_mask:0xf bank_mask:0xf
v_mul_f32 v92, 0x3ae38e39, v92
v_fma_f32 v92, -v236, v236, v92
v_max_f32 v92, 0, v92
v_add_f32 v92, 0x3727c5ac, v92
ds_write_b32 v243, v92 offset:96
s_waitcnt vmcnt(15) lgkmcnt(0)
s_barrier
s_mov_b32 s76, 589824
s_mov_b32 s77, 1179648
s_mov_b32 s88, 1769472
s_mov_b32 s89, 2359296
s_mov_b32 s90, 2949120
s_mov_b32 s91, 3538944
s_mov_b32 s96, 4128768
s_mov_b32 s97, 4718592
rda 4 240 0
rda 12 240 36864
rda 20 241 1024
rda 28 241 37888
trv 32 6 0
trv 34 6 512
trv 36 6 1024
trv 38 6 1536
wl 0
mzvva 88 32 0
trv 40 7 0
mvva 88 36 16
trv 42 7 512
mzvva 92 36 20
trv 44 7 1024
trv 46 7 1536
mvva 92 32 4
trv 48 7 8192
mzvva 96 32 8
rda 36 240 2048
mvva 96 36 24
trv 50 7 8704
mzvva 100 36 28
rda 44 240 38912
mvva 100 32 12
buffer_load_dword v249, v3, s[44:47], 0 offen offset:128
wl 4
mzvva 116 40 12
trv 52 7 9216
mvva 116 44 28
s_waitcnt vmcnt(12)
s_barrier
mzvva 112 44 24
trv 54 7 9728
rda 52 241 3072
mvva 112 40 8
rda 60 241 39936
s_add_u32 m0, s65, 65536
mzvva 108 40 4
trv 32 6 8192
mvva 108 44 20
rda 68 240 4096
mzvva 104 44 16
trv 34 6 8704
mvva 104 40 0
rda 76 240 40960
wl 6
mvva 104 48 32
trv 36 6 9216
mvva 104 52 48
dma 4 44 97 0
wl 6
mvva 108 52 52
trv 38 6 9728
rda 84 241 5120
mvva 108 48 36
rda 92 241 41984
mvva 112 48 40
trv 40 6 16384
mvva 112 52 56
rda 100 240 6144
wl 10
mvva 116 52 60
trv 42 6 16896
mvva 116 48 44
dma 5 44 97 1024
wl 5
mvva 100 32 44
rda 108 240 43008
s_add_u32 m0, s65, 73728
mvva 100 36 60
trv 44 6 17408
mvva 96 36 56
trv 46 6 17920
rda 116 241 7168
mvva 96 32 40
rda 124 241 44032
mvva 92 32 36
trv 48 7 16384
mvva 92 36 52
rda 132 240 8192
mvva 88 36 48
trv 50 7 16896
mvva 88 32 32
buffer_load_dwordx4 v4, s[48:51], 0 offen lds
wl 5
mvva 88 40 64
rda 140 240 45056
mvva 88 44 80
trv 52 7 17408
mvva 92 44 84
trv 54 7 17920
rda 148 241 9216
mvva 92 40 68
rda 156 241 46080
mvva 96 40 72
ds_read_b32 v20, v242 offset:0
mvva 96 44 88
trv 32 7 24576
mvva 100 44 92
rda 164 240 10240
mvva 100 40 76
buffer_load_dwordx4 v5, s[48:51], 0 offen offset:1024 lds
wl 5
mvva 116 48 76
trv 34 7 25088
rda 172 240 47104
mvva 116 52 92
s_waitcnt vmcnt(12)
s_barrier
mvva 112 52 88
trv 36 7 25600
trv 38 7 26112
mvva 112 48 72
ds_read_b32 v21, v242 offset:64
rda 180 241 11264
mvva 108 48 68
rda 188 241 48128
ds_read_b32 v22, v242 offset:128
mvva 108 52 84
trv 40 6 24576
s_add_u32 m0, s65, 0
mvva 104 52 80
rda 196 240 12288
mvva 104 48 64
trv 42 6 25088
wl 7
mvva 104 32 96
rda 204 240 49152
ds_read_b32 v23, v242 offset:192
mvva 104 36 112
trv 44 6 25600
dma 4 48 76 0
mvva 108 36 116
trv 46 6 26112
rda 212 241 13312
mvva 108 32 100
rda 220 241 50176
mvva 112 32 104
trv 48 6 32768
mvva 112 36 120
rda 228 240 14336
mvva 116 36 124
trv 50 6 33280
mvva 116 32 108
rda 236 240 51200
wl 6
mvva 100 40 108
dma 5 48 76 1024
s_add_u32 m0, s65, 8192
mvva 100 44 124
trv 52 6 33792
mvva 96 44 120
trv 54 6 34304
rda 244 241 15360
mvva 96 40 104
rda 252 241 52224
mvva 92 40 100
trv 32 7 32768
mvva 92 44 116
rdv 60 240 16384
mvva 88 44 112
trv 34 7 33280
mvva 88 40 96
rdv 68 240 53248
wl 6
mvva 88 48 128
dma 4 48 77 0
mvva 88 52 144
trv 36 7 33792
mvva 92 52 148
trv 38 7 34304
rdv 76 241 17408
mvva 92 48 132
rdv 84 241 54272
mvva 96 48 136
trv 40 7 40960
mvva 96 52 152
dma 5 48 77 1024
mvva 100 52 156
trv 42 7 41472
mvva 100 48 140
trv 44 7 41984
wl 5
mvva 116 32 140
trv 46 7 42496
mvva 116 36 156
s_waitcnt vmcnt(12) lgkmcnt(4)
s_barrier
mvva 112 36 152
trv 48 6 40960
s_add_u32 m0, s65, 147456
mvva 112 32 136
trv 50 6 41472
mvva 108 32 132
trv 52 6 41984
mvva 108 36 148
dma 4 48 88 0
mvva 104 36 144
trv 54 6 42496
mvva 104 32 128
trv 32 6 49152
wl 5
mvva 104 40 160
dma 5 48 88 1024
mvva 104 44 176
trv 34 6 49664
mvva 108 44 180
trv 36 6 50176
mvva 108 40 164
s_add_u32 m0, s65, 155648
v_rsq_f32 v16, v20
mvva 112 40 168
trv 38 6 50688
mvva 112 44 184
dma 4 48 89 0
mvva 116 44 188
buffer_load_dword v249, v3, s[48:51], 0 offen offset:128
mvva 116 40 172
trv 40 7 49152
wl 5
mvva 100 48 172
trv 42 7 49664
mvva 100 52 188
dma 5 48 89 1024
mvva 96 52 184
trv 44 7 50176
mvva 96 48 168
v_rsq_f32 v17, v21
mvva 92 48 164
trv 46 7 50688
mvva 92 52 180
s_add_u32 m0, s65, 131072
mvva 88 52 176
dma 4 48 90 0
mvva 88 48 160
trv 48 7 57344
wl 5
mvva 88 32 192
trv 50 7 57856
mvva 88 36 208
v_rsq_f32 v18, v22
mvva 92 36 212
trv 52 7 58368
mvva 92 32 196
dma 5 48 90 1024
mvva 96 32 200
trv 54 7 58880
mvva 96 36 216
mvva 100 36 220
mvva 100 32 204
trv 32 6 57344
wl 5
mvva 116 40 204
trv 34 6 57856
mvva 116 44 220
s_waitcnt vmcnt(11)
s_barrier
mvva 112 44 216
s_add_u32 m0, s65, 139264
trv 36 6 58368
mvva 112 40 200
dma 4 48 91 0
mvva 108 40 196
trv 38 6 58880
mvva 108 44 212
v_rsq_f32 v19, v23
mvva 104 44 208
mvva 104 40 192
trv 40 8 0
wl 5
mvva 104 48 224
dma 5 48 91 1024
mvva 104 52 240
trv 42 8 512
mvva 108 52 244
trv 44 8 1024
mvva 108 48 228
s_add_u32 m0, s65, 114688
mvva 112 48 232
trv 46 8 1536
mvva 112 52 248
dma 4 48 96 0
mvva 116 52 252
v_mul_f32 v16, 0xbfb8aa3b, v16
mvva 116 48 236
trv 48 9 0
wl 5
mvva 100 32 236
trv 50 9 512
mvva 100 36 252
dma 5 48 96 1024
mvva 96 36 248
trv 52 9 1024
mvva 96 32 232
v_mul_f32 v17, 0xbfb8aa3b, v17
mvva 92 32 228
trv 54 9 1536
mvva 92 36 244
s_add_u32 m0, s65, 122880
mvva 88 36 240
dma 4 48 97 0
mvva 88 32 224
trv 32 9 8192
wl 5
mvvv 88 40 56
trv 34 9 8704
v_mul_f32 v18, 0xbfb8aa3b, v18
mvvv 88 44 72
mvvv 92 44 76
trv 36 9 9216
mvvv 92 40 60
dma 5 48 97 1024
mvvv 96 40 64
trv 38 9 9728
mvvv 96 44 80
v_mul_f32 v19, 0xbfb8aa3b, v19
mvvv 100 44 84
mvvv 100 40 68
trv 40 8 8192
wl 5
mvvv 116 48 68
trv 42 8 8704
mvvv 116 52 84
s_waitcnt vmcnt(13)
s_barrier
mvvv 112 52 80
s_add_u32 s44, s44, 128
s_addc_u32 s45, s45, 0
mvvv 112 48 64
s_sub_u32 s46, s46, 128
s_add_u32 m0, s65, 98304
mvvv 108 48 60
trv 44 8 9216
mvvv 108 52 76
buffer_load_dwordx4 v4, s[44:47], 0 offen lds
mvvv 104 52 72
trv 46 8 9728
mvvv 104 48 56
trv 48 6 0
wl 5
mzvva 168 32 0
trv 50 6 512
mvva 168 36 16
buffer_load_dwordx4 v5, s[44:47], 0 offen offset:1024 lds
mzvva 172 36 20
trv 52 6 1024
mvva 172 32 4
mul 24 16 88
mul 25 16 89
mzvva 176 32 8
trv 54 6 1536
mul 26 16 90
mvva 176 36 24
trv 240 7 0
mul 27 16 91
mzvva 180 36 28
trv 242 7 512
mvva 180 32 12
trv 244 7 1024
wl 7
mzvva 164 40 12
trv 246 7 1536
s_add_u32 m0, s65, 106496
mvva 164 44 28
dma 4 44 76 0
mzvva 160 44 24
trv 32 7 8192
mvva 160 40 8
exp 24 24
mzvva 156 40 4
trv 34 7 8704
fma 24 24 20 20
mvva 156 44 20
exp 25 25
mzvva 152 44 16
trv 36 7 9216
fma 25 25 20 20
mvva 152 40 0
mul 28 16 104
wl 7
mvva 152 48 32
dma 5 44 76 1024
mul 29 16 105
mvva 152 52 48
trv 38 7 9728
exp 26 26
mvva 156 52 52
trv 40 6 8192
exp 27 27
mvva 156 48 36
rcp 24 24
mvva 160 48 40
trv 42 6 8704
fma 26 26 20 20
mvva 160 52 56
rcp 25 25
mvva 164 52 60
trv 44 6 9216
fma 27 27 20 20
mvva 164 48 44
mul 88 24 88
wl 7
mvva 180 240 44
trv 46 6 9728
mul 89 25 89
mvva 180 244 60
s_waitcnt vmcnt(12)
s_barrier
mvva 176 244 56
s_add_u32 m0, s65, 81920
trv 48 10 16384
mvva 176 240 40
dma 4 44 77 0
mvva 172 240 36
trv 50 10 16896
rcp 26 26
mvva 172 244 52
rcp 27 27
mvva 168 244 48
trv 52 10 17408
mul 90 26 90
mvva 168 240 32
mul 91 27 91
wl 3
mvva 168 32 64
trv 54 10 17920
mul 30 16 106
mvva 168 36 80
dma 5 44 77 1024
mvva 172 36 84
trv 240 11 16384
mul 31 16 107
mvva 172 32 68
exp 28 28
mvva 176 32 72
trv 242 11 16896
fma 28 28 20 20
mvva 176 36 88
exp 29 29
mvva 180 36 92
trv 244 11 17408
fma 29 29 20 20
mvva 180 32 76
exp 30 30
mvva 164 40 76
trv 246 11 17920
s_add_u32 m0, s65, 90112
mvva 164 44 92
dma 4 44 88 0
mvva 160 44 88
trv 32 11 24576
fma 30 30 20 20
mvva 160 40 72
exp 31 31
mvva 156 40 68
trv 34 11 25088
fma 31 31 20 20
mvva 156 44 84
rcp 28 28
mvva 152 44 80
trv 36 11 25600
mul 104 28 104
mvva 152 40 64
mul 24 17 92
wl 3
mvva 152 48 96
dma 5 44 88 1024
mvva 152 52 112
trv 38 11 26112
mul 25 17 93
mvva 156 52 116
trv 40 10 24576
mul 26 17 94
L_pgf1:
s_cbranch_execz L_pgf5
mvva 156 48 100
rcp 29 29
mvva 160 48 104
trv 42 10 25088
mul 105 29 105
mvva 160 52 120
rcp 30 30
mvva 164 52 124
trv 44 10 25600
mul 106 30 106
mvva 164 48 108
rcp 31 31
mvva 180 240 108
trv 46 10 26112
mul 107 31 107
mvva 180 244 124
s_waitcnt vmcnt(12)
s_barrier
mvva 176 244 120
s_add_u32 m0, s65, 16384
trv 48 10 0
mvva 176 240 104
dma 4 44 89 0
mvva 172 240 100
trv 50 10 512
mul 27 17 95
mvva 172 244 116
exp 24 24
mvva 168 244 112
trv 52 10 1024
fma 24 24 21 21
mvva 168 240 96
wl 3
mvva 168 32 128
trv 54 10 1536
mvva 168 36 144
dma 5 44 89 1024
mvva 172 36 148
trv 240 11 0
mvva 172 32 132
exp 25 25
mvva 176 32 136
trv 242 11 512
fma 25 25 21 21
mvva 176 36 152
exp 26 26
mvva 180 36 156
trv 244 11 1024
fma 26 26 21 21
mvva 180 32 140
exp 27 27
mvva 164 40 140
trv 246 11 1536
s_add_u32 m0, s65, 24576
mvva 164 44 156
dma 4 44 90 0
mvva 160 44 152
trv 32 11 8192
fma 27 27 21 21
mvva 160 40 136
rcp 24 24
mvva 156 40 132
trv 34 11 8704
mul 92 24 92
mvva 156 44 148
rcp 25 25
mvva 152 44 144
trv 36 11 9216
mul 93 25 93
mvva 152 40 128
mul 28 17 108
wl 3
mvva 152 48 160
dma 5 44 90 1024
mvva 152 52 176
trv 38 11 9728
rcp 26 26
mvva 156 52 180
trv 40 10 8192
mul 94 26 94
mvva 156 48 164
rcp 27 27
mvva 160 48 168
trv 42 10 8704
mul 95 27 95
mvva 160 52 184
exp 28 28
mvva 164 52 188
buffer_load_dword v249, v3, s[44:47], 0 offen offset:128
mvva 164 48 172
trv 44 10 9216
mul 29 17 109
mvva 180 240 172
trv 46 10 9728
mul 30 17 110
mvva 180 244 188
s_waitcnt vmcnt(13)
s_barrier
mvva 176 244 184
s_add_u32 m0, s65, 32768
trv 48 8 49152
mvva 176 240 168
dma 4 44 91 0
mvva 172 240 164
trv 50 8 49664
mul 31 17 111
mvva 172 244 180
exp 29 29
mvva 168 244 176
trv 52 8 50176
fma 28 28 21 21
mvva 168 240 160
fma 29 29 21 21
wl 3
mvva 168 32 192
trv 54 8 50688
exp 30 30
mvva 168 36 208
dma 5 44 91 1024
mvva 172 36 212
trv 240 9 49152
exp 31 31
mvva 172 32 196
rcp 28 28
mvva 176 32 200
trv 242 9 49664
fma 30 30 21 21
mvva 176 36 216
rcp 29 29
mvva 180 36 220
trv 244 9 50176
fma 31 31 21 21
mvva 180 32 204
rcp 30 30
mvva 164 40 204
trv 246 9 50688
s_add_u32 m0, s65, 40960
mvva 164 44 220
dma 4 44 96 0
mvva 160 44 216
trv 32 9 57344
mul 108 28 108
mvva 160 40 200
rcp 31 31
mvva 156 40 196
trv 34 9 57856
mul 109 29 109
mvva 156 44 212
mul 110 30 110
mul 111 31 111
mvva 152 44 208
trv 36 9 58368
mul 24 18 96
mvva 152 40 192
mul 25 18 97
wl 3
mvva 152 48 224
dma 5 44 96 1024
mvva 152 52 240
trv 38 9 58880
mul 26 18 98
mvva 156 52 244
trv 40 8 57344
mul 27 18 99
mvva 156 48 228
exp 24 24
mvva 160 48 232
trv 42 8 57856
fma 24 24 22 22
mvva 160 52 248
exp 25 25
mvva 164 52 252
trv 44 8 58368
fma 25 25 22 22
mvva 164 48 236
exp 26 26
mvva 180 240 236
trv 46 8 58880
fma 26 26 22 22
mvva 180 244 252
s_waitcnt vmcnt(13)
s_barrier
mvva 176 244 248
s_add_u32 m0, s65, 131072
trv 48 8 32768
mvva 176 240 232
dma 4 44 97 0
mvva 172 240 228
trv 50 8 33280
mul 28 18 112
mvva 172 244 244
exp 27 27
mvva 168 244 240
trv 52 8 33792
fma 27 27 22 22
mvva 168 240 224
mul 29 18 113
wl 3
mvvv 168 32 56
trv 54 8 34304
mul 30 18 114
mvvv 168 36 72
dma 5 44 97 1024
mvvv 172 36 76
trv 240 9 32768
mul 31 18 115
mvvv 172 32 60
rcp 24 24
mvvv 176 32 64
trv 242 9 33280
mul 96 24 96
mvvv 176 36 80
rcp 25 25
mvvv 180 36 84
trv 244 9 33792
mul 97 25 97
mvvv 180 32 68
rcp 26 26
mvvv 164 40 68
trv 246 9 34304
mul 98 26 98
mvvv 164 44 84
s_add_u32 s48, s48, 128
s_addc_u32 s49, s49, 0
mvvv 160 44 80
s_sub_u32 s50, s50, 128
s_add_u32 m0, s65, 139264
mvvv 160 40 64
buffer_load_dwordx4 v4, s[48:51], 0 offen lds
mvvv 156 40 60
trv 32 9 40960
rcp 27 27
mvvv 156 44 76
trv 34 9 41472
mul 99 27 99
mvvv 152 44 72
trv 36 9 41984
mvvv 152 40 56
wl 3
mzvva 120 48 0
buffer_load_dwordx4 v5, s[48:51], 0 offen offset:1024 lds
mvva 120 52 16
trv 38 9 42496
mzvva 124 52 20
trv 40 8 40960
exp 28 28
mvva 124 48 4
exp 29 29
mzvva 128 48 8
trv 42 8 41472
fma 28 28 22 22
mvva 128 52 24
exp 30 30
mzvva 132 52 28
trv 44 8 41984
fma 29 29 22 22
mvva 132 48 12
exp 31 31
mzvva 148 240 12
trv 46 8 42496
fma 30 30 22 22
mvva 148 244 28
s_waitcnt vmcnt(13)
s_barrier
mzvva 144 244 24
s_add_u32 m0, s65, 114688
trv 48 8 16384
mvva 144 240 8
dma 4 48 76 0
mzvva 140 240 4
trv 50 8 16896
fma 31 31 22 22
mvva 140 244 20
rcp 28 28
mzvva 136 244 16
trv 52 8 17408
mul 112 28 112
mvva 136 240 0
rcp 29 29
wl 3
mvva 136 32 32
trv 54 8 17920
mul 113 29 113
mvva 136 36 48
dma 5 48 76 1024
mul 24 19 100
mvva 140 36 52
trv 240 9 16384
rcp 30 30
mvva 140 32 36
rcp 31 31
mvva 144 32 40
trv 242 9 16896
mul 114 30 114
mvva 144 36 56
exp 24 24
mvva 148 36 60
trv 244 9 17408
mul 115 31 115
mvva 148 32 44
mul 25 19 101
mul 26 19 102
mvva 132 40 44
trv 246 9 17920
s_add_u32 m0, s65, 122880
mvva 132 44 60
dma 4 48 77 0
mvva 128 44 56
trv 32 9 24576
mul 27 19 103
mvva 128 40 40
exp 25 25
mvva 124 40 36
trv 34 9 25088
fma 24 24 23 23
mvva 124 44 52
exp 26 26
mvva 120 44 48
trv 36 9 25600
fma 25 25 23 23
mvva 120 40 32
fma 26 26 23 23
wl 3
mvva 120 48 64
dma 5 48 77 1024
mvva 120 52 80
trv 38 9 26112
mul 28 19 116
mvva 124 52 84
trv 40 8 24576
mul 29 19 117
mvva 124 48 68
exp 27 27
mvva 128 48 72
trv 42 8 25088
fma 27 27 23 23
mvva 128 52 88
rcp 24 24
mvva 132 52 92
trv 44 8 25600
mul 100 24 100
mvva 132 48 76
rcp 25 25
mvva 148 240 76
trv 46 8 26112
mul 101 25 101
mvva 148 244 92
s_waitcnt vmcnt(13)
s_barrier
mvva 144 244 88
s_add_u32 m0, s65, 98304
trv 48 6 16384
mvva 144 240 72
dma 4 48 88 0
mvva 140 240 68
trv 50 6 16896
rcp 26 26
mvva 140 244 84
rcp 27 27
mvva 136 244 80
trv 52 6 17408
mul 102 26 102
mvva 136 240 64
mul 103 27 103
wl 3
mvva 136 32 96
trv 54 6 17920
mul 30 19 118
mvva 136 36 112
dma 5 48 88 1024
mvva 140 36 116
trv 240 7 16384
mul 31 19 119
mvva 140 32 100
exp 28 28
mvva 144 32 104
trv 242 7 16896
fma 28 28 23 23
mvva 144 36 120
exp 29 29
mvva 148 36 124
trv 244 7 17408
fma 29 29 23 23
mvva 148 32 108
exp 30 30
mvva 132 40 108
trv 246 7 17920
s_add_u32 m0, s65, 106496
mvva 132 44 124
dma 4 48 89 0
mvva 128 44 120
trv 32 7 24576
fma 30 30 23 23
mvva 128 40 104
exp 31 31
mvva 124 40 100
trv 34 7 25088
fma 31 31 23 23
mvva 124 44 116
rcp 28 28
mvva 120 44 112
trv 36 7 25600
mul 116 28 116
mvva 120 40 96
mul 152 88 152
wl 3
mvva 120 48 128
dma 5 48 89 1024
mvva 120 52 144
trv 38 7 26112
mul 153 89 153
mvva 124 52 148
trv 40 6 24576
mul 154 90 154
mvva 124 48 132
rcp 29 29
mvva 128 48 136
trv 42 6 25088
mul 117 29 117
mvva 128 52 152
rcp 30 30
mvva 132 52 156
trv 44 6 25600
mul 118 30 118
mvva 132 48 140
rcp 31 31
mvva 148 240 140
trv 46 6 26112
mul 119 31 119
mvva 148 244 156
s_waitcnt vmcnt(12)
s_barrier
mvva 144 244 152
s_add_u32 m0, s65, 81920
trv 48 6 32768
mvva 144 240 136
dma 4 48 90 0
mvva 140 240 132
trv 50 6 33280
mul 155 91 155
mvva 140 244 148
mul 168 104 168
mul 169 105 169
mvva 136 244 144
trv 52 6 33792
mul 170 106 170
mvva 136 240 128
mul 171 107 171
wl 3
mvva 136 32 160
trv 54 6 34304
cvt 88 152 153
mvva 136 36 176
dma 5 48 90 1024
mvva 140 36 180
trv 240 7 32768
cvt 89 154 155
mvva 140 32 164
cvt 90 168 169
cvt 91 170 171
mvva 144 32 168
ds_write_b128 v12, v[88:91] offset:49152
mvva 144 36 184
trv 242 7 33280
mul 157 93 157
mvva 148 36 188
buffer_load_dword v249, v3, s[48:51], 0 offen offset:128
mvva 148 32 172
trv 244 7 33792
mul 158 94 158
mvva 132 40 172
trv 246 7 34304
s_add_u32 m0, s65, 90112
mvva 132 44 188
dma 4 48 91 0
mvva 128 44 184
trv 32 7 40960
mul 156 92 156
mvva 128 40 168
mul 159 95 159
mul 173 109 173
mvva 124 40 164
trv 34 7 41472
mul 172 108 172
mvva 124 44 180
mul 175 111 175
cvt 92 156 157
mvva 120 44 176
trv 36 7 41984
mul 174 110 174
mvva 120 40 160
cvt 94 172 173
wl 3
mvva 120 48 192
dma 5 48 91 1024
mvva 120 52 208
trv 38 7 42496
cvt 93 158 159
mvva 124 52 212
trv 40 6 40960
cvt 95 174 175
mvva 124 48 196
mul 160 96 160
mul 161 97 161
mvva 128 48 200
ds_write_b128 v12, v[92:95] offset:50176
mvva 128 52 216
trv 42 6 41472
mul 163 99 163
mvva 132 52 220
trv 44 6 41984
mul 176 112 176
mvva 132 48 204
mul 177 113 177
mul 178 114 178
mvva 148 240 204
trv 46 6 42496
mul 179 115 179
mvva 148 244 220
s_waitcnt vmcnt(13)
s_barrier
mvva 144 244 216
s_add_u32 m0, s65, 49152
trv 48 10 0
mvva 144 240 200
dma 4 48 96 0
mvva 140 240 196
trv 50 10 512
mul 162 98 162
mvva 140 244 212
cvt 97 162 163
cvt 98 176 177
mvva 136 244 208
trv 52 10 1024
cvt 99 178 179
mvva 136 240 192
mul 164 100 164
wl 3
mvva 136 32 224
trv 54 10 1536
cvt 96 160 161
mvva 136 36 240
dma 5 48 96 1024
mvva 140 36 244
trv 240 11 0
mul 165 101 165
mvva 140 32 228
mul 166 102 166
mul 167 103 167
mvva 144 32 232
ds_write_b128 v12, v[96:99] offset:51200
mvva 144 36 248
trv 242 11 512
mul 181 117 181
mvva 148 36 252
trv 244 11 1024
mul 182 118 182
mvva 148 32 236
mul 183 119 183
cvt 100 164 165
mvva 132 40 236
trv 246 11 1536
s_add_u32 m0, s65, 57344
mvva 132 44 252
dma 4 48 97 0
mvva 128 44 248
trv 32 11 8192
cvt 101 166 167
mvva 128 40 232
cvt 103 182 183
mvva 124 40 228
trv 34 11 8704
mul 180 116 180
mvva 124 44 244
mvva 120 44 240
trv 36 11 9216
mvva 120 40 224
wl 3
mvvv 120 48 56
dma 5 48 97 1024
mvvv 120 52 72
trv 38 11 9728
mvvv 124 52 76
trv 40 10 8192
cvt 102 180 181
mvvv 124 48 60
mvvv 128 48 64
trv 42 10 8704
mvvv 128 52 80
ds_write_b128 v12, v[100:103] offset:52224
mvvv 132 52 84
trv 44 10 9216
L_pgf2:
s_cbranch_execz L_pgf6
mvvv 132 48 68
mvvv 148 240 68
trv 46 10 9728
mvvv 148 244 84
s_waitcnt vmcnt(13)
s_barrier
mvvv 144 244 80
s_add_u32 s44, s44, 128
s_addc_u32 s45, s45, 0
mvvv 144 240 64
s_sub_u32 s46, s46, 128
s_add_u32 m0, s65, 65536
mvvv 140 240 60
trv 48 8 49152
mvvv 140 244 76
buffer_load_dwordx4 v4, s[44:47], 0 offen lds
mvvv 136 244 72
trv 50 8 49664
mvvv 136 240 56
trv 52 8 50176
wl 3
mzvva 168 32 0
trv 54 8 50688
mvva 168 36 16
buffer_load_dwordx4 v5, s[44:47], 0 offen offset:1024 lds
mzvva 172 36 20
trv 240 9 49152
mvva 172 32 4
mul 24 16 120
mul 25 16 121
mzvva 176 32 8
trv 242 9 49664
mul 26 16 122
mvva 176 36 24
exp 24 24
mzvva 180 36 28
trv 244 9 50176
mul 27 16 123
mvva 180 32 12
exp 25 25
mzvva 164 40 12
trv 246 9 50688
s_add_u32 m0, s65, 73728
mvva 164 44 28
dma 4 44 76 0
mzvva 160 44 24
trv 32 9 57344
fma 24 24 20 20
mvva 160 40 8
exp 26 26
mzvva 156 40 4
trv 34 9 57856
fma 25 25 20 20
mvva 156 44 20
exp 27 27
mzvva 152 44 16
trv 36 9 58368
fma 27 27 20 20
mvva 152 40 0
fma 26 26 20 20
wl 3
mvva 152 48 32
dma 5 44 76 1024
mvva 152 52 48
trv 38 9 58880
mul 28 16 136
mvva 156 52 52
trv 40 8 57344
mul 29 16 137
mvva 156 48 36
rcp 24 24
mvva 160 48 40
trv 42 8 57856
mul 120 24 120
mvva 160 52 56
rcp 25 25
mvva 164 52 60
trv 44 8 58368
mul 121 25 121
mvva 164 48 44
rcp 26 26
mvva 180 240 44
trv 46 8 58880
mul 122 26 122
mvva 180 244 60
s_waitcnt vmcnt(13)
s_barrier
mvva 176 244 56
s_add_u32 m0, s65, 0
trv 48 8 32768
mvva 176 240 40
dma 4 44 77 0
mvva 172 240 36
trv 50 8 33280
mul 30 16 138
mvva 172 244 52
rcp 27 27
mvva 168 244 48
trv 52 8 33792
mul 123 27 123
mvva 168 240 32
mul 31 16 139
wl 3
mvva 168 32 64
trv 54 8 34304
mvva 168 36 80
dma 5 44 77 1024
mvva 172 36 84
trv 240 9 32768
mvva 172 32 68
exp 28 28
mvva 176 32 72
trv 242 9 33280
fma 28 28 20 20
mvva 176 36 88
exp 29 29
mvva 180 36 92
trv 244 9 33792
fma 29 29 20 20
mvva 180 32 76
exp 30 30
mvva 164 40 76
trv 246 9 34304
s_add_u32 m0, s65, 8192
mvva 164 44 92
dma 4 44 88 0
mvva 160 44 88
trv 32 9 40960
fma 30 30 20 20
mvva 160 40 72
exp 31 31
mvva 156 40 68
trv 34 9 41472
fma 31 31 20 20
mvva 156 44 84
rcp 28 28
mvva 152 44 80
trv 36 9 41984
mul 136 28 136
mvva 152 40 64
mul 24 17 124
wl 3
mvva 152 48 96
dma 5 44 88 1024
mvva 152 52 112
trv 38 9 42496
mul 25 17 125
mvva 156 52 116
trv 40 8 40960
mul 26 17 126
mvva 156 48 100
rcp 29 29
mvva 160 48 104
trv 42 8 41472
mul 137 29 137
mvva 160 52 120
rcp 30 30
mvva 164 52 124
trv 44 8 41984
mul 138 30 138
mvva 164 48 108
rcp 31 31
mvva 180 240 108
trv 46 8 42496
mul 139 31 139
mvva 180 244 124
s_waitcnt vmcnt(12)
s_barrier
mvva 176 244 120
s_add_u32 m0, s65, 114688
trv 48 8 16384
mvva 176 240 104
dma 4 44 89 0
mvva 172 240 100
trv 50 8 16896
mul 27 17 127
mvva 172 244 116
exp 24 24
mvva 168 244 112
trv 52 8 17408
fma 24 24 21 21
mvva 168 240 96
wl 3
mvva 168 32 128
trv 54 8 17920
mvva 168 36 144
dma 5 44 89 1024
mvva 172 36 148
trv 240 9 16384
mvva 172 32 132
exp 25 25
mvva 176 32 136
trv 242 9 16896
fma 25 25 21 21
mvva 176 36 152
exp 26 26
mvva 180 36 156
trv 244 9 17408
fma 26 26 21 21
mvva 180 32 140
exp 27 27
mvva 164 40 140
trv 246 9 17920
s_add_u32 m0, s65, 122880
mvva 164 44 156
dma 4 44 90 0
mvva 160 44 152
trv 32 9 24576
fma 27 27 21 21
mvva 160 40 136
rcp 24 24
mvva 156 40 132
trv 34 9 25088
mul 124 24 124
mvva 156 44 148
rcp 25 25
mvva 152 44 144
trv 36 9 25600
mul 125 25 125
mvva 152 40 128
mul 28 17 140
wl 3
mvva 152 48 160
dma 5 44 90 1024
mvva 152 52 176
trv 38 9 26112
rcp 26 26
mvva 156 52 180
trv 40 8 24576
mul 126 26 126
mvva 156 48 164
rcp 27 27
mvva 160 48 168
trv 42 8 25088
mul 127 27 127
mvva 160 52 184
exp 28 28
mvva 164 52 188
buffer_load_dword v249, v3, s[44:47], 0 offen offset:128
mvva 164 48 172
trv 44 8 25600
mul 29 17 141
mvva 180 240 172
trv 46 8 26112
mul 30 17 142
mvva 180 244 188
s_waitcnt vmcnt(13)
s_barrier
mvva 176 244 184
s_add_u32 m0, s65, 98304
trv 48 6 49152
mvva 176 240 168
dma 4 44 91 0
mvva 172 240 164
trv 50 6 49664
mul 31 17 143
mvva 172 244 180
exp 29 29
mvva 168 244 176
trv 52 6 50176
fma 28 28 21 21
mvva 168 240 160
fma 29 29 21 21
wl 3
mvva 168 32 192
trv 54 6 50688
exp 30 30
mvva 168 36 208
dma 5 44 91 1024
mvva 172 36 212
trv 240 7 49152
exp 31 31
mvva 172 32 196
rcp 28 28
mvva 176 32 200
trv 242 7 49664
fma 30 30 21 21
mvva 176 36 216
rcp 29 29
mvva 180 36 220
trv 244 7 50176
fma 31 31 21 21
mvva 180 32 204
rcp 30 30
mvva 164 40 204
trv 246 7 50688
s_add_u32 m0, s65, 106496
mvva 164 44 220
dma 4 44 96 0
mvva 160 44 216
trv 32 7 57344
mul 140 28 140
mvva 160 40 200
rcp 31 31
mvva 156 40 196
trv 34 7 57856
mul 141 29 141
mvva 156 44 212
mul 142 30 142
mul 143 31 143
mvva 152 44 208
trv 36 7 58368
mul 24 18 128
mvva 152 40 192
mul 25 18 129
wl 3
mvva 152 48 224
dma 5 44 96 1024
mvva 152 52 240
trv 38 7 58880
mul 26 18 130
mvva 156 52 244
trv 40 6 57344
mul 27 18 131
mvva 156 48 228
exp 24 24
mvva 160 48 232
trv 42 6 57856
fma 24 24 22 22
mvva 160 52 248
exp 25 25
mvva 164 52 252
trv 44 6 58368
fma 25 25 22 22
mvva 164 48 236
exp 26 26
mvva 180 240 236
trv 46 6 58880
fma 26 26 22 22
mvva 180 244 252
s_waitcnt vmcnt(13)
s_barrier
mvva 176 244 248
s_add_u32 m0, s65, 81920
trv 48 8 0
mvva 176 240 232
dma 4 44 97 0
mvva 172 240 228
trv 50 8 512
mul 28 18 144
mvva 172 244 244
exp 27 27
mvva 168 244 240
trv 52 8 1024
fma 27 27 22 22
mvva 168 240 224
mul 29 18 145
wl 3
mvvv 168 32 56
trv 54 8 1536
mul 30 18 146
mvvv 168 36 72
dma 5 44 97 1024
mvvv 172 36 76
trv 240 9 0
mul 31 18 147
mvvv 172 32 60
rcp 24 24
mvvv 176 32 64
trv 242 9 512
mul 128 24 128
mvvv 176 36 80
rcp 25 25
mvvv 180 36 84
trv 244 9 1024
mul 129 25 129
mvvv 180 32 68
rcp 26 26
mvvv 164 40 68
trv 246 9 1536
mul 130 26 130
mvvv 164 44 84
s_add_u32 s48, s48, 128
s_addc_u32 s49, s49, 0
mvvv 160 44 80
s_sub_u32 s50, s50, 128
s_add_u32 m0, s65, 90112
mvvv 160 40 64
buffer_load_dwordx4 v4, s[48:51], 0 offen lds
mvvv 156 40 60
trv 32 9 8192
rcp 27 27
mvvv 156 44 76
trv 34 9 8704
mul 131 27 131
mvvv 152 44 72
trv 36 9 9216
mvvv 152 40 56
wl 3
mzvva 88 48 0
buffer_load_dwordx4 v5, s[48:51], 0 offen offset:1024 lds
mvva 88 52 16
trv 38 9 9728
mzvva 92 52 20
trv 40 8 8192
exp 28 28
mvva 92 48 4
exp 29 29
mzvva 96 48 8
trv 42 8 8704
fma 28 28 22 22
mvva 96 52 24
exp 30 30
mzvva 100 52 28
trv 44 8 9216
fma 29 29 22 22
mvva 100 48 12
exp 31 31
mzvva 116 240 12
trv 46 8 9728
fma 30 30 22 22
mvva 116 244 28
s_waitcnt vmcnt(13)
s_barrier
mzvva 112 244 24
s_add_u32 m0, s65, 16384
trv 48 6 0
mvva 112 240 8
dma 4 48 76 0
mzvva 108 240 4
trv 50 6 512
fma 31 31 22 22
mvva 108 244 20
rcp 28 28
mzvva 104 244 16
trv 52 6 1024
mul 144 28 144
mvva 104 240 0
rcp 29 29
wl 3
mvva 104 32 32
trv 54 6 1536
mul 145 29 145
mvva 104 36 48
dma 5 48 76 1024
mul 24 19 132
mvva 108 36 52
trv 240 7 0
rcp 30 30
mvva 108 32 36
rcp 31 31
mvva 112 32 40
trv 242 7 512
mul 146 30 146
mvva 112 36 56
exp 24 24
mvva 116 36 60
trv 244 7 1024
mul 147 31 147
mvva 116 32 44
mul 25 19 133
mul 26 19 134
mvva 100 40 44
trv 246 7 1536
s_add_u32 m0, s65, 24576
mvva 100 44 60
dma 4 48 77 0
mvva 96 44 56
trv 32 7 8192
mul 27 19 135
mvva 96 40 40
exp 25 25
mvva 92 40 36
trv 34 7 8704
fma 24 24 23 23
mvva 92 44 52
exp 26 26
mvva 88 44 48
trv 36 7 9216
fma 25 25 23 23
mvva 88 40 32
fma 26 26 23 23
wl 3
mvva 88 48 64
dma 5 48 77 1024
mvva 88 52 80
trv 38 7 9728
mul 28 19 148
mvva 92 52 84
trv 40 6 8192
mul 29 19 149
mvva 92 48 68
exp 27 27
mvva 96 48 72
trv 42 6 8704
fma 27 27 23 23
mvva 96 52 88
rcp 24 24
mvva 100 52 92
trv 44 6 9216
mul 132 24 132
mvva 100 48 76
rcp 25 25
mvva 116 240 76
trv 46 6 9728
mul 133 25 133
mvva 116 244 92
s_waitcnt vmcnt(13)
s_barrier
mvva 112 244 88
s_add_u32 m0, s65, 32768
trv 48 8 49152
mvva 112 240 72
dma 4 48 88 0
mvva 108 240 68
trv 50 8 49664
rcp 26 26
mvva 108 244 84
rcp 27 27
mvva 104 244 80
trv 52 8 50176
mul 134 26 134
mvva 104 240 64
mul 135 27 135
wl 3
mvva 104 32 96
trv 54 8 50688
mul 30 19 150
mvva 104 36 112
dma 5 48 88 1024
mvva 108 36 116
trv 240 9 49152
mul 31 19 151
mvva 108 32 100
exp 28 28
mvva 112 32 104
trv 242 9 49664
fma 28 28 23 23
mvva 112 36 120
exp 29 29
mvva 116 36 124
trv 244 9 50176
fma 29 29 23 23
mvva 116 32 108
exp 30 30
mvva 100 40 108
trv 246 9 50688
s_add_u32 m0, s65, 40960
mvva 100 44 124
dma 4 48 89 0
mvva 96 44 120
trv 32 9 57344
fma 30 30 23 23
mvva 96 40 104
exp 31 31
mvva 92 40 100
trv 34 9 57856
fma 31 31 23 23
mvva 92 44 116
rcp 28 28
mvva 88 44 112
trv 36 9 58368
mul 148 28 148
mvva 88 40 96
mul 152 120 152
wl 3
mvva 88 48 128
dma 5 48 89 1024
mvva 88 52 144
trv 38 9 58880
mul 153 121 153
mvva 92 52 148
trv 40 8 57344
mul 154 122 154
mvva 92 48 132
rcp 29 29
mvva 96 48 136
trv 42 8 57856
mul 149 29 149
mvva 96 52 152
rcp 30 30
mvva 100 52 156
trv 44 8 58368
mul 150 30 150
mvva 100 48 140
rcp 31 31
mvva 116 240 140
trv 46 8 58880
mul 151 31 151
mvva 116 244 156
s_waitcnt vmcnt(12)
s_barrier
mvva 112 244 152
s_add_u32 m0, s65, 49152
trv 48 8 32768
mvva 112 240 136
dma 4 48 90 0
mvva 108 240 132
trv 50 8 33280
mul 155 123 155
mvva 108 244 148
mul 168 136 168
mul 169 137 169
mvva 104 244 144
trv 52 8 33792
L_pgf3:
s_cbranch_execz L_pgf7
mul 170 138 170
mvva 104 240 128
mul 171 139 171
wl 3
mvva 104 32 160
trv 54 8 34304
cvt 120 152 153
mvva 104 36 176
dma 5 48 90 1024
mvva 108 36 180
trv 240 9 32768
cvt 121 154 155
mvva 108 32 164
cvt 122 168 169
cvt 123 170 171
mvva 112 32 168
ds_write_b128 v12, v[120:123] offset:32768
mvva 112 36 184
trv 242 9 33280
mul 157 125 157
mvva 116 36 188
buffer_load_dword v249, v3, s[48:51], 0 offen offset:128
mvva 116 32 172
trv 244 9 33792
mul 158 126 158
mvva 100 40 172
trv 246 9 34304
s_add_u32 m0, s65, 57344
mvva 100 44 188
dma 4 48 91 0
mvva 96 44 184
trv 32 9 40960
mul 156 124 156
mvva 96 40 168
mul 159 127 159
mul 173 141 173
mvva 92 40 164
trv 34 9 41472
mul 172 140 172
mvva 92 44 180
mul 175 143 175
cvt 124 156 157
mvva 88 44 176
trv 36 9 41984
mul 174 142 174
mvva 88 40 160
cvt 126 172 173
wl 3
mvva 88 48 192
dma 5 48 91 1024
mvva 88 52 208
trv 38 9 42496
cvt 125 158 159
mvva 92 52 212
trv 40 8 40960
cvt 127 174 175
mvva 92 48 196
mul 160 128 160
mul 161 129 161
mvva 96 48 200
ds_write_b128 v12, v[124:127] offset:33792
mvva 96 52 216
trv 42 8 41472
mul 163 131 163
mvva 100 52 220
trv 44 8 41984
mul 176 144 176
mvva 100 48 204
mul 177 145 177
mul 178 146 178
mvva 116 240 204
trv 46 8 42496
mul 179 147 179
mvva 116 244 220
s_waitcnt vmcnt(13)
s_barrier
mvva 112 244 216
s_add_u32 m0, s65, 65536
trv 48 8 16384
mvva 112 240 200
dma 4 48 96 0
mvva 108 240 196
trv 50 8 16896
mul 162 130 162
mvva 108 244 212
cvt 129 162 163
cvt 130 176 177
mvva 104 244 208
trv 52 8 17408
cvt 131 178 179
mvva 104 240 192
mul 164 132 164
wl 3
mvva 104 32 224
trv 54 8 17920
cvt 128 160 161
mvva 104 36 240
dma 5 48 96 1024
mvva 108 36 244
trv 240 9 16384
mul 165 133 165
mvva 108 32 228
mul 166 134 166
mul 167 135 167
mvva 112 32 232
ds_write_b128 v12, v[128:131] offset:34816
mvva 112 36 248
trv 242 9 16896
mul 181 149 181
mvva 116 36 252
trv 244 9 17408
mul 182 150 182
mvva 116 32 236
mul 183 151 183
cvt 132 164 165
mvva 100 40 236
trv 246 9 17920
s_add_u32 m0, s65, 73728
mvva 100 44 252
dma 4 48 97 0
mvva 96 44 248
trv 32 9 24576
cvt 133 166 167
mvva 96 40 232
cvt 135 182 183
mvva 92 40 228
trv 34 9 25088
mul 180 148 180
mvva 92 44 244
mvva 88 44 240
trv 36 9 25600
mvva 88 40 224
wl 3
mvvv 88 48 56
dma 5 48 97 1024
mvvv 88 52 72
trv 38 9 26112
mvvv 92 52 76
trv 40 8 24576
cvt 134 180 181
mvvv 92 48 60
mvvv 96 48 64
trv 42 8 25088
mvvv 96 52 80
ds_write_b128 v12, v[132:135] offset:35840
mvvv 100 52 84
trv 44 8 25600
mvvv 100 48 68
mvvv 116 240 68
trv 46 8 26112
mvvv 116 244 84
s_waitcnt vmcnt(13)
s_barrier
mvvv 112 244 80
s_add_u32 s44, s44, 128
s_addc_u32 s45, s45, 0
mvvv 112 240 64
s_sub_u32 s46, s46, 128
s_add_u32 m0, s65, 98304
mvvv 108 240 60
trv 48 6 16384
mvvv 108 244 76
buffer_load_dwordx4 v4, s[44:47], 0 offen lds
mvvv 104 244 72
trv 50 6 16896
mvvv 104 240 56
trv 52 6 17408
wl 3
mzvva 168 32 0
trv 54 6 17920
mvva 168 36 16
buffer_load_dwordx4 v5, s[44:47], 0 offen offset:1024 lds
mzvva 172 36 20
trv 240 7 16384
mvva 172 32 4
mul 24 16 88
mul 25 16 89
mzvva 176 32 8
trv 242 7 16896
mul 26 16 90
mvva 176 36 24
exp 24 24
mzvva 180 36 28
trv 244 7 17408
mul 27 16 91
mvva 180 32 12
exp 25 25
mzvva 164 40 12
trv 246 7 17920
s_add_u32 m0, s65, 106496
mvva 164 44 28
dma 4 44 76 0
mzvva 160 44 24
trv 32 7 24576
fma 24 24 20 20
mvva 160 40 8
exp 26 26
mzvva 156 40 4
trv 34 7 25088
fma 25 25 20 20
mvva 156 44 20
exp 27 27
mzvva 152 44 16
trv 36 7 25600
fma 27 27 20 20
mvva 152 40 0
fma 26 26 20 20
wl 3
mvva 152 48 32
dma 5 44 76 1024
mvva 152 52 48
trv 38 7 26112
mul 28 16 104
mvva 156 52 52
trv 40 6 24576
mul 29 16 105
mvva 156 48 36
rcp 24 24
mvva 160 48 40
trv 42 6 25088
mul 88 24 88
mvva 160 52 56
rcp 25 25
mvva 164 52 60
trv 44 6 25600
mul 89 25 89
mvva 164 48 44
rcp 26 26
mvva 180 240 44
trv 46 6 26112
mul 90 26 90
mvva 180 244 60
s_waitcnt vmcnt(13)
s_barrier
mvva 176 244 56
s_add_u32 m0, s65, 81920
trv 48 6 32768
mvva 176 240 40
dma 4 44 77 0
mvva 172 240 36
trv 50 6 33280
mul 30 16 106
mvva 172 244 52
rcp 27 27
mvva 168 244 48
trv 52 6 33792
mul 91 27 91
mvva 168 240 32
mul 31 16 107
wl 3
mvva 168 32 64
trv 54 6 34304
mvva 168 36 80
dma 5 44 77 1024
mvva 172 36 84
trv 240 7 32768
mvva 172 32 68
exp 28 28
mvva 176 32 72
trv 242 7 33280
fma 28 28 20 20
mvva 176 36 88
exp 29 29
mvva 180 36 92
trv 244 7 33792
fma 29 29 20 20
mvva 180 32 76
exp 30 30
mvva 164 40 76
trv 246 7 34304
s_add_u32 m0, s65, 90112
mvva 164 44 92
dma 4 44 88 0
mvva 160 44 88
trv 32 7 40960
fma 30 30 20 20
mvva 160 40 72
exp 31 31
mvva 156 40 68
trv 34 7 41472
fma 31 31 20 20
mvva 156 44 84
rcp 28 28
mvva 152 44 80
trv 36 7 41984
mul 104 28 104
mvva 152 40 64
mul 24 17 92
wl 3
mvva 152 48 96
dma 5 44 88 1024
mvva 152 52 112
trv 38 7 42496
mul 25 17 93
mvva 156 52 116
trv 40 6 40960
mul 26 17 94
mvva 156 48 100
rcp 29 29
mvva 160 48 104
trv 42 6 41472
mul 105 29 105
mvva 160 52 120
rcp 30 30
mvva 164 52 124
trv 44 6 41984
mul 106 30 106
mvva 164 48 108
rcp 31 31
mvva 180 240 108
trv 46 6 42496
mul 107 31 107
mvva 180 244 124
s_waitcnt vmcnt(12)
s_barrier
mvva 176 244 120
s_add_u32 m0, s65, 0
trv 48 6 49152
mvva 176 240 104
dma 4 44 89 0
s_mov_b32 s92, s36
mvva 172 240 100
trv 50 6 49664
mul 27 17 95
mvva 172 244 116
exp 24 24
mvva 168 244 112
trv 52 6 50176
s_mov_b32 s93, s37
mvva 168 240 96
fma 24 24 21 21
wl 3
mvva 168 32 128
trv 54 6 50688
s_mov_b32 s94, 64
mvva 168 36 144
dma 5 44 89 1024
mvva 172 36 148
trv 240 7 49152
mvva 172 32 132
exp 25 25
mvva 176 32 136
trv 242 7 49664
s_mov_b32 s95, 0x20000
mvva 176 36 152
exp 26 26
mvva 180 36 156
trv 244 7 50176
fma 25 25 21 21
mvva 180 32 140
exp 27 27
mvva 164 40 140
trv 246 7 50688
s_add_u32 m0, s65, 8192
mvva 164 44 156
dma 4 44 90 0
mvva 160 44 152
trv 32 7 57344
fma 26 26 21 21
mvva 160 40 136
rcp 24 24
mvva 156 40 132
trv 34 7 57856
fma 27 27 21 21
mvva 156 44 148
rcp 25 25
mvva 152 44 144
trv 36 7 58368
v_mov_b32 v249, 1
mvva 152 40 128
mul 92 24 92
wl 3
mvva 152 48 160
buffer_atomic_add v249, v254, s[92:95], 0 offen sc1
mvva 152 52 176
dma 5 44 90 1024
mul 93 25 93
mvva 156 52 180
trv 38 7 58880
rcp 26 26
mvva 156 48 164
trv 40 6 57344
rcp 27 27
mvva 160 48 168
trv 42 6 57856
mul 94 26 94
mvva 160 52 184
mul 95 27 95
mul 28 17 108
mvva 164 52 188
buffer_load_dword v249, v3, s[44:47], 0 offen offset:128
mvva 164 48 172
trv 44 6 58368
mul 29 17 109
mvva 180 240 172
trv 46 6 58880
mul 30 17 110
mvva 180 244 188
s_waitcnt vmcnt(14)
s_barrier
mvva 176 244 184
s_add_u32 m0, s65, 16384
trv 48 8 0
mvva 176 240 168
dma 4 44 91 0
mvva 172 240 164
trv 50 8 512
mul 31 17 111
mvva 172 244 180
exp 28 28
mvva 168 244 176
trv 52 8 1024
exp 29 29
mvva 168 240 160
fma 28 28 21 21
wl 3
mvva 168 32 192
trv 54 8 1536
exp 30 30
mvva 168 36 208
dma 5 44 91 1024
mvva 172 36 212
trv 240 9 0
exp 31 31
mvva 172 32 196
rcp 28 28
mvva 176 32 200
trv 242 9 512
fma 29 29 21 21
mvva 176 36 216
rcp 29 29
mvva 180 36 220
trv 244 9 1024
fma 30 30 21 21
mvva 180 32 204
rcp 30 30
mvva 164 40 204
trv 246 9 1536
s_add_u32 m0, s65, 24576
mvva 164 44 220
dma 4 44 96 0
fma 31 31 21 21
mvva 160 44 216
trv 32 9 8192
mul 108 28 108
mvva 160 40 200
rcp 31 31
mvva 156 40 196
trv 34 9 8704
mul 109 29 109
mvva 156 44 212
mul 110 30 110
mul 111 31 111
mvva 152 44 208
trv 36 9 9216
mul 24 18 96
mvva 152 40 192
mul 25 18 97
wl 3
mvva 152 48 224
dma 5 44 96 1024
mvva 152 52 240
trv 38 9 9728
mul 26 18 98
mvva 156 52 244
trv 40 8 8192
mul 27 18 99
mvva 156 48 228
exp 24 24
mvva 160 48 232
trv 42 8 8704
fma 24 24 22 22
mvva 160 52 248
exp 25 25
mvva 164 52 252
trv 44 8 9216
fma 25 25 22 22
mvva 164 48 236
exp 26 26
mvva 180 240 236
trv 46 8 9728
fma 26 26 22 22
mvva 180 244 252
s_waitcnt vmcnt(14)
s_barrier
mvva 176 244 248
s_add_u32 m0, s65, 32768
trv 48 8 32768
mvva 176 240 232
dma 4 44 97 0
mvva 172 240 228
trv 50 8 33280
mul 28 18 112
mvva 172 244 244
exp 27 27
mvva 168 244 240
trv 52 8 33792
fma 27 27 22 22
mvva 168 240 224
mul 29 18 113
wl 3
mvvv 168 32 56
trv 54 8 34304
mul 30 18 114
mvvv 168 36 72
dma 5 44 97 1024
mvvv 172 36 76
trv 240 9 32768
mul 31 18 115
mvvv 172 32 60
rcp 24 24
mvvv 176 32 64
trv 242 9 33280
mul 96 24 96
mvvv 176 36 80
rcp 25 25
mvvv 180 36 84
trv 244 9 33792
mul 97 25 97
mvvv 180 32 68
rcp 26 26
mvvv 164 40 68
trv 246 9 34304
mul 98 26 98
mvvv 164 44 84
s_add_u32 s48, s48, 128
s_addc_u32 s49, s49, 0
mvvv 160 44 80
s_sub_u32 s50, s50, 128
s_add_u32 m0, s65, 40960
mvvv 160 40 64
buffer_load_dwordx4 v4, s[48:51], 0 offen lds
mvvv 156 40 60
trv 32 9 40960
rcp 27 27
mvvv 156 44 76
trv 34 9 41472
mul 99 27 99
mvvv 152 44 72
trv 36 9 41984
mvvv 152 40 56
wl 3
mzvva 120 48 0
buffer_load_dwordx4 v5, s[48:51], 0 offen offset:1024 lds
mvva 120 52 16
trv 38 9 42496
mzvva 124 52 20
trv 40 8 40960
exp 28 28
mvva 124 48 4
exp 29 29
mzvva 128 48 8
trv 42 8 41472
fma 28 28 22 22
mvva 128 52 24
exp 30 30
mzvva 132 52 28
trv 44 8 41984
fma 29 29 22 22
mvva 132 48 12
exp 31 31
mzvva 148 240 12
trv 46 8 42496
fma 30 30 22 22
mvva 148 244 28
s_waitcnt vmcnt(14)
s_barrier
mzvva 144 244 24
s_add_u32 m0, s65, 49152
trv 48 8 16384
mvva 144 240 8
dma 4 48 76 0
mzvva 140 240 4
trv 50 8 16896
fma 31 31 22 22
mvva 140 244 20
rcp 28 28
mzvva 136 244 16
trv 52 8 17408
mul 112 28 112
mvva 136 240 0
rcp 29 29
wl 3
mvva 136 32 32
trv 54 8 17920
mul 113 29 113
mvva 136 36 48
dma 5 48 76 1024
L_pgf4:
s_cbranch_execz L_pgf8
mul 24 19 100
mvva 140 36 52
trv 240 9 16384
rcp 30 30
mvva 140 32 36
rcp 31 31
mvva 144 32 40
trv 242 9 16896
mul 114 30 114
mvva 144 36 56
exp 24 24
mvva 148 36 60
trv 244 9 17408
mul 115 31 115
mvva 148 32 44
mul 25 19 101
mul 26 19 102
mvva 132 40 44
trv 246 9 17920
s_add_u32 m0, s65, 57344
mvva 132 44 60
dma 4 48 77 0
mvva 128 44 56
trv 32 9 24576
mul 27 19 103
mvva 128 40 40
exp 25 25
mvva 124 40 36
trv 34 9 25088
fma 24 24 23 23
mvva 124 44 52
exp 26 26
mvva 120 44 48
trv 36 9 25600
fma 25 25 23 23
mvva 120 40 32
fma 26 26 23 23
wl 3
mvva 120 48 64
dma 5 48 77 1024
mvva 120 52 80
trv 38 9 26112
mul 28 19 116
mvva 124 52 84
trv 40 8 24576
mul 29 19 117
mvva 124 48 68
exp 27 27
mvva 128 48 72
trv 42 8 25088
fma 27 27 23 23
mvva 128 52 88
rcp 24 24
mvva 132 52 92
trv 44 8 25600
mul 100 24 100
mvva 132 48 76
rcp 25 25
mvva 148 240 76
trv 46 8 26112
mul 101 25 101
mvva 148 244 92
s_waitcnt vmcnt(13)
s_barrier
mvva 144 244 88
s_add_u32 m0, s65, 98304
trv 48 6 0
mvva 144 240 72
dma 4 48 88 0
mvva 140 240 68
trv 50 6 512
rcp 26 26
mvva 140 244 84
rcp 27 27
mvva 136 244 80
trv 52 6 1024
mul 102 26 102
mvva 136 240 64
mul 103 27 103
wl 3
mvva 136 32 96
trv 54 6 1536
mul 30 19 118
mvva 136 36 112
dma 5 48 88 1024
mvva 140 36 116
trv 240 7 0
mul 31 19 119
mvva 140 32 100
exp 28 28
mvva 144 32 104
trv 242 7 512
fma 28 28 23 23
mvva 144 36 120
exp 29 29
mvva 148 36 124
trv 244 7 1024
fma 29 29 23 23
mvva 148 32 108
exp 30 30
mvva 132 40 108
trv 246 7 1536
s_add_u32 m0, s65, 106496
mvva 132 44 124
dma 4 48 89 0
mvva 128 44 120
trv 32 7 8192
fma 30 30 23 23
mvva 128 40 104
exp 31 31
mvva 124 40 100
trv 34 7 8704
fma 31 31 23 23
mvva 124 44 116
rcp 28 28
mvva 120 44 112
trv 36 7 9216
mul 116 28 116
mvva 120 40 96
mul 152 88 152
wl 3
mvva 120 48 128
dma 5 48 89 1024
mvva 120 52 144
trv 38 7 9728
mul 153 89 153
mvva 124 52 148
trv 40 6 8192
mul 154 90 154
mvva 124 48 132
rcp 29 29
mvva 128 48 136
trv 42 6 8704
mul 117 29 117
mvva 128 52 152
rcp 30 30
mvva 132 52 156
trv 44 6 9216
mul 118 30 118
mvva 132 48 140
rcp 31 31
mvva 148 240 140
trv 46 6 9728
mul 119 31 119
mvva 148 244 156
s_waitcnt vmcnt(12)
s_barrier
mvva 144 244 152
s_add_u32 m0, s65, 81920
trv 48 6 16384
mvva 144 240 136
dma 4 48 90 0
mvva 140 240 132
trv 50 6 16896
mul 155 91 155
mvva 140 244 148
mul 168 104 168
mul 169 105 169
mvva 136 244 144
trv 52 6 17408
mul 170 106 170
mvva 136 240 128
mul 171 107 171
wl 3
mvva 136 32 160
trv 54 6 17920
cvt 88 152 153
mvva 136 36 176
dma 5 48 90 1024
mvva 140 36 180
trv 240 7 16384
cvt 89 154 155
mvva 140 32 164
cvt 90 168 169
cvt 91 170 171
mvva 144 32 168
ds_write_b128 v12, v[88:91] offset:16384
mvva 144 36 184
trv 242 7 16896
mul 157 93 157
mvva 148 36 188
buffer_load_dword v249, v3, s[48:51], 0 offen offset:128
mvva 148 32 172
trv 244 7 17408
mul 158 94 158
mvva 132 40 172
trv 246 7 17920
s_add_u32 m0, s65, 90112
mvva 132 44 188
dma 4 48 91 0
mvva 128 44 184
trv 32 7 24576
mul 156 92 156
mvva 128 40 168
mul 159 95 159
mul 173 109 173
mvva 124 40 164
trv 34 7 25088
mul 172 108 172
mvva 124 44 180
mul 175 111 175
cvt 92 156 157
mvva 120 44 176
trv 36 7 25600
mul 174 110 174
mvva 120 40 160
cvt 94 172 173
wl 3
mvva 120 48 192
dma 5 48 91 1024
mvva 120 52 208
trv 38 7 26112
cvt 93 158 159
mvva 124 52 212
trv 40 6 24576
cvt 95 174 175
mvva 124 48 196
mul 160 96 160
mul 161 97 161
mvva 128 48 200
ds_write_b128 v12, v[92:95] offset:17408
mvva 128 52 216
trv 42 6 25088
mul 163 99 163
mvva 132 52 220
trv 44 6 25600
mul 176 112 176
mvva 132 48 204
mul 177 113 177
mul 178 114 178
mvva 148 240 204
trv 46 6 26112
mul 179 115 179
mvva 148 244 220
s_waitcnt vmcnt(13)
s_barrier
mvva 144 244 216
s_add_u32 m0, s65, 65536
trv 48 6 32768
mvva 144 240 200
dma 4 48 96 0
mvva 140 240 196
trv 50 6 33280
mul 162 98 162
mvva 140 244 212
cvt 97 162 163
cvt 98 176 177
mvva 136 244 208
trv 52 6 33792
cvt 99 178 179
mvva 136 240 192
mul 164 100 164
wl 3
mvva 136 32 224
trv 54 6 34304
cvt 96 160 161
mvva 136 36 240
dma 5 48 96 1024
mvva 140 36 244
trv 240 7 32768
mul 165 101 165
mvva 140 32 228
mul 166 102 166
mul 167 103 167
mvva 144 32 232
ds_write_b128 v12, v[96:99] offset:18432
mvva 144 36 248
trv 242 7 33280
mul 181 117 181
mvva 148 36 252
trv 244 7 33792
mul 182 118 182
mvva 148 32 236
mul 183 119 183
cvt 100 164 165
mvva 132 40 236
trv 246 7 34304
s_add_u32 m0, s65, 73728
mvva 132 44 252
dma 4 48 97 0
mvva 128 44 248
trv 32 7 40960
cvt 101 166 167
mvva 128 40 232
cvt 103 182 183
mvva 124 40 228
trv 34 7 41472
mul 180 116 180
mvva 124 44 244
mvva 120 44 240
trv 36 7 41984
mvva 120 40 224
wl 3
mvvv 120 48 56
dma 5 48 97 1024
mvvv 120 52 72
trv 38 7 42496
mvvv 124 52 76
trv 40 6 40960
cvt 102 180 181
mvvv 124 48 60
mvvv 128 48 64
trv 42 6 41472
mvvv 128 52 80
ds_write_b128 v12, v[100:103] offset:19456
mvvv 132 52 84
trv 44 6 41984
mvvv 132 48 68
mvvv 148 240 68
trv 46 6 42496
mvvv 148 244 84
s_waitcnt vmcnt(13)
s_barrier
mvvv 144 244 80
s_add_u32 s44, s44, 128
s_addc_u32 s45, s45, 0
mvvv 144 240 64
s_sub_u32 s46, s46, 128
s_add_u32 m0, s65, 0
mvvv 140 240 60
trv 48 6 49152
mvvv 140 244 76
buffer_load_dwordx4 v4, s[44:47], 0 offen lds
mvvv 136 244 72
trv 50 6 49664
mvvv 136 240 56
trv 52 6 50176
wl 3
mzvva 168 32 0
trv 54 6 50688
mvva 168 36 16
buffer_load_dwordx4 v5, s[44:47], 0 offen offset:1024 lds
mzvva 172 36 20
trv 240 7 49152
mvva 172 32 4
mul 24 16 120
mul 25 16 121
mzvva 176 32 8
trv 242 7 49664
mul 26 16 122
mvva 176 36 24
exp 24 24
mzvva 180 36 28
trv 244 7 50176
mul 27 16 123
mvva 180 32 12
exp 25 25
mzvva 164 40 12
trv 246 7 50688
s_add_u32 m0, s65, 8192
mvva 164 44 28
dma 4 44 76 0
mzvva 160 44 24
trv 32 7 57344
fma 24 24 20 20
mvva 160 40 8
exp 26 26
mzvva 156 40 4
trv 34 7 57856
fma 25 25 20 20
mvva 156 44 20
exp 27 27
mzvva 152 44 16
trv 36 7 58368
fma 27 27 20 20
mvva 152 40 0
fma 26 26 20 20
wl 3
mvva 152 48 32
dma 5 44 76 1024
mvva 152 52 48
trv 38 7 58880
mul 28 16 136
mvva 156 52 52
trv 40 6 57344
mul 29 16 137
mvva 156 48 36
rcp 24 24
mvva 160 48 40
trv 42 6 57856
mul 120 24 120
mvva 160 52 56
rcp 25 25
mvva 164 52 60
trv 44 6 58368
mul 121 25 121
mvva 164 48 44
rcp 26 26
mvva 180 240 44
trv 46 6 58880
mul 122 26 122
mvva 180 244 60
s_waitcnt vmcnt(13)
s_barrier
mvva 176 244 56
s_add_u32 m0, s65, 16384
trv 48 8 32768
mvva 176 240 40
dma 4 44 77 0
mvva 172 240 36
trv 50 8 33280
mul 30 16 138
mvva 172 244 52
rcp 27 27
mvva 168 244 48
trv 52 8 33792
mul 123 27 123
mvva 168 240 32
mul 31 16 139
wl 3
mvva 168 32 64
trv 54 8 34304
mvva 168 36 80
dma 5 44 77 1024
mvva 172 36 84
trv 240 9 32768
mvva 172 32 68
exp 28 28
mvva 176 32 72
trv 242 9 33280
fma 28 28 20 20
mvva 176 36 88
exp 29 29
mvva 180 36 92
trv 244 9 33792
fma 29 29 20 20
mvva 180 32 76
exp 30 30
mvva 164 40 76
trv 246 9 34304
s_add_u32 m0, s65, 24576
mvva 164 44 92
dma 4 44 88 0
mvva 160 44 88
trv 32 9 40960
fma 30 30 20 20
mvva 160 40 72
exp 31 31
mvva 156 40 68
trv 34 9 41472
fma 31 31 20 20
mvva 156 44 84
rcp 28 28
mvva 152 44 80
trv 36 9 41984
mul 136 28 136
mvva 152 40 64
mul 24 17 124
wl 3
mvva 152 48 96
dma 5 44 88 1024
mvva 152 52 112
trv 38 9 42496
mul 25 17 125
mvva 156 52 116
trv 40 8 40960
mul 26 17 126
mvva 156 48 100
rcp 29 29
mvva 160 48 104
trv 42 8 41472
mul 137 29 137
mvva 160 52 120
rcp 30 30
mvva 164 52 124
trv 44 8 41984
mul 138 30 138
mvva 164 48 108
rcp 31 31
mvva 180 240 108
trv 46 8 42496
mul 139 31 139
mvva 180 244 124
s_waitcnt vmcnt(12)
s_barrier
mvva 176 244 120
s_add_u32 m0, s65, 32768
trv 48 8 16384
mvva 176 240 104
dma 4 44 89 0
mvva 172 240 100
trv 50 8 16896
mul 27 17 127
mvva 172 244 116
exp 24 24
mvva 168 244 112
trv 52 8 17408
fma 24 24 21 21
mvva 168 240 96
wl 3
mvva 168 32 128
trv 54 8 17920
mvva 168 36 144
dma 5 44 89 1024
mvva 172 36 148
trv 240 9 16384
mvva 172 32 132
exp 25 25
mvva 176 32 136
trv 242 9 16896
fma 25 25 21 21
mvva 176 36 152
exp 26 26
mvva 180 36 156
trv 244 9 17408
fma 26 26 21 21
mvva 180 32 140
exp 27 27
mvva 164 40 140
trv 246 9 17920
s_add_u32 m0, s65, 40960
mvva 164 44 156
dma 4 44 90 0
mvva 160 44 152
trv 32 9 24576
fma 27 27 21 21
mvva 160 40 136
rcp 24 24
mvva 156 40 132
trv 34 9 25088
mul 124 24 124
mvva 156 44 148
rcp 25 25
mvva 152 44 144
trv 36 9 25600
mul 125 25 125
mvva 152 40 128
mul 28 17 140
wl 3
mvva 152 48 160
dma 5 44 90 1024
mvva 152 52 176
trv 38 9 26112
rcp 26 26
mvva 156 52 180
trv 40 8 24576
mul 126 26 126
mvva 156 48 164
rcp 27 27
mvva 160 48 168
trv 42 8 25088
mul 127 27 127
mvva 160 52 184
exp 28 28
mvva 164 52 188
buffer_load_dword v249, v3, s[44:47], 0 offen offset:128
mvva 164 48 172
trv 44 8 25600
mul 29 17 141
mvva 180 240 172
trv 46 8 26112
mul 30 17 142
mvva 180 244 188
s_waitcnt vmcnt(13)
s_barrier
mvva 176 244 184
s_add_u32 m0, s65, 49152
trv 48 8 0
mvva 176 240 168
dma 4 44 91 0
mvva 172 240 164
trv 50 8 512
mul 31 17 143
mvva 172 244 180
exp 29 29
mvva 168 244 176
trv 52 8 1024
fma 28 28 21 21
mvva 168 240 160
fma 29 29 21 21
wl 3
mvva 168 32 192
trv 54 8 1536
exp 30 30
mvva 168 36 208
dma 5 44 91 1024
mvva 172 36 212
trv 240 9 0
exp 31 31
mvva 172 32 196
rcp 28 28
mvva 176 32 200
trv 242 9 512
fma 30 30 21 21
mvva 176 36 216
rcp 29 29
mvva 180 36 220
trv 244 9 1024
fma 31 31 21 21
mvva 180 32 204
L_pgf5:
s_cbranch_execz L_pgf9
rcp 30 30
mvva 164 40 204
trv 246 9 1536
s_add_u32 m0, s65, 57344
mvva 164 44 220
dma 4 44 96 0
mvva 160 44 216
trv 32 9 8192
mul 140 28 140
mvva 160 40 200
rcp 31 31
mvva 156 40 196
trv 34 9 8704
mul 141 29 141
mvva 156 44 212
mul 142 30 142
mul 143 31 143
mvva 152 44 208
trv 36 9 9216
mul 24 18 128
mvva 152 40 192
mul 25 18 129
wl 3
mvva 152 48 224
dma 5 44 96 1024
mvva 152 52 240
trv 38 9 9728
mul 26 18 130
mvva 156 52 244
trv 40 8 8192
mul 27 18 131
mvva 156 48 228
exp 24 24
mvva 160 48 232
trv 42 8 8704
fma 24 24 22 22
mvva 160 52 248
exp 25 25
mvva 164 52 252
trv 44 8 9216
fma 25 25 22 22
mvva 164 48 236
exp 26 26
mvva 180 240 236
trv 46 8 9728
fma 26 26 22 22
mvva 180 244 252
s_waitcnt vmcnt(13)
s_barrier
mvva 176 244 248
s_add_u32 m0, s65, 81920
trv 48 6 0
mvva 176 240 232
dma 4 44 97 0
mvva 172 240 228
trv 50 6 512
mul 28 18 144
mvva 172 244 244
exp 27 27
mvva 168 244 240
trv 52 6 1024
fma 27 27 22 22
mvva 168 240 224
mul 29 18 145
wl 3
mvvv 168 32 56
trv 54 6 1536
mul 30 18 146
mvvv 168 36 72
dma 5 44 97 1024
mvvv 172 36 76
trv 240 7 0
mul 31 18 147
mvvv 172 32 60
rcp 24 24
mvvv 176 32 64
trv 242 7 512
mul 128 24 128
mvvv 176 36 80
rcp 25 25
mvvv 180 36 84
trv 244 7 1024
mul 129 25 129
mvvv 180 32 68
rcp 26 26
mvvv 164 40 68
trv 246 7 1536
mul 130 26 130
mvvv 164 44 84
s_add_u32 s48, s48, 128
s_addc_u32 s49, s49, 0
mvvv 160 44 80
s_sub_u32 s50, s50, 128
s_add_u32 m0, s65, 90112
mvvv 160 40 64
buffer_load_dwordx4 v4, s[48:51], 0 offen lds
mvvv 156 40 60
trv 32 7 8192
rcp 27 27
mvvv 156 44 76
trv 34 7 8704
mul 131 27 131
mvvv 152 44 72
trv 36 7 9216
mvvv 152 40 56
wl 3
mzvva 88 48 0
buffer_load_dwordx4 v5, s[48:51], 0 offen offset:1024 lds
mvva 88 52 16
trv 38 7 9728
mzvva 92 52 20
trv 40 6 8192
exp 28 28
mvva 92 48 4
exp 29 29
mzvva 96 48 8
trv 42 6 8704
fma 28 28 22 22
mvva 96 52 24
exp 30 30
mzvva 100 52 28
trv 44 6 9216
fma 29 29 22 22
mvva 100 48 12
exp 31 31
mzvva 116 240 12
trv 46 6 9728
fma 30 30 22 22
mvva 116 244 28
s_waitcnt vmcnt(13)
s_barrier
mzvva 112 244 24
s_add_u32 m0, s65, 65536
trv 48 6 16384
mvva 112 240 8
dma 4 48 76 0
mzvva 108 240 4
trv 50 6 16896
fma 31 31 22 22
mvva 108 244 20
rcp 28 28
mzvva 104 244 16
trv 52 6 17408
mul 144 28 144
mvva 104 240 0
rcp 29 29
wl 3
mvva 104 32 32
trv 54 6 17920
mul 145 29 145
mvva 104 36 48
dma 5 48 76 1024
mul 24 19 132
mvva 108 36 52
trv 240 7 16384
rcp 30 30
mvva 108 32 36
rcp 31 31
mvva 112 32 40
trv 242 7 16896
mul 146 30 146
mvva 112 36 56
exp 24 24
mvva 116 36 60
trv 244 7 17408
mul 147 31 147
mvva 116 32 44
mul 25 19 133
mul 26 19 134
mvva 100 40 44
trv 246 7 17920
s_add_u32 m0, s65, 73728
mvva 100 44 60
dma 4 48 77 0
mvva 96 44 56
trv 32 7 24576
mul 27 19 135
mvva 96 40 40
exp 25 25
mvva 92 40 36
trv 34 7 25088
fma 24 24 23 23
mvva 92 44 52
exp 26 26
mvva 88 44 48
trv 36 7 25600
fma 25 25 23 23
mvva 88 40 32
fma 26 26 23 23
wl 3
mvva 88 48 64
dma 5 48 77 1024
mvva 88 52 80
trv 38 7 26112
mul 28 19 148
mvva 92 52 84
trv 40 6 24576
mul 29 19 149
mvva 92 48 68
exp 27 27
mvva 96 48 72
trv 42 6 25088
fma 27 27 23 23
mvva 96 52 88
rcp 24 24
mvva 100 52 92
trv 44 6 25600
mul 132 24 132
mvva 100 48 76
rcp 25 25
mvva 116 240 76
trv 46 6 26112
mul 133 25 133
mvva 116 244 92
s_waitcnt vmcnt(13)
s_barrier
mvva 112 244 88
s_add_u32 m0, s65, 0
trv 48 6 32768
mvva 112 240 72
dma 4 48 88 0
mvva 108 240 68
trv 50 6 33280
rcp 26 26
mvva 108 244 84
rcp 27 27
mvva 104 244 80
trv 52 6 33792
mul 134 26 134
mvva 104 240 64
mul 135 27 135
wl 3
mvva 104 32 96
trv 54 6 34304
mul 30 19 150
mvva 104 36 112
dma 5 48 88 1024
mvva 108 36 116
trv 240 7 32768
mul 31 19 151
mvva 108 32 100
exp 28 28
mvva 112 32 104
trv 242 7 33280
fma 28 28 23 23
mvva 112 36 120
exp 29 29
mvva 116 36 124
trv 244 7 33792
fma 29 29 23 23
mvva 116 32 108
exp 30 30
mvva 100 40 108
trv 246 7 34304
s_add_u32 m0, s65, 8192
mvva 100 44 124
dma 4 48 89 0
mvva 96 44 120
trv 32 7 40960
fma 30 30 23 23
mvva 96 40 104
exp 31 31
mvva 92 40 100
trv 34 7 41472
fma 31 31 23 23
mvva 92 44 116
rcp 28 28
mvva 88 44 112
trv 36 7 41984
mul 148 28 148
mvva 88 40 96
mul 152 120 152
wl 3
mvva 88 48 128
dma 5 48 89 1024
mvva 88 52 144
trv 38 7 42496
mul 153 121 153
mvva 92 52 148
trv 40 6 40960
mul 154 122 154
mvva 92 48 132
rcp 29 29
mvva 96 48 136
trv 42 6 41472
mul 149 29 149
mvva 96 52 152
rcp 30 30
mvva 100 52 156
trv 44 6 41984
mul 150 30 150
mvva 100 48 140
rcp 31 31
mvva 116 240 140
trv 46 6 42496
mul 151 31 151
mvva 116 244 156
s_waitcnt vmcnt(12)
s_barrier
mvva 112 244 152
s_add_u32 m0, s65, 16384
trv 48 6 49152
mvva 112 240 136
dma 4 48 90 0
mvva 108 240 132
trv 50 6 49664
mul 155 123 155
mvva 108 244 148
mul 168 136 168
mul 169 137 169
mvva 104 244 144
trv 52 6 50176
mul 170 138 170
mvva 104 240 128
mul 171 139 171
wl 3
mvva 104 32 160
trv 54 6 50688
cvt 120 152 153
mvva 104 36 176
dma 5 48 90 1024
mvva 108 36 180
trv 240 7 49152
cvt 121 154 155
mvva 108 32 164
cvt 122 168 169
cvt 123 170 171
mvva 112 32 168
ds_write_b128 v12, v[120:123] offset:0
mvva 112 36 184
trv 242 7 49664
mul 157 125 157
mvva 116 36 188
buffer_load_dword v249, v3, s[48:51], 0 offen offset:128
mvva 116 32 172
trv 244 7 50176
mul 158 126 158
mvva 100 40 172
trv 246 7 50688
s_add_u32 m0, s65, 24576
mvva 100 44 188
dma 4 48 91 0
mvva 96 44 184
trv 32 7 57344
mul 156 124 156
mvva 96 40 168
mul 159 127 159
mul 173 141 173
mvva 92 40 164
trv 34 7 57856
mul 172 140 172
mvva 92 44 180
mul 175 143 175
cvt 124 156 157
mvva 88 44 176
trv 36 7 58368
mul 174 142 174
mvva 88 40 160
cvt 126 172 173
wl 3
mvva 88 48 192
dma 5 48 91 1024
mvva 88 52 208
trv 38 7 58880
cvt 125 158 159
mvva 92 52 212
trv 40 6 57344
cvt 127 174 175
mvva 92 48 196
mul 160 128 160
mul 161 129 161
mvva 96 48 200
ds_write_b128 v12, v[124:127] offset:1024
mvva 96 52 216
trv 42 6 57856
mul 163 131 163
mvva 100 52 220
trv 44 6 58368
mul 176 144 176
mvva 100 48 204
mul 177 145 177
mul 178 146 178
mvva 116 240 204
trv 46 6 58880
mul 179 147 179
mvva 116 244 220
s_waitcnt vmcnt(13)
s_barrier
mvva 112 244 216
s_add_u32 m0, s65, 32768
trv 48 8 16384
mvva 112 240 200
dma 4 48 96 0
mvva 108 240 196
trv 50 8 16896
mul 162 130 162
mvva 108 244 212
cvt 129 162 163
cvt 130 176 177
mvva 104 244 208
trv 52 8 17408
cvt 131 178 179
mvva 104 240 192
mul 164 132 164
wl 3
mvva 104 32 224
trv 54 8 17920
cvt 128 160 161
mvva 104 36 240
dma 5 48 96 1024
mvva 108 36 244
trv 240 9 16384
mul 165 133 165
mvva 108 32 228
mul 166 134 166
mul 167 135 167
mvva 112 32 232
ds_write_b128 v12, v[128:131] offset:2048
mvva 112 36 248
trv 242 9 16896
mul 181 149 181
mvva 116 36 252
trv 244 9 17408
mul 182 150 182
mvva 116 32 236
mul 183 151 183
cvt 132 164 165
mvva 100 40 236
trv 246 9 17920
s_add_u32 m0, s65, 40960
mvva 100 44 252
dma 4 48 97 0
mvva 96 44 248
trv 32 9 24576
cvt 133 166 167
mvva 96 40 232
cvt 135 182 183
mvva 92 40 228
trv 34 9 25088
mul 180 148 180
mvva 92 44 244
mvva 88 44 240
trv 36 9 25600
mvva 88 40 224
wl 3
mvvv 88 48 56
dma 5 48 97 1024
mvvv 88 52 72
trv 38 9 26112
mvvv 92 52 76
trv 40 8 24576
cvt 134 180 181
mvvv 92 48 60
mvvv 96 48 64
trv 42 8 25088
mvvv 96 52 80
ds_write_b128 v12, v[132:135] offset:3072
mvvv 100 52 84
trv 44 8 25600
mvvv 100 48 68
mvvv 116 240 68
trv 46 8 26112
mvvv 116 244 84
s_waitcnt vmcnt(13)
s_barrier
mvvv 112 244 80
s_add_u32 s44, s44, 128
s_addc_u32 s45, s45, 0
mvvv 112 240 64
s_sub_u32 s46, s46, 128
s_add_u32 m0, s65, 49152
mvvv 108 240 60
trv 48 8 0
mvvv 108 244 76
buffer_load_dwordx4 v4, s[44:47], 0 offen lds
mvvv 104 244 72
trv 50 8 512
mvvv 104 240 56
trv 52 8 1024
wl 3
mzvva 168 32 0
trv 54 8 1536
mvva 168 36 16
buffer_load_dwordx4 v5, s[44:47], 0 offen offset:1024 lds
mzvva 172 36 20
trv 240 9 0
mvva 172 32 4
mul 24 16 88
mul 25 16 89
mzvva 176 32 8
trv 242 9 512
mul 26 16 90
mvva 176 36 24
exp 24 24
mzvva 180 36 28
trv 244 9 1024
mul 27 16 91
mvva 180 32 12
exp 25 25
mzvva 164 40 12
trv 246 9 1536
s_add_u32 m0, s65, 57344
mvva 164 44 28
dma 4 44 76 0
mzvva 160 44 24
trv 32 9 8192
fma 24 24 20 20
mvva 160 40 8
exp 26 26
mzvva 156 40 4
trv 34 9 8704
fma 25 25 20 20
mvva 156 44 20
exp 27 27
mzvva 152 44 16
trv 36 9 9216
fma 27 27 20 20
mvva 152 40 0
fma 26 26 20 20
wl 3
mvva 152 48 32
dma 5 44 76 1024
mvva 152 52 48
trv 38 9 9728
mul 28 16 104
mvva 156 52 52
trv 40 8 8192
mul 29 16 105
mvva 156 48 36
rcp 24 24
mvva 160 48 40
trv 42 8 8704
mul 88 24 88
mvva 160 52 56
rcp 25 25
mvva 164 52 60
trv 44 8 9216
mul 89 25 89
mvva 164 48 44
rcp 26 26
mvva 180 240 44
trv 46 8 9728
mul 90 26 90
mvva 180 244 60
s_waitcnt vmcnt(13)
s_barrier
mvva 176 244 56
trv 48 6 0
mul 30 16 106
mvva 176 240 40
rcp 27 27
mvva 172 240 36
trv 50 6 512
mul 91 27 91
mvva 172 244 52
exp 28 28
mvva 168 244 48
trv 52 6 1024
fma 28 28 20 20
mvva 168 240 32
mul 31 16 107
wl 3
mvva 168 32 64
trv 54 6 1536
mvva 168 36 80
exp 30 30
mvva 172 36 84
trv 240 7 0
fma 30 30 20 20
mvva 172 32 68
exp 29 29
mvva 176 32 72
trv 242 7 512
fma 29 29 20 20
mvva 176 36 88
rcp 28 28
mvva 180 36 92
trv 244 7 1024
mul 104 28 104
mvva 180 32 76
exp 31 31
mvva 164 40 76
trv 246 7 1536
mvva 164 44 92
rcp 29 29
mvva 160 44 88
trv 32 7 8192
mul 105 29 105
mvva 160 40 72
rcp 30 30
mvva 156 40 68
trv 34 7 8704
L_pgf6:
s_cbranch_execz L_pgf10
fma 31 31 20 20
mvva 156 44 84
mul 106 30 106
mul 24 17 92
mvva 152 44 80
trv 36 7 9216
mul 25 17 93
mvva 152 40 64
mul 26 17 94
wl 3
mvva 152 48 96
trv 38 7 9728
mul 27 17 95
mvva 152 52 112
rcp 31 31
mvva 156 52 116
trv 40 6 8192
mvva 156 48 100
exp 24 24
mvva 160 48 104
trv 42 6 8704
mvva 160 52 120
exp 25 25
mvva 164 52 124
trv 44 6 9216
mul 107 31 107
mvva 164 48 108
exp 27 27
mvva 180 240 108
trv 46 6 9728
fma 24 24 21 21
mvva 180 244 124
s_waitcnt vmcnt(8)
s_barrier
mvva 176 244 120
s_add_u32 m0, s65, 65536
trv 48 6 16384
mvva 176 240 104
dma 4 44 77 0
mvva 172 240 100
trv 50 6 16896
fma 25 25 21 21
mvva 172 244 116
rcp 24 24
mvva 168 244 112
trv 52 6 17408
fma 27 27 21 21
mvva 168 240 96
wl 3
mvva 168 32 128
trv 54 6 17920
mvva 168 36 144
dma 5 44 77 1024
mvva 172 36 148
trv 240 7 16384
mul 92 24 92
mvva 172 32 132
exp 26 26
mvva 176 32 136
trv 242 7 16896
fma 26 26 21 21
mvva 176 36 152
rcp 26 26
mvva 180 36 156
trv 244 7 17408
mul 94 26 94
mvva 180 32 140
rcp 27 27
mvva 164 40 140
trv 246 7 17920
s_add_u32 m0, s65, 73728
mvva 164 44 156
dma 4 44 88 0
mvva 160 44 152
trv 32 7 24576
mul 95 27 95
mvva 160 40 136
rcp 25 25
mvva 156 40 132
trv 34 7 25088
mul 28 17 108
mvva 156 44 148
exp 28 28
mvva 152 44 144
trv 36 7 25600
mul 29 17 109
mvva 152 40 128
mul 93 25 93
wl 3
mvva 152 48 160
dma 5 44 88 1024
mvva 152 52 176
trv 38 7 26112
mul 31 17 111
mvva 156 52 180
trv 40 6 24576
fma 28 28 21 21
mvva 156 48 164
exp 29 29
mvva 160 48 168
trv 42 6 25088
mul 30 17 110
mvva 160 52 184
exp 31 31
mvva 164 52 188
buffer_load_dword v249, v3, s[44:47], 0 offen offset:128
mvva 164 48 172
trv 44 6 25600
fma 29 29 21 21
mvva 180 240 172
trv 46 6 26112
fma 31 31 21 21
mvva 180 244 188
s_waitcnt vmcnt(9)
s_barrier
mvva 176 244 184
s_add_u32 m0, s65, 0
trv 48 6 32768
mvva 176 240 168
dma 4 44 89 0
mvva 172 240 164
trv 50 6 33280
mvva 172 244 180
exp 30 30
mvva 168 244 176
trv 52 6 33792
mvva 168 240 160
fma 30 30 21 21
wl 3
mvva 168 32 192
trv 54 6 34304
mul 24 18 96
mvva 168 36 208
dma 5 44 89 1024
mvva 172 36 212
trv 240 7 32768
mul 25 18 97
mvva 172 32 196
rcp 28 28
mvva 176 32 200
trv 242 7 33280
mul 108 28 108
mvva 176 36 216
rcp 29 29
mvva 180 36 220
trv 244 7 33792
mul 109 29 109
mvva 180 32 204
rcp 30 30
mvva 164 40 204
trv 246 7 34304
s_add_u32 m0, s65, 8192
mvva 164 44 220
dma 4 44 90 0
mvva 160 44 216
trv 32 7 40960
mul 110 30 110
mvva 160 40 200
rcp 31 31
mvva 156 40 196
trv 34 7 41472
mul 111 31 111
mvva 156 44 212
exp 24 24
mvva 152 44 208
trv 36 7 41984
mul 26 18 98
mvva 152 40 192
mul 27 18 99
wl 3
mvva 152 48 224
dma 5 44 90 1024
mvva 152 52 240
trv 38 7 42496
fma 24 24 22 22
mvva 156 52 244
trv 40 6 40960
mvva 156 48 228
exp 25 25
mvva 160 48 232
trv 42 6 41472
fma 25 25 22 22
mvva 160 52 248
exp 26 26
mvva 164 52 252
trv 44 6 41984
fma 26 26 22 22
mvva 164 48 236
exp 27 27
mvva 180 240 236
trv 46 6 42496
mvva 180 244 252
s_waitcnt vmcnt(9)
s_barrier
mvva 176 244 248
s_add_u32 m0, s65, 16384
trv 48 6 49152
mvva 176 240 232
dma 4 44 91 0
mvva 172 240 228
trv 50 6 49664
fma 27 27 22 22
mvva 172 244 244
rcp 24 24
mvva 168 244 240
trv 52 6 50176
mul 96 24 96
mvva 168 240 224
mul 28 18 112
wl 3
mvvv 168 32 56
trv 54 6 50688
mul 29 18 113
mvvv 168 36 72
dma 5 44 91 1024
mvvv 172 36 76
trv 240 7 49152
mul 30 18 114
mvvv 172 32 60
rcp 25 25
mvvv 176 32 64
trv 242 7 49664
mul 97 25 97
mvvv 176 36 80
rcp 26 26
mvvv 180 36 84
trv 244 7 50176
mul 98 26 98
mvvv 180 32 68
rcp 27 27
mvvv 164 40 68
trv 246 7 50688
s_add_u32 m0, s65, 24576
mvvv 164 44 84
dma 4 44 96 0
mvvv 160 44 80
trv 32 7 57344
mul 99 27 99
mvvv 160 40 64
exp 28 28
mvvv 156 40 60
trv 34 7 57856
mul 31 18 115
mvvv 156 44 76
exp 29 29
mvvv 152 44 72
trv 36 7 58368
fma 28 28 22 22
mvvv 152 40 56
fma 29 29 22 22
wl 3
mzvva 120 48 0
dma 5 44 96 1024
mvva 120 52 16
trv 38 7 58880
mzvva 124 52 20
trv 40 6 57344
mvva 124 48 4
exp 30 30
mzvva 128 48 8
trv 42 6 57856
fma 30 30 22 22
mvva 128 52 24
exp 31 31
mzvva 132 52 28
trv 44 6 58368
fma 31 31 22 22
mvva 132 48 12
rcp 28 28
mzvva 148 240 12
trv 46 6 58880
mul 112 28 112
mvva 148 244 28
s_waitcnt vmcnt(9)
s_barrier
mzvva 144 244 24
s_add_u32 m0, s65, 32768
trv 48 8 0
mvva 144 240 8
dma 4 44 97 0
mzvva 140 240 4
trv 50 8 512
mul 24 19 100
mvva 140 244 20
rcp 29 29
mzvva 136 244 16
trv 52 8 1024
mul 113 29 113
mvva 136 240 0
mul 25 19 101
wl 3
mvva 136 32 32
trv 54 8 1536
mul 26 19 102
mvva 136 36 48
dma 5 44 97 1024
mul 27 19 103
mvva 140 36 52
trv 240 9 0
rcp 30 30
mvva 140 32 36
rcp 31 31
mvva 144 32 40
trv 242 9 512
mul 114 30 114
mvva 144 36 56
exp 24 24
mvva 148 36 60
trv 244 9 1024
mul 115 31 115
mvva 148 32 44
exp 26 26
mvva 132 40 44
trv 246 9 1536
fma 24 24 23 23
mvva 132 44 60
s_add_u32 s48, s48, 128
s_addc_u32 s49, s49, 0
mvva 128 44 56
s_sub_u32 s50, s50, 128
s_add_u32 m0, s65, 40960
mvva 128 40 40
buffer_load_dwordx4 v4, s[48:51], 0 offen lds
mvva 124 40 36
trv 32 9 8192
fma 26 26 23 23
mvva 124 44 52
trv 34 9 8704
mvva 120 44 48
trv 36 9 9216
mvva 120 40 32
exp 25 25
wl 3
mvva 120 48 64
buffer_load_dwordx4 v5, s[48:51], 0 offen offset:1024 lds
mvva 120 52 80
trv 38 9 9728
fma 25 25 23 23
mvva 124 52 84
trv 40 8 8192
mul 28 19 116
mvva 124 48 68
exp 27 27
mvva 128 48 72
trv 42 8 8704
fma 27 27 23 23
mvva 128 52 88
rcp 24 24
mvva 132 52 92
trv 44 8 9216
mul 100 24 100
mvva 132 48 76
rcp 25 25
mvva 148 240 76
trv 46 8 9728
mul 101 25 101
mvva 148 244 92
s_waitcnt vmcnt(8)
s_barrier
mvva 144 244 88
s_add_u32 m0, s65, 49152
trv 48 6 0
mvva 144 240 72
dma 4 48 76 0
mvva 140 240 68
trv 50 6 512
rcp 26 26
mvva 140 244 84
rcp 27 27
mvva 136 244 80
trv 52 6 1024
mul 102 26 102
mvva 136 240 64
mul 103 27 103
wl 3
mvva 136 32 96
trv 54 6 1536
mul 29 19 117
mvva 136 36 112
dma 5 48 76 1024
mvva 140 36 116
trv 240 7 0
mul 30 19 118
mvva 140 32 100
exp 28 28
mvva 144 32 104
trv 242 7 512
mul 31 19 119
mvva 144 36 120
exp 29 29
mvva 148 36 124
trv 244 7 1024
fma 28 28 23 23
mvva 148 32 108
exp 30 30
mvva 132 40 108
trv 246 7 1536
s_add_u32 m0, s65, 57344
mvva 132 44 124
dma 4 48 77 0
mvva 128 44 120
trv 32 7 8192
fma 29 29 23 23
mvva 128 40 104
exp 31 31
mvva 124 40 100
trv 34 7 8704
fma 30 30 23 23
mvva 124 44 116
rcp 28 28
mvva 120 44 112
trv 36 7 9216
fma 31 31 23 23
mvva 120 40 96
mul 116 28 116
wl 3
mvva 120 48 128
dma 5 48 77 1024
mvva 120 52 144
trv 38 7 9728
mul 152 88 152
mvva 124 52 148
trv 40 6 8192
mul 153 89 153
mvva 124 48 132
rcp 29 29
mvva 128 48 136
trv 42 6 8704
mul 117 29 117
mvva 128 52 152
rcp 30 30
mvva 132 52 156
trv 44 6 9216
mul 118 30 118
mvva 132 48 140
rcp 31 31
mvva 148 240 140
trv 46 6 9728
mul 119 31 119
mvva 148 244 156
s_waitcnt vmcnt(8)
s_barrier
mvva 144 244 152
s_add_u32 m0, s65, 65536
trv 48 6 16384
mvva 144 240 136
dma 4 48 88 0
mvva 140 240 132
trv 50 6 16896
mul 154 90 154
mvva 140 244 148
mul 155 91 155
mul 168 104 168
mvva 136 244 144
trv 52 6 17408
mul 169 105 169
mvva 136 240 128
mul 170 106 170
wl 3
mvva 136 32 160
trv 54 6 17920
mul 171 107 171
mvva 136 36 176
dma 5 48 88 1024
mvva 140 36 180
trv 240 7 16384
cvt 88 152 153
mvva 140 32 164
cvt 89 154 155
cvt 90 168 169
mvva 144 32 168
trv 242 7 16896
cvt 91 170 171
mvva 144 36 184
ds_write_b128 v14, v[88:91] offset:0
mvva 148 36 188
buffer_load_dword v249, v3, s[48:51], 0 offen offset:128
mvva 148 32 172
trv 244 7 17408
mul 157 93 157
mvva 132 40 172
trv 246 7 17920
s_add_u32 m0, s65, 73728
mvva 132 44 188
dma 4 48 89 0
mvva 128 44 184
trv 32 7 24576
mul 156 92 156
mvva 128 40 168
mul 158 94 158
mul 159 95 159
mvva 124 40 164
trv 34 7 25088
mul 172 108 172
mvva 124 44 180
mul 173 109 173
mul 175 111 175
mvva 120 44 176
trv 36 7 25600
mul 174 110 174
mvva 120 40 160
cvt 92 156 157
wl 3
mvva 120 48 192
dma 5 48 89 1024
mvva 120 52 208
trv 38 7 26112
cvt 93 158 159
mvva 124 52 212
trv 40 6 24576
cvt 94 172 173
mvva 124 48 196
cvt 95 174 175
mul 160 96 160
mvva 128 48 200
ds_write_b128 v14, v[92:95] offset:1024
mvva 128 52 216
trv 42 6 25088
mul 162 98 162
mvva 132 52 220
trv 44 6 25600
mul 163 99 163
mvva 132 48 204
mul 176 112 176
mul 177 113 177
mvva 148 240 204
trv 46 6 26112
mul 178 114 178
mvva 148 244 220
s_waitcnt vmcnt(9)
s_barrier
mvva 144 244 216
s_add_u32 m0, s65, 0
trv 48 6 32768
mvva 144 240 200
dma 4 48 90 0
mvva 140 240 196
trv 50 6 33280
mul 161 97 161
mvva 140 244 212
cvt 96 160 161
cvt 97 162 163
mvva 136 244 208
trv 52 6 33792
cvt 98 176 177
mvva 136 240 192
mul 179 115 179
wl 3
mvva 136 32 224
trv 54 6 34304
mul 164 100 164
mvva 136 36 240
dma 5 48 90 1024
mvva 140 36 244
trv 240 7 32768
mul 165 101 165
mvva 140 32 228
cvt 99 178 179
mul 166 102 166
mvva 144 32 232
ds_write_b128 v14, v[96:99] offset:2048
mvva 144 36 248
trv 242 7 33280
mul 180 116 180
mvva 148 36 252
trv 244 7 33792
mul 181 117 181
mvva 148 32 236
mul 182 118 182
mul 183 119 183
mvva 132 40 236
trv 246 7 34304
s_add_u32 m0, s65, 8192
mvva 132 44 252
dma 4 48 91 0
mvva 128 44 248
trv 32 7 40960
cvt 100 164 165
mvva 128 40 232
mul 167 103 167
cvt 102 180 181
mvva 124 40 228
trv 34 7 41472
cvt 103 182 183
mvva 124 44 244
mvva 120 44 240
trv 36 7 41984
mvva 120 40 224
wl 3
mvvv 120 48 56
dma 5 48 91 1024
mvvv 120 52 72
trv 38 7 42496
L_pgf7:
s_cbranch_execz L_pgf11
cvt 101 166 167
mvvv 124 52 76
trv 40 6 40960
mvvv 124 48 60
mvvv 128 48 64
trv 42 6 41472
mvvv 128 52 80
ds_write_b128 v14, v[100:103] offset:3072
mvvv 132 52 84
trv 44 6 41984
mvvv 132 48 68
mvvv 148 240 68
trv 46 6 42496
mvvv 148 244 84
s_waitcnt vmcnt(9)
s_barrier
mvvv 144 244 80
s_add_u32 m0, s65, 16384
trv 48 6 49152
mvvv 144 240 64
dma 4 48 96 0
mvvv 140 240 60
trv 50 6 49664
mvvv 140 244 76
mvvv 136 244 72
trv 52 6 50176
mvvv 136 240 56
wl 3
mzvva 168 32 0
trv 54 6 50688
mvva 168 36 16
dma 5 48 96 1024
mzvva 172 36 20
trv 240 7 49152
mvva 172 32 4
mul 24 16 120
mul 25 16 121
mzvva 176 32 8
trv 242 7 49664
mul 26 16 122
mvva 176 36 24
exp 24 24
mzvva 180 36 28
trv 244 7 50176
mul 27 16 123
mvva 180 32 12
exp 26 26
mzvva 164 40 12
trv 246 7 50688
s_add_u32 m0, s65, 24576
mvva 164 44 28
dma 4 48 97 0
mzvva 160 44 24
trv 32 7 57344
fma 24 24 20 20
mvva 160 40 8
exp 25 25
mzvva 156 40 4
trv 34 7 57856
fma 25 25 20 20
mvva 156 44 20
exp 27 27
mzvva 152 44 16
trv 36 7 58368
fma 27 27 20 20
mvva 152 40 0
wl 3
mvva 152 48 32
dma 5 48 97 1024
mvva 152 52 48
trv 38 7 58880
fma 26 26 20 20
mvva 156 52 52
trv 40 6 57344
mul 28 16 136
mvva 156 48 36
rcp 24 24
mvva 160 48 40
trv 42 6 57856
mul 120 24 120
mvva 160 52 56
rcp 25 25
mvva 164 52 60
trv 44 6 58368
mul 121 25 121
mvva 164 48 44
rcp 26 26
mvva 180 240 44
trv 46 6 58880
mul 122 26 122
mvva 180 244 60
s_waitcnt vmcnt(8)
s_barrier
mvva 176 244 56
s_add_u32 s44, s44, 128
s_addc_u32 s45, s45, 0
mvva 176 240 40
s_sub_u32 s46, s46, 128
s_add_u32 m0, s65, 32768
mvva 172 240 36
trv 48 8 0
mul 29 16 137
mvva 172 244 52
buffer_load_dwordx4 v4, s[44:47], 0 offen lds
mvva 168 244 48
trv 50 8 512
mul 30 16 138
mvva 168 240 32
trv 52 8 1024
wl 3
mvva 168 32 64
trv 54 8 1536
rcp 27 27
mvva 168 36 80
buffer_load_dwordx4 v5, s[44:47], 0 offen offset:1024 lds
mvva 172 36 84
trv 240 9 0
mul 123 27 123
mvva 172 32 68
exp 28 28
mvva 176 32 72
trv 242 9 512
mul 31 16 139
mvva 176 36 88
exp 29 29
mvva 180 36 92
trv 244 9 1024
fma 28 28 20 20
mvva 180 32 76
exp 30 30
mvva 164 40 76
trv 246 9 1536
s_add_u32 m0, s65, 40960
mvva 164 44 92
dma 4 44 76 0
mvva 160 44 88
trv 32 9 8192
fma 29 29 20 20
mvva 160 40 72
exp 31 31
mvva 156 40 68
trv 34 9 8704
fma 31 31 20 20
mvva 156 44 84
rcp 28 28
mvva 152 44 80
trv 36 9 9216
fma 30 30 20 20
mvva 152 40 64
mul 136 28 136
wl 3
mvva 152 48 96
dma 5 44 76 1024
mvva 152 52 112
trv 38 9 9728
mul 24 17 124
mvva 156 52 116
trv 40 8 8192
mul 25 17 125
mvva 156 48 100
rcp 29 29
mvva 160 48 104
trv 42 8 8704
mul 137 29 137
mvva 160 52 120
rcp 30 30
mvva 164 52 124
trv 44 8 9216
mul 138 30 138
mvva 164 48 108
rcp 31 31
mvva 180 240 108
trv 46 8 9728
mul 26 17 126
mvva 180 244 124
s_waitcnt vmcnt(8)
s_barrier
mvva 176 244 120
s_add_u32 m0, s65, 49152
trv 48 6 0
mvva 176 240 104
dma 4 44 77 0
mvva 172 240 100
trv 50 6 512
mul 139 31 139
mvva 172 244 116
exp 24 24
mvva 168 244 112
trv 52 6 1024
mul 27 17 127
mvva 168 240 96
fma 24 24 21 21
wl 3
mvva 168 32 128
trv 54 6 1536
mvva 168 36 144
dma 5 44 77 1024
mvva 172 36 148
trv 240 7 0
mvva 172 32 132
exp 25 25
mvva 176 32 136
trv 242 7 512
fma 25 25 21 21
mvva 176 36 152
exp 26 26
mvva 180 36 156
trv 244 7 1024
fma 26 26 21 21
mvva 180 32 140
exp 27 27
mvva 164 40 140
trv 246 7 1536
s_add_u32 m0, s65, 57344
mvva 164 44 156
dma 4 44 88 0
mvva 160 44 152
trv 32 7 8192
fma 27 27 21 21
mvva 160 40 136
rcp 24 24
mvva 156 40 132
trv 34 7 8704
mul 124 24 124
mvva 156 44 148
rcp 25 25
mvva 152 44 144
trv 36 7 9216
mul 125 25 125
mvva 152 40 128
mul 28 17 140
wl 3
mvva 152 48 160
dma 5 44 88 1024
mvva 152 52 176
trv 38 7 9728
mul 29 17 141
mvva 156 52 180
trv 40 6 8192
mul 30 17 142
mvva 156 48 164
rcp 26 26
mvva 160 48 168
trv 42 6 8704
mul 126 26 126
mvva 160 52 184
rcp 27 27
mvva 164 52 188
buffer_load_dword v249, v3, s[44:47], 0 offen offset:128
mvva 164 48 172
trv 44 6 9216
mul 127 27 127
mvva 180 240 172
trv 46 6 9728
mvva 180 244 188
s_waitcnt vmcnt(9)
s_barrier
mvva 176 244 184
s_add_u32 m0, s65, 65536
trv 48 6 16384
mvva 176 240 168
dma 4 44 89 0
mvva 172 240 164
trv 50 6 16896
mul 31 17 143
mvva 172 244 180
exp 28 28
mvva 168 244 176
trv 52 6 17408
fma 28 28 21 21
mvva 168 240 160
wl 3
mvva 168 32 192
trv 54 6 17920
mvva 168 36 208
dma 5 44 89 1024
mvva 172 36 212
trv 240 7 16384
mvva 172 32 196
exp 29 29
mvva 176 32 200
trv 242 7 16896
fma 29 29 21 21
mvva 176 36 216
exp 30 30
mvva 180 36 220
trv 244 7 17408
fma 30 30 21 21
mvva 180 32 204
exp 31 31
mvva 164 40 204
trv 246 7 17920
s_add_u32 m0, s65, 73728
mvva 164 44 220
dma 4 44 90 0
mvva 160 44 216
trv 32 7 24576
fma 31 31 21 21
mvva 160 40 200
rcp 28 28
mvva 156 40 196
trv 34 7 25088
mul 140 28 140
mvva 156 44 212
rcp 29 29
mvva 152 44 208
trv 36 7 25600
mul 141 29 141
mvva 152 40 192
mul 24 18 128
wl 3
mvva 152 48 224
dma 5 44 90 1024
mvva 152 52 240
trv 38 7 26112
mul 25 18 129
mvva 156 52 244
trv 40 6 24576
mul 26 18 130
mvva 156 48 228
rcp 30 30
mvva 160 48 232
L_flate:
trv 42 6 25088
mul 142 30 142
mvva 160 52 248
rcp 31 31
mvva 164 52 252
trv 44 6 25600
s_and_b32 s86, s72, 15
mvva 164 48 236
exp 24 24
mvva 180 240 236
trv 46 6 26112
mul 143 31 143
mvva 180 244 252
s_waitcnt vmcnt(9)
s_barrier
mvva 176 244 248
s_add_u32 m0, s65, 0
trv 48 6 32768
mvva 176 240 232
dma 4 44 91 0
s_lshl_b32 s86, s86, 2
mvva 172 240 228
trv 50 6 33280
mul 27 18 131
mvva 172 244 244
exp 25 25
mvva 168 244 240
trv 52 6 33792
s_add_u32 s86, s86, s64
mvva 168 240 224
s_mul_i32 s86, s86, 1792
wl 3
mvvv 168 32 56
trv 54 6 34304
v_mov_b32 v255, v1
mvvv 168 36 72
dma 5 44 91 1024
mvvv 172 36 76
trv 240 7 32768
fma 24 24 22 22
mvvv 172 32 60
exp 26 26
mvvv 176 32 64
trv 242 7 33280
v_cmp_gt_u32 vcc, 14, v255
mvvv 176 36 80
exp 27 27
mvvv 180 36 84
trv 244 7 33792
fma 25 25 22 22
mvvv 180 32 68
rcp 24 24
mvvv 164 40 68
trv 246 7 34304
s_add_u32 m0, s65, 8192
mvvv 164 44 84
dma 4 44 96 0
mvvv 160 44 80
trv 32 7 40960
fma 26 26 22 22
mvvv 160 40 64
rcp 25 25
mvvv 156 40 60
trv 34 7 41472
fma 27 27 22 22
mvvv 156 44 76
rcp 26 26
mvvv 152 44 72
trv 36 7 41984
v_lshlrev_b32 v255, 7, v255
mvvv 152 40 56
s_waitcnt vmcnt(7)
v_mov_b32 v249, 0x7fffffff
wl 3
mzvva 88 48 0
dma 5 44 96 1024
mvva 88 52 16
trv 38 7 42496
v_cndmask_b32 v255, v249, v255, vcc
mzvva 92 52 20
trv 40 6 40960
rcp 27 27
mvva 92 48 4
mul 128 24 128
mul 129 25 129
mzvva 96 48 8
trv 42 6 41472
mul 130 26 130
mvva 96 52 24
mul 131 27 131
mul 28 18 144
mzvva 100 52 28
trv 44 6 41984
mul 29 18 145
mvva 100 48 12
exp 28 28
mzvva 116 240 12
trv 46 6 42496
mul 30 18 146
mvva 116 244 28
s_barrier
mzvva 112 244 24
s_add_u32 m0, s65, 16384
trv 48 6 49152
mvva 112 240 8
dma 4 44 97 0
mul 31 18 147
mzvva 108 240 4
trv 50 6 49664
fma 28 28 22 22
mvva 108 244 20
exp 29 29
mzvva 104 244 16
trv 52 6 50176
fma 29 29 22 22
mvva 104 240 0
wl 3
mvva 104 32 32
trv 54 6 50688
exp 30 30
mvva 104 36 48
dma 5 44 97 1024
mvva 108 36 52
trv 240 7 49152
exp 31 31
mvva 108 32 36
rcp 28 28
mvva 112 32 40
trv 242 7 49664
fma 30 30 22 22
mvva 112 36 56
rcp 29 29
mvva 116 36 60
trv 244 7 50176
fma 31 31 22 22
mvva 116 32 44
rcp 30 30
mvva 100 40 44
trv 246 7 50688
mul 144 28 144
mvva 100 44 60
s_add_u32 s48, s48, 128
s_addc_u32 s49, s49, 0
mvva 96 44 56
s_sub_u32 s50, s50, 128
s_add_u32 m0, s65, 24576
mvva 96 40 40
buffer_load_dwordx4 v4, s[48:51], 0 offen lds
mvva 92 40 36
trv 32 7 57344
mul 145 29 145
mvva 92 44 52
trv 34 7 57856
mul 146 30 146
mvva 88 44 48
trv 36 7 58368
mul 24 19 132
mvva 88 40 32
rcp 31 31
wl 3
mvva 88 48 64
buffer_load_dwordx4 v5, s[48:51], 0 offen offset:1024 lds
mvva 88 52 80
trv 38 7 58880
mul 147 31 147
mvva 92 52 84
trv 40 6 57344
mul 25 19 133
mvva 92 48 68
exp 24 24
mvva 96 48 72
trv 42 6 57856
mul 26 19 134
mvva 96 52 88
exp 25 25
mvva 100 52 92
trv 44 6 58368
mul 27 19 135
mvva 100 48 76
exp 26 26
mvva 116 240 76
trv 46 6 58880
fma 24 24 23 23
mvva 116 244 92
s_waitcnt vmcnt(8)
s_barrier
mvva 112 244 88
s_add_u32 m0, s65, 32768
trv 48 8 0
mvva 112 240 72
dma 4 48 76 0
mvva 108 240 68
trv 50 8 512
fma 25 25 23 23
mvva 108 244 84
exp 27 27
mvva 104 244 80
trv 52 8 1024
fma 26 26 23 23
mvva 104 240 64
fma 27 27 23 23
wl 3
mvva 104 32 96
trv 54 8 1536
mul 28 19 148
mvva 104 36 112
dma 5 48 76 1024
mvva 108 36 116
trv 240 9 0
mul 29 19 149
mvva 108 32 100
rcp 24 24
mvva 112 32 104
trv 242 9 512
mul 132 24 132
mvva 112 36 120
rcp 25 25
mvva 116 36 124
trv 244 9 1024
mul 133 25 133
mvva 116 32 108
rcp 26 26
mvva 100 40 108
trv 246 9 1536
s_add_u32 m0, s65, 40960
mvva 100 44 124
dma 4 48 77 0
mvva 96 44 120
trv 32 9 8192
mul 134 26 134
mvva 96 40 104
rcp 27 27
mvva 92 40 100
trv 34 9 8704
mul 135 27 135
mvva 92 44 116
exp 28 28
mvva 88 44 112
trv 36 9 9216
mul 30 19 150
mvva 88 40 96
mul 31 19 151
wl 3
mvva 88 48 128
dma 5 48 77 1024
mvva 88 52 144
trv 38 9 9728
fma 28 28 23 23
mvva 92 52 148
trv 40 8 8192
mvva 92 48 132
exp 29 29
mvva 96 48 136
trv 42 8 8704
fma 29 29 23 23
mvva 96 52 152
exp 30 30
mvva 100 52 156
trv 44 8 9216
fma 30 30 23 23
mvva 100 48 140
exp 31 31
mvva 116 240 140
trv 46 8 9728
mvva 116 244 156
s_waitcnt vmcnt(8)
s_barrier
mvva 112 244 152
s_add_u32 m0, s65, 49152
trv 48 6 0
L_pgf8:
s_cbranch_execz L_pgf12
mvva 112 240 136
dma 4 48 88 0
mvva 108 240 132
trv 50 6 512
fma 31 31 23 23
mvva 108 244 148
rcp 28 28
mvva 104 244 144
trv 52 6 1024
mul 148 28 148
mvva 104 240 128
mul 152 120 152
wl 3
mvva 104 32 160
trv 54 6 1536
mul 153 121 153
mvva 104 36 176
dma 5 48 88 1024
mvva 108 36 180
trv 240 7 0
mul 154 122 154
mvva 108 32 164
rcp 29 29
mvva 112 32 168
trv 242 7 512
mul 149 29 149
mvva 112 36 184
rcp 30 30
mvva 116 36 188
buffer_load_dword v249, v3, s[48:51], 0 offen offset:128
mvva 116 32 172
trv 244 7 1024
mul 150 30 150
mvva 100 40 172
trv 246 7 1536
s_add_u32 m0, s65, 57344
mvva 100 44 188
dma 4 48 89 0
mul 155 123 155
mvva 96 44 184
trv 32 7 8192
rcp 31 31
mvva 96 40 168
mul 151 31 151
mul 168 136 168
mvva 92 40 164
buffer_load_dword v249, v255, s[52:55], s86 offen
s_add_u32 s86, s86, 114688
mvva 92 44 180
trv 34 7 8704
mul 169 137 169
mvva 88 44 176
trv 36 7 9216
mul 170 138 170
mvva 88 40 160
mul 171 139 171
wl 3
mvva 88 48 192
dma 5 48 89 1024
mvva 88 52 208
trv 38 7 9728
cvt 184 152 153
mvva 92 52 212
trv 40 6 8192
cvt 185 154 155
mvva 92 48 196
cvt 186 168 169
cvt 187 170 171
mvva 96 48 200
trv 42 6 8704
mul 156 124 156
mvva 96 52 216
mul 157 125 157
mul 159 127 159
mvva 100 52 220
trv 44 6 9216
mul 158 126 158
mvva 100 48 204
mul 173 141 173
mul 174 142 174
mvva 116 240 204
trv 46 6 9728
mul 172 140 172
mvva 116 244 220
s_waitcnt vmcnt(10)
s_barrier
mvva 112 244 216
s_add_u32 m0, s65, 65536
trv 48 6 16384
mvva 112 240 200
dma 4 48 90 0
mvva 108 240 196
trv 50 6 16896
mul 175 143 175
mvva 108 244 212
cvt 188 156 157
cvt 189 158 159
mvva 104 244 208
trv 52 6 17408
cvt 190 172 173
mvva 104 240 192
cvt 191 174 175
wl 3
mvva 104 32 224
trv 54 6 17920
mul 160 128 160
mvva 104 36 240
dma 5 48 90 1024
mvva 108 36 244
trv 240 7 16384
mul 161 129 161
mvva 108 32 228
mul 162 130 162
mul 163 131 163
mvva 112 32 232
trv 242 7 16896
mul 176 144 176
mvva 112 36 248
mul 177 145 177
mul 179 147 179
mvva 116 36 252
trv 244 7 17408
mul 178 146 178
mvva 116 32 236
cvt 193 162 163
cvt 194 176 177
mvva 100 40 236
trv 246 7 17920
s_add_u32 m0, s65, 73728
mvva 100 44 252
dma 4 48 91 0
mvva 96 44 248
trv 32 7 24576
cvt 192 160 161
mvva 96 40 232
cvt 195 178 179
mul 165 133 165
mvva 92 40 228
trv 34 7 25088
mul 164 132 164
mvva 92 44 244
mul 167 135 167
mul 180 148 180
mvva 88 44 240
trv 36 7 25600
mul 166 134 166
mvva 88 40 224
mul 182 150 182
wl 3
mvvv 88 48 56
dma 5 48 91 1024
mvvv 88 52 72
trv 38 7 26112
mul 181 149 181
mvvv 92 52 76
trv 40 6 24576
cvt 196 164 165
mvvv 92 48 60
mul 183 151 183
cvt 198 180 181
mvvv 96 48 64
trv 42 6 25088
cvt 199 182 183
mvvv 96 52 80
cvt 197 166 167
mvvv 100 52 84
trv 44 6 25600
mvvv 100 48 68
mvvv 116 240 68
trv 46 6 26112
mvvv 116 244 84
s_waitcnt vmcnt(10)
s_barrier
mvvv 112 244 80
s_add_u32 m0, s65, 0
trv 48 6 32768
mvvv 112 240 64
dma 4 48 96 0
mvvv 108 240 60
trv 50 6 33280
mvvv 108 244 76
mvvv 104 244 72
trv 52 6 33792
mvvv 104 240 56
wl 3
mzvva 168 32 0
trv 54 6 34304
mvva 168 36 16
dma 5 48 96 1024
mzvva 172 36 20
trv 240 7 32768
mvva 172 32 4
mul 24 16 88
mul 25 16 89
mzvva 176 32 8
trv 242 7 33280
mul 26 16 90
mvva 176 36 24
exp 24 24
mzvva 180 36 28
trv 244 7 33792
mul 27 16 91
mvva 180 32 12
exp 26 26
mzvva 164 40 12
trv 246 7 34304
s_add_u32 m0, s65, 8192
mvva 164 44 28
dma 4 48 97 0
mzvva 160 44 24
trv 32 7 40960
fma 24 24 20 20
mvva 160 40 8
exp 25 25
mzvva 156 40 4
trv 34 7 41472
fma 25 25 20 20
mvva 156 44 20
exp 27 27
mzvva 152 44 16
trv 36 7 41984
fma 27 27 20 20
mvva 152 40 0
wl 3
mvva 152 48 32
dma 5 48 97 1024
mvva 152 52 48
trv 38 7 42496
fma 26 26 20 20
mvva 156 52 52
trv 40 6 40960
mul 28 16 104
mvva 156 48 36
rcp 24 24
mvva 160 48 40
trv 42 6 41472
mul 88 24 88
mvva 160 52 56
rcp 25 25
mvva 164 52 60
trv 44 6 41984
mul 89 25 89
mvva 164 48 44
rcp 26 26
mvva 180 240 44
trv 46 6 42496
mul 90 26 90
mvva 180 244 60
s_waitcnt vmcnt(8)
s_barrier
mvva 176 244 56
s_add_u32 s44, s44, 128
s_addc_u32 s45, s45, 0
mvva 176 240 40
s_sub_u32 s46, s46, 128
s_add_u32 m0, s65, 16384
mvva 172 240 36
trv 48 6 49152
mul 29 16 105
mvva 172 244 52
buffer_load_dwordx4 v4, s[44:47], 0 offen lds
mvva 168 244 48
trv 50 6 49664
mul 30 16 106
mvva 168 240 32
trv 52 6 50176
wl 3
mvva 168 32 64
trv 54 6 50688
rcp 27 27
mvva 168 36 80
buffer_load_dwordx4 v5, s[44:47], 0 offen offset:1024 lds
mvva 172 36 84
trv 240 7 49152
mul 91 27 91
mvva 172 32 68
exp 28 28
mvva 176 32 72
trv 242 7 49664
mul 31 16 107
mvva 176 36 88
exp 29 29
mvva 180 36 92
trv 244 7 50176
fma 28 28 20 20
mvva 180 32 76
exp 30 30
mvva 164 40 76
trv 246 7 50688
s_add_u32 m0, s65, 24576
mvva 164 44 92
dma 4 44 76 0
mvva 160 44 88
trv 32 7 57344
fma 29 29 20 20
mvva 160 40 72
exp 31 31
mvva 156 40 68
trv 34 7 57856
fma 31 31 20 20
mvva 156 44 84
rcp 28 28
mvva 152 44 80
trv 36 7 58368
fma 30 30 20 20
mvva 152 40 64
mul 104 28 104
wl 3
mvva 152 48 96
buffer_load_dword v249, v255, s[52:55], s86 offen
s_add_u32 s86, s86, 114688
mvva 152 52 112
dma 5 44 76 1024
mvva 156 52 116
trv 38 7 58880
mul 24 17 92
mvva 156 48 100
trv 40 6 57344
mul 25 17 93
mvva 160 48 104
trv 42 6 57856
mul 26 17 94
mvva 160 52 120
rcp 29 29
mvva 164 52 124
trv 44 6 58368
mul 105 29 105
mvva 164 48 108
rcp 30 30
mvva 180 240 108
trv 46 6 58880
mul 106 30 106
mvva 180 244 124
s_waitcnt vmcnt(9)
s_barrier
mvva 176 244 120
s_add_u32 m0, s65, 32768
trv 48 8 0
mvva 176 240 104
dma 4 44 77 0
mvva 172 240 100
trv 50 8 512
rcp 31 31
mvva 172 244 116
exp 24 24
mvva 168 244 112
trv 52 8 1024
mul 107 31 107
mvva 168 240 96
mul 27 17 95
wl 3
mvva 168 32 128
trv 54 8 1536
fma 24 24 21 21
mvva 168 36 144
dma 5 44 77 1024
mvva 172 36 148
trv 240 9 0
mvva 172 32 132
exp 25 25
mvva 176 32 136
trv 242 9 512
fma 25 25 21 21
mvva 176 36 152
exp 26 26
mvva 180 36 156
trv 244 9 1024
fma 26 26 21 21
mvva 180 32 140
exp 27 27
mvva 164 40 140
trv 246 9 1536
s_add_u32 m0, s65, 40960
mvva 164 44 156
dma 4 44 88 0
mvva 160 44 152
trv 32 9 8192
fma 27 27 21 21
mvva 160 40 136
rcp 24 24
mvva 156 40 132
trv 34 9 8704
mul 92 24 92
mvva 156 44 148
rcp 25 25
mvva 152 44 144
trv 36 9 9216
mul 93 25 93
mvva 152 40 128
mul 28 17 108
wl 3
mvva 152 48 160
dma 5 44 88 1024
mvva 152 52 176
trv 38 9 9728
mul 29 17 109
mvva 156 52 180
trv 40 8 8192
mul 30 17 110
mvva 156 48 164
rcp 26 26
mvva 160 48 168
trv 42 8 8704
mul 94 26 94
mvva 160 52 184
rcp 27 27
mvva 164 52 188
buffer_load_dword v249, v3, s[44:47], 0 offen offset:128
mvva 164 48 172
trv 44 8 9216
mul 95 27 95
mvva 180 240 172
trv 46 8 9728
mvva 180 244 188
s_waitcnt vmcnt(10)
s_barrier
mvva 176 244 184
s_add_u32 m0, s65, 49152
trv 48 6 0
mvva 176 240 168
dma 4 44 89 0
mvva 172 240 164
trv 50 6 512
mul 31 17 111
mvva 172 244 180
exp 28 28
mvva 168 244 176
trv 52 6 1024
fma 28 28 21 21
mvva 168 240 160
wl 3
mvva 168 32 192
trv 54 6 1536
mvva 168 36 208
dma 5 44 89 1024
mvva 172 36 212
trv 240 7 0
mvva 172 32 196
exp 29 29
mvva 176 32 200
trv 242 7 512
fma 29 29 21 21
mvva 176 36 216
exp 30 30
mvva 180 36 220
trv 244 7 1024
fma 30 30 21 21
mvva 180 32 204
exp 31 31
mvva 164 40 204
trv 246 7 1536
s_add_u32 m0, s65, 57344
mvva 164 44 220
dma 4 44 90 0
mvva 160 44 216
trv 32 7 8192
fma 31 31 21 21
mvva 160 40 200
rcp 28 28
mvva 156 40 196
trv 34 7 8704
mul 108 28 108
mvva 156 44 212
rcp 29 29
mvva 152 44 208
trv 36 7 9216
mul 109 29 109
mvva 152 40 192
mul 24 18 96
wl 3
mvva 152 48 224
dma 5 44 90 1024
mvva 152 52 240
trv 38 7 9728
mul 25 18 97
mvva 156 52 244
trv 40 6 8192
mul 26 18 98
mvva 156 48 228
rcp 30 30
mvva 160 48 232
trv 42 6 8704
mul 110 30 110
mvva 160 52 248
rcp 31 31
mvva 164 52 252
trv 44 6 9216
mul 111 31 111
mvva 164 48 236
exp 24 24
mvva 180 240 236
trv 46 6 9728
mul 27 18 99
mvva 180 244 252
s_waitcnt vmcnt(9)
s_barrier
mvva 176 244 248
s_add_u32 m0, s65, 65536
trv 48 6 16384
mvva 176 240 232
dma 4 44 91 0
mvva 172 240 228
trv 50 6 16896
fma 24 24 22 22
mvva 172 244 244
exp 25 25
mvva 168 244 240
trv 52 6 17408
fma 25 25 22 22
mvva 168 240 224
wl 3
mvvv 168 32 56
trv 54 6 17920
mvvv 168 36 72
dma 5 44 91 1024
mvvv 172 36 76
trv 240 7 16384
mvvv 172 32 60
exp 26 26
mvvv 176 32 64
trv 242 7 16896
fma 26 26 22 22
mvvv 176 36 80
exp 27 27
mvvv 180 36 84
trv 244 7 17408
fma 27 27 22 22
mvvv 180 32 68
rcp 24 24
mvvv 164 40 68
trv 246 7 17920
s_add_u32 m0, s65, 73728
mvvv 164 44 84
dma 4 44 96 0
mvvv 160 44 80
trv 32 7 24576
mul 96 24 96
mvvv 160 40 64
rcp 25 25
mvvv 156 40 60
trv 34 7 25088
mul 97 25 97
mvvv 156 44 76
rcp 26 26
mvvv 152 44 72
trv 36 7 25600
mul 98 26 98
mvvv 152 40 56
mul 28 18 112
wl 3
mzvva 120 48 0
dma 5 44 96 1024
mvva 120 52 16
trv 38 7 26112
mul 29 18 113
mzvva 124 52 20
trv 40 6 24576
rcp 27 27
mvva 124 48 4
exp 28 28
mzvva 128 48 8
buffer_load_dword v249, v255, s[52:55], s86 offen
s_add_u32 s86, s86, 114688
mvva 128 52 24
trv 42 6 25088
mul 99 27 99
mzvva 132 52 28
trv 44 6 25600
mul 30 18 114
mvva 132 48 12
exp 29 29
mzvva 148 240 12
trv 46 6 26112
mul 31 18 115
mvva 148 244 28
s_waitcnt vmcnt(10)
s_barrier
mzvva 144 244 24
s_add_u32 m0, s65, 0
trv 48 6 32768
mvva 144 240 8
dma 4 44 97 0
mzvva 140 240 4
trv 50 6 33280
fma 28 28 22 22
mvva 140 244 20
exp 30 30
mzvva 136 244 16
trv 52 6 33792
fma 29 29 22 22
L_pgf9:
s_cbranch_execz L_pgf13
mvva 136 240 0
fma 30 30 22 22
wl 3
mvva 136 32 32
trv 54 6 34304
mvva 136 36 48
dma 5 44 97 1024
mvva 140 36 52
trv 240 7 32768
exp 31 31
mvva 140 32 36
rcp 28 28
mvva 144 32 40
trv 242 7 33280
fma 31 31 22 22
mvva 144 36 56
rcp 29 29
mvva 148 36 60
trv 244 7 33792
mul 112 28 112
mvva 148 32 44
rcp 30 30
mvva 132 40 44
trv 246 7 34304
mul 113 29 113
mvva 132 44 60
s_add_u32 s48, s48, 128
s_addc_u32 s49, s49, 0
mvva 128 44 56
s_sub_u32 s50, s50, 128
s_add_u32 m0, s65, 8192
mvva 128 40 40
buffer_load_dwordx4 v4, s[48:51], 0 offen lds
mvva 124 40 36
trv 32 7 40960
mul 114 30 114
mvva 124 44 52
trv 34 7 41472
mul 24 19 100
mvva 120 44 48
trv 36 7 41984
mul 25 19 101
mvva 120 40 32
rcp 31 31
wl 3
mvva 120 48 64
buffer_load_dwordx4 v5, s[48:51], 0 offen offset:1024 lds
mvva 120 52 80
trv 38 7 42496
mul 115 31 115
mvva 124 52 84
trv 40 6 40960
mul 26 19 102
mvva 124 48 68
exp 24 24
mvva 128 48 72
trv 42 6 41472
mul 27 19 103
mvva 128 52 88
exp 25 25
mvva 132 52 92
trv 44 6 41984
fma 24 24 23 23
mvva 132 48 76
exp 26 26
mvva 148 240 76
trv 46 6 42496
fma 25 25 23 23
mvva 148 244 92
s_waitcnt vmcnt(9)
s_barrier
mvva 144 244 88
s_add_u32 m0, s65, 16384
trv 48 6 49152
mvva 144 240 72
dma 4 48 76 0
mvva 140 240 68
trv 50 6 49664
fma 26 26 23 23
mvva 140 244 84
exp 27 27
mvva 136 244 80
trv 52 6 50176
fma 27 27 23 23
mvva 136 240 64
mul 28 19 116
wl 3
mvva 136 32 96
trv 54 6 50688
mul 29 19 117
mvva 136 36 112
dma 5 48 76 1024
mvva 140 36 116
trv 240 7 49152
mul 30 19 118
mvva 140 32 100
rcp 24 24
mvva 144 32 104
trv 242 7 49664
mul 100 24 100
mvva 144 36 120
rcp 25 25
mvva 148 36 124
trv 244 7 50176
mul 101 25 101
mvva 148 32 108
rcp 26 26
mvva 132 40 108
trv 246 7 50688
s_add_u32 m0, s65, 24576
mvva 132 44 124
dma 4 48 77 0
mvva 128 44 120
trv 32 7 57344
mul 102 26 102
mvva 128 40 104
rcp 27 27
mvva 124 40 100
trv 34 7 57856
mul 103 27 103
mvva 124 44 116
exp 28 28
mvva 120 44 112
trv 36 7 58368
mul 31 19 119
mvva 120 40 96
fma 28 28 23 23
wl 3
mvva 120 48 128
dma 5 48 77 1024
mvva 120 52 144
trv 38 7 58880
mvva 124 52 148
trv 40 6 57344
mvva 124 48 132
exp 29 29
mvva 128 48 136
trv 42 6 57856
fma 29 29 23 23
mvva 128 52 152
exp 30 30
mvva 132 52 156
trv 44 6 58368
fma 30 30 23 23
mvva 132 48 140
exp 31 31
mvva 148 240 140
trv 46 6 58880
mvva 148 244 156
s_waitcnt vmcnt(9)
s_barrier
mvva 144 244 152
s_add_u32 m0, s65, 32768
trv 48 8 0
mvva 144 240 136
dma 4 48 88 0
mvva 140 240 132
trv 50 8 512
fma 31 31 23 23
mvva 140 244 148
rcp 28 28
mvva 136 244 144
trv 52 8 1024
mul 116 28 116
mvva 136 240 128
mul 152 88 152
wl 3
mvva 136 32 160
trv 54 8 1536
mul 153 89 153
mvva 136 36 176
dma 5 48 88 1024
mvva 140 36 180
trv 240 9 0
mul 154 90 154
mvva 140 32 164
rcp 29 29
mvva 144 32 168
trv 242 9 512
mul 117 29 117
mvva 144 36 184
rcp 30 30
mvva 148 36 188
buffer_load_dword v249, v3, s[48:51], 0 offen offset:128
mvva 148 32 172
trv 244 9 1024
mul 118 30 118
mvva 132 40 172
trv 246 9 1536
s_add_u32 m0, s65, 40960
mvva 132 44 188
dma 4 48 89 0
mul 155 91 155
mvva 128 44 184
trv 32 9 8192
rcp 31 31
mvva 128 40 168
mul 119 31 119
mul 168 104 168
mvva 124 40 164
trv 34 9 8704
mul 169 105 169
mvva 124 44 180
mul 170 106 170
cvt 200 152 153
mvva 120 44 176
trv 36 9 9216
mul 171 107 171
mvva 120 40 160
cvt 202 168 169
wl 3
mvva 120 48 192
dma 5 48 89 1024
mvva 120 52 208
trv 38 9 9728
cvt 201 154 155
mvva 124 52 212
trv 40 8 8192
mul 156 92 156
mvva 124 48 196
cvt 203 170 171
mul 158 94 158
mvva 128 48 200
trv 42 8 8704
mul 159 95 159
mvva 128 52 216
mul 157 93 157
mul 173 109 173
mvva 132 52 220
trv 44 8 9216
mul 174 110 174
mvva 132 48 204
mul 175 111 175
cvt 204 156 157
mvva 148 240 204
buffer_load_dword v249, v255, s[52:55], s86 offen
s_add_u32 s86, s86, 114688
mvva 148 244 220
s_waitcnt vmcnt(10)
s_barrier
mvva 144 244 216
trv 46 8 9728
s_add_u32 m0, s65, 49152
mvva 144 240 200
trv 48 6 0
mul 172 108 172
mvva 140 240 196
dma 4 48 90 0
mvva 140 244 212
trv 50 6 512
cvt 205 158 159
mvva 136 244 208
trv 52 6 1024
cvt 206 172 173
mvva 136 240 192
cvt 207 174 175
wl 3
mvva 136 32 224
trv 54 6 1536
mul 160 96 160
mvva 136 36 240
dma 5 48 90 1024
mvva 140 36 244
trv 240 7 0
mul 161 97 161
mvva 140 32 228
mul 162 98 162
mul 163 99 163
mvva 144 32 232
trv 242 7 512
mul 176 112 176
mvva 144 36 248
mul 177 113 177
mul 179 115 179
mvva 148 36 252
trv 244 7 1024
mul 178 114 178
mvva 148 32 236
cvt 209 162 163
cvt 210 176 177
mvva 132 40 236
trv 246 7 1536
s_add_u32 m0, s65, 57344
mvva 132 44 252
dma 4 48 91 0
mvva 128 44 248
trv 32 7 8192
cvt 208 160 161
mvva 128 40 232
cvt 211 178 179
mul 165 101 165
mvva 124 40 228
trv 34 7 8704
mul 164 100 164
mvva 124 44 244
mul 167 103 167
mul 180 116 180
mvva 120 44 240
trv 36 7 9216
mul 166 102 166
mvva 120 40 224
mul 182 118 182
wl 3
mvvv 120 48 56
dma 5 48 91 1024
mvvv 120 52 72
trv 38 7 9728
mul 181 117 181
mvvv 124 52 76
trv 40 6 8192
cvt 212 164 165
mvvv 124 48 60
mul 183 119 183
cvt 214 180 181
mvvv 128 48 64
trv 42 6 8704
cvt 215 182 183
mvvv 128 52 80
cvt 213 166 167
mvvv 132 52 84
trv 44 6 9216
mvvv 132 48 68
mvvv 148 240 68
trv 46 6 9728
mvvv 148 244 84
s_waitcnt vmcnt(10)
s_barrier
mvvv 144 244 80
s_add_u32 m0, s65, 65536
trv 48 6 16384
mvvv 144 240 64
dma 4 48 96 0
mvvv 140 240 60
trv 50 6 16896
mvvv 140 244 76
mvvv 136 244 72
trv 52 6 17408
mvvv 136 240 56
wl 3
mzvva 168 32 0
trv 54 6 17920
mvva 168 36 16
dma 5 48 96 1024
mzvva 172 36 20
trv 240 7 16384
mvva 172 32 4
mul 24 16 120
mul 25 16 121
mzvva 176 32 8
trv 242 7 16896
mul 26 16 122
mvva 176 36 24
exp 24 24
mzvva 180 36 28
trv 244 7 17408
mul 27 16 123
mvva 180 32 12
exp 26 26
mzvva 164 40 12
trv 246 7 17920
s_add_u32 m0, s65, 73728
mvva 164 44 28
dma 4 48 97 0
mzvva 160 44 24
trv 32 7 24576
fma 24 24 20 20
mvva 160 40 8
exp 25 25
mzvva 156 40 4
trv 34 7 25088
fma 25 25 20 20
mvva 156 44 20
exp 27 27
mzvva 152 44 16
trv 36 7 25600
fma 27 27 20 20
mvva 152 40 0
wl 3
mvva 152 48 32
dma 5 48 97 1024
mvva 152 52 48
trv 38 7 26112
fma 26 26 20 20
mvva 156 52 52
trv 40 6 24576
mul 28 16 136
mvva 156 48 36
rcp 24 24
mvva 160 48 40
trv 42 6 25088
mul 120 24 120
mvva 160 52 56
rcp 25 25
mvva 164 52 60
trv 44 6 25600
mul 121 25 121
mvva 164 48 44
rcp 26 26
mvva 180 240 44
trv 46 6 26112
mul 122 26 122
mvva 180 244 60
s_waitcnt vmcnt(9)
s_barrier
mvva 176 244 56
s_add_u32 s44, s44, 128
s_addc_u32 s45, s45, 0
mvva 176 240 40
s_sub_u32 s46, s46, 128
s_add_u32 m0, s65, 0
mvva 172 240 36
trv 48 6 32768
mul 29 16 137
mvva 172 244 52
buffer_load_dwordx4 v4, s[44:47], 0 offen lds
mvva 168 244 48
trv 50 6 33280
mul 30 16 138
mvva 168 240 32
trv 52 6 33792
wl 3
mvva 168 32 64
trv 54 6 34304
rcp 27 27
mvva 168 36 80
buffer_load_dwordx4 v5, s[44:47], 0 offen offset:1024 lds
mvva 172 36 84
trv 240 7 32768
mul 123 27 123
mvva 172 32 68
exp 28 28
mvva 176 32 72
trv 242 7 33280
mul 31 16 139
mvva 176 36 88
exp 29 29
mvva 180 36 92
trv 244 7 33792
fma 28 28 20 20
mvva 180 32 76
exp 30 30
mvva 164 40 76
trv 246 7 34304
s_add_u32 m0, s65, 8192
mvva 164 44 92
dma 4 44 76 0
mvva 160 44 88
trv 32 7 40960
fma 29 29 20 20
mvva 160 40 72
exp 31 31
mvva 156 40 68
trv 34 7 41472
fma 31 31 20 20
mvva 156 44 84
rcp 28 28
mvva 152 44 80
trv 36 7 41984
fma 30 30 20 20
mvva 152 40 64
mul 136 28 136
wl 3
mvva 152 48 96
dma 5 44 76 1024
mvva 152 52 112
trv 38 7 42496
mul 24 17 124
mvva 156 52 116
trv 40 6 40960
mul 25 17 125
mvva 156 48 100
rcp 29 29
mvva 160 48 104
trv 42 6 41472
mul 137 29 137
mvva 160 52 120
rcp 30 30
mvva 164 52 124
trv 44 6 41984
mul 138 30 138
mvva 164 48 108
rcp 31 31
mvva 180 240 108
trv 46 6 42496
mul 26 17 126
mvva 180 244 124
s_waitcnt vmcnt(8)
s_barrier
mvva 176 244 120
s_add_u32 m0, s65, 16384
trv 48 6 49152
mvva 176 240 104
dma 4 44 77 0
mvva 172 240 100
buffer_load_dword v249, v255, s[52:55], s86 offen
s_add_u32 s86, s86, 114688
mvva 172 244 116
trv 50 6 49664
mul 139 31 139
mvva 168 244 112
trv 52 6 50176
mul 27 17 127
mvva 168 240 96
wl 3
mvva 168 32 128
trv 54 6 50688
mvva 168 36 144
dma 5 44 77 1024
mvva 172 36 148
trv 240 7 49152
mvva 172 32 132
exp 24 24
mvva 176 32 136
trv 242 7 49664
fma 24 24 21 21
mvva 176 36 152
exp 25 25
mvva 180 36 156
trv 244 7 50176
fma 25 25 21 21
mvva 180 32 140
exp 26 26
mvva 164 40 140
trv 246 7 50688
s_add_u32 m0, s65, 24576
mvva 164 44 156
dma 4 44 88 0
mvva 160 44 152
trv 32 7 57344
fma 26 26 21 21
mvva 160 40 136
exp 27 27
mvva 156 40 132
trv 34 7 57856
fma 27 27 21 21
mvva 156 44 148
rcp 24 24
mvva 152 44 144
trv 36 7 58368
mul 124 24 124
mvva 152 40 128
mul 28 17 140
wl 3
mvva 152 48 160
dma 5 44 88 1024
mvva 152 52 176
trv 38 7 58880
mul 29 17 141
mvva 156 52 180
trv 40 6 57344
mul 30 17 142
mvva 156 48 164
rcp 25 25
mvva 160 48 168
trv 42 6 57856
mul 125 25 125
mvva 160 52 184
rcp 26 26
mvva 164 52 188
trv 44 6 58368
mul 126 26 126
mvva 164 48 172
rcp 27 27
mvva 180 240 172
trv 46 6 58880
mul 127 27 127
mvva 180 244 188
s_waitcnt vmcnt(9)
s_barrier
mvva 176 244 184
s_add_u32 m0, s65, 32768
trv 48 8 0
mvva 176 240 168
dma 4 44 89 0
mvva 172 240 164
trv 50 8 512
mul 31 17 143
mvva 172 244 180
exp 28 28
mvva 168 244 176
trv 52 8 1024
fma 28 28 21 21
mvva 168 240 160
wl 3
mvva 168 32 192
trv 54 8 1536
mvva 168 36 208
dma 5 44 89 1024
mvva 172 36 212
trv 240 9 0
mvva 172 32 196
L_pgf10:
s_cbranch_execz L_pgf14
exp 29 29
mvva 176 32 200
trv 242 9 512
fma 29 29 21 21
mvva 176 36 216
exp 30 30
mvva 180 36 220
trv 244 9 1024
fma 30 30 21 21
mvva 180 32 204
exp 31 31
mvva 164 40 204
trv 246 9 1536
s_add_u32 m0, s65, 40960
mvva 164 44 220
dma 4 44 90 0
mvva 160 44 216
trv 32 9 8192
fma 31 31 21 21
mvva 160 40 200
rcp 28 28
mvva 156 40 196
trv 34 9 8704
mul 140 28 140
mvva 156 44 212
rcp 29 29
mvva 152 44 208
trv 36 9 9216
mul 141 29 141
mvva 152 40 192
mul 24 18 128
wl 3
mvva 152 48 224
dma 5 44 90 1024
mvva 152 52 240
trv 38 9 9728
mul 25 18 129
mvva 156 52 244
trv 40 8 8192
mul 26 18 130
mvva 156 48 228
rcp 30 30
mvva 160 48 232
trv 42 8 8704
mul 142 30 142
mvva 160 52 248
rcp 31 31
mvva 164 52 252
trv 44 8 9216
mul 143 31 143
mvva 164 48 236
exp 24 24
mvva 180 240 236
trv 46 8 9728
mul 27 18 131
mvva 180 244 252
s_waitcnt vmcnt(9)
s_barrier
mvva 176 244 248
s_add_u32 m0, s65, 49152
trv 48 6 0
mvva 176 240 232
dma 4 44 91 0
mvva 172 240 228
trv 50 6 512
fma 24 24 22 22
mvva 172 244 244
exp 25 25
mvva 168 244 240
trv 52 6 1024
fma 25 25 22 22
mvva 168 240 224
wl 3
mvvv 168 32 56
trv 54 6 1536
mvvv 168 36 72
dma 5 44 91 1024
mvvv 172 36 76
trv 240 7 0
mvvv 172 32 60
exp 26 26
mvvv 176 32 64
trv 242 7 512
fma 26 26 22 22
mvvv 176 36 80
exp 27 27
mvvv 180 36 84
trv 244 7 1024
fma 27 27 22 22
mvvv 180 32 68
rcp 24 24
mvvv 164 40 68
trv 246 7 1536
s_add_u32 m0, s65, 57344
mvvv 164 44 84
dma 4 44 96 0
mvvv 160 44 80
trv 32 7 8192
mul 128 24 128
mvvv 160 40 64
rcp 25 25
mvvv 156 40 60
trv 34 7 8704
mul 129 25 129
mvvv 156 44 76
rcp 26 26
mvvv 152 44 72
trv 36 7 9216
mul 130 26 130
mvvv 152 40 56
mul 28 18 144
wl 3
mzvva 88 48 0
dma 5 44 96 1024
mvva 88 52 16
trv 38 7 9728
mul 29 18 145
mzvva 92 52 20
trv 40 6 8192
rcp 27 27
mvva 92 48 4
exp 28 28
mzvva 96 48 8
trv 42 6 8704
mul 131 27 131
mvva 96 52 24
exp 29 29
mzvva 100 52 28
trv 44 6 9216
mul 30 18 146
mvva 100 48 12
exp 30 30
mzvva 116 240 12
trv 46 6 9728
mul 31 18 147
mvva 116 244 28
s_waitcnt vmcnt(8)
s_barrier
mzvva 112 244 24
s_add_u32 m0, s65, 65536
trv 48 6 16384
mvva 112 240 8
dma 4 44 97 0
mzvva 108 240 4
trv 50 6 16896
fma 28 28 22 22
mvva 108 244 20
exp 31 31
mzvva 104 244 16
trv 52 6 17408
fma 29 29 22 22
mvva 104 240 0
fma 30 30 22 22
wl 3
mvva 104 32 32
buffer_load_dword v249, v255, s[52:55], s86 offen
s_add_u32 s86, s86, 114688
mvva 104 36 48
trv 54 6 17920
fma 31 31 22 22
mvva 108 36 52
dma 5 44 97 1024
mvva 108 32 36
trv 240 7 16384
mul 24 19 132
mvva 112 32 40
trv 242 7 16896
mul 25 19 133
mvva 112 36 56
rcp 28 28
mvva 116 36 60
trv 244 7 17408
mul 144 28 144
mvva 116 32 44
rcp 29 29
mvva 100 40 44
trv 246 7 17920
mul 145 29 145
mvva 100 44 60
s_add_u32 s48, s48, 128
s_addc_u32 s49, s49, 0
mvva 96 44 56
s_sub_u32 s50, s50, 128
s_add_u32 m0, s65, 73728
mvva 96 40 40
buffer_load_dwordx4 v4, s[48:51], 0 offen lds
mvva 92 40 36
trv 32 7 24576
mul 26 19 134
mvva 92 44 52
trv 34 7 25088
rcp 30 30
mvva 88 44 48
trv 36 7 25600
mul 146 30 146
mvva 88 40 32
rcp 31 31
wl 3
mvva 88 48 64
buffer_load_dwordx4 v5, s[48:51], 0 offen offset:1024 lds
mvva 88 52 80
trv 38 7 26112
mul 147 31 147
mvva 92 52 84
trv 40 6 24576
mul 27 19 135
mvva 92 48 68
exp 24 24
mvva 96 48 72
trv 42 6 25088
fma 24 24 23 23
mvva 96 52 88
exp 25 25
mvva 100 52 92
trv 44 6 25600
fma 25 25 23 23
mvva 100 48 76
exp 26 26
mvva 116 240 76
trv 46 6 26112
fma 26 26 23 23
mvva 116 244 92
s_waitcnt vmcnt(9)
s_barrier
mvva 112 244 88
s_add_u32 m0, s65, 0
trv 48 6 32768
mvva 112 240 72
dma 4 48 76 0
mvva 108 240 68
trv 50 6 33280
mvva 108 244 84
exp 27 27
mvva 104 244 80
trv 52 6 33792
fma 27 27 23 23
mvva 104 240 64
mul 28 19 148
wl 3
mvva 104 32 96
trv 54 6 34304
mul 29 19 149
mvva 104 36 112
dma 5 48 76 1024
mvva 108 36 116
trv 240 7 32768
mul 30 19 150
mvva 108 32 100
rcp 24 24
mvva 112 32 104
trv 242 7 33280
mul 132 24 132
mvva 112 36 120
rcp 25 25
mvva 116 36 124
trv 244 7 33792
mul 133 25 133
mvva 116 32 108
rcp 26 26
mvva 100 40 108
trv 246 7 34304
s_add_u32 m0, s65, 8192
mvva 100 44 124
dma 4 48 77 0
mvva 96 44 120
trv 32 7 40960
mul 134 26 134
mvva 96 40 104
rcp 27 27
mvva 92 40 100
trv 34 7 41472
mul 135 27 135
mvva 92 44 116
exp 28 28
mvva 88 44 112
trv 36 7 41984
mul 31 19 151
mvva 88 40 96
fma 28 28 23 23
wl 3
mvva 88 48 128
dma 5 48 77 1024
mvva 88 52 144
trv 38 7 42496
mvva 92 52 148
trv 40 6 40960
mvva 92 48 132
exp 29 29
mvva 96 48 136
trv 42 6 41472
fma 29 29 23 23
mvva 96 52 152
exp 30 30
mvva 100 52 156
trv 44 6 41984
fma 30 30 23 23
mvva 100 48 140
exp 31 31
mvva 116 240 140
trv 46 6 42496
mvva 116 244 156
s_waitcnt vmcnt(9)
s_barrier
mvva 112 244 152
s_add_u32 m0, s65, 16384
trv 48 6 49152
mvva 112 240 136
dma 4 48 88 0
mvva 108 240 132
trv 50 6 49664
fma 31 31 23 23
mvva 108 244 148
rcp 28 28
mvva 104 244 144
trv 52 6 50176
mul 148 28 148
mvva 104 240 128
mul 152 120 152
wl 3
mvva 104 32 160
trv 54 6 50688
mul 153 121 153
mvva 104 36 176
dma 5 48 88 1024
mvva 108 36 180
trv 240 7 49152
mul 154 122 154
mvva 108 32 164
rcp 29 29
mvva 112 32 168
trv 242 7 49664
mul 149 29 149
mvva 112 36 184
rcp 30 30
mvva 116 36 188
trv 244 7 50176
mul 150 30 150
mvva 116 32 172
rcp 31 31
mvva 100 40 172
trv 246 7 50688
s_add_u32 m0, s65, 24576
mvva 100 44 188
dma 4 48 89 0
mvva 96 44 184
trv 32 7 57344
mul 151 31 151
mvva 96 40 168
mul 155 123 155
mul 168 136 168
mvva 92 40 164
trv 34 7 57856
mul 169 137 169
mvva 92 44 180
mul 170 138 170
cvt 216 152 153
mvva 88 44 176
trv 36 7 58368
mul 171 139 171
mvva 88 40 160
cvt 218 168 169
wl 3
mvva 88 48 192
dma 5 48 89 1024
mvva 88 52 208
trv 38 7 58880
cvt 217 154 155
mvva 92 52 212
trv 40 6 57344
mul 156 124 156
mvva 92 48 196
cvt 219 170 171
mul 158 126 158
mvva 96 48 200
trv 42 6 57856
mul 159 127 159
mvva 96 52 216
mul 157 125 157
mul 173 141 173
mvva 100 52 220
trv 44 6 58368
mul 174 142 174
mvva 100 48 204
mul 175 143 175
cvt 220 156 157
mvva 116 240 204
trv 46 6 58880
mul 172 140 172
mvva 116 244 220
s_waitcnt vmcnt(8)
s_barrier
mvva 112 244 216
s_add_u32 m0, s65, 32768
trv 48 8 0
mvva 112 240 200
dma 4 48 90 0
mvva 108 240 196
trv 50 8 512
cvt 222 172 173
mvva 108 244 212
cvt 221 158 159
mul 160 128 160
mvva 104 244 208
trv 52 8 1024
mul 161 129 161
mvva 104 240 192
cvt 223 174 175
wl 3
mvva 104 32 224
trv 54 8 1536
mul 163 131 163
mvva 104 36 240
dma 5 48 90 1024
mvva 108 36 244
trv 240 9 0
mul 162 130 162
mvva 108 32 228
mul 177 145 177
mul 178 146 178
mvva 112 32 232
trv 242 9 512
mul 176 144 176
mvva 112 36 248
cvt 224 160 161
cvt 225 162 163
mvva 116 36 252
trv 244 9 1024
cvt 226 176 177
mvva 116 32 236
mul 179 147 179
mul 164 132 164
mvva 100 40 236
trv 246 9 1536
s_add_u32 m0, s65, 40960
mvva 100 44 252
dma 4 48 91 0
mvva 96 44 248
trv 32 9 8192
mul 165 133 165
mvva 96 40 232
cvt 227 178 179
mul 167 135 167
mvva 92 40 228
trv 34 9 8704
mul 180 148 180
mvva 92 44 244
mul 181 149 181
mul 182 150 182
mvva 88 44 240
trv 36 9 9216
mul 166 134 166
mvva 88 40 224
cvt 228 164 165
wl 3
mvvv 88 48 56
dma 5 48 91 1024
mvvv 88 52 72
trv 38 9 9728
cvt 229 166 167
mvvv 92 52 76
trv 40 8 8192
cvt 230 180 181
mvvv 92 48 60
mul 183 151 183
mvvv 96 48 64
trv 42 8 8704
mvvv 96 52 80
mvvv 100 52 84
trv 44 8 9216
mvvv 100 48 68
cvt 231 182 183
mvvv 116 240 68
trv 46 8 9728
mvvv 116 244 84
s_waitcnt vmcnt(8)
s_barrier
mvvv 112 244 80
s_add_u32 m0, s65, 49152
trv 48 6 0
mvvv 112 240 64
dma 4 48 96 0
mvvv 108 240 60
trv 50 6 512
mvvv 108 244 76
mvvv 104 244 72
trv 52 6 1024
mvvv 104 240 56
wl 3
mzvva 168 32 0
trv 54 6 1536
mvva 168 36 16
dma 5 48 96 1024
mzvva 172 36 20
trv 240 7 0
mvva 172 32 4
mul 24 16 88
mul 25 16 89
mzvva 176 32 8
trv 242 7 512
mul 26 16 90
mvva 176 36 24
exp 24 24
mzvva 180 36 28
trv 244 7 1024
mul 27 16 91
mvva 180 32 12
exp 25 25
mzvva 164 40 12
trv 246 7 1536
s_add_u32 m0, s65, 57344
mvva 164 44 28
dma 4 48 97 0
mzvva 160 44 24
trv 32 7 8192
fma 24 24 20 20
mvva 160 40 8
exp 26 26
mzvva 156 40 4
trv 34 7 8704
fma 25 25 20 20
mvva 156 44 20
exp 27 27
mzvva 152 44 16
trv 36 7 9216
fma 27 27 20 20
mvva 152 40 0
rda 0 13 49152
wl 4
mvva 152 48 32
dma 5 48 97 1024
mvva 152 52 48
trv 38 7 9728
fma 26 26 20 20
mvva 156 52 52
rda 4 13 50176
mul 28 16 104
mvva 156 48 36
trv 40 6 8192
mul 29 16 105
mvva 160 48 40
rda 8 13 51200
mul 30 16 106
mvva 160 52 56
trv 42 6 8704
mul 31 16 107
mvva 164 52 60
rda 12 13 52224
mvva 164 48 44
trv 44 6 9216
mvva 180 240 44
rda 16 13 57344
rcp 24 24
mvva 180 244 60
s_waitcnt vmcnt(8)
s_barrier
mvva 176 244 56
trv 46 6 9728
s_mov_b32 s66, 0
mvva 176 240 40
rda 20 13 58368
s_add_u32 m0, s65, 65536
mvva 172 240 36
trv 48 6 16384
rcp 25 25
mvva 172 244 52
dma 250 52 66 0
mul 88 24 88
mvva 168 244 48
rda 24 13 59392
rcp 26 26
mvva 168 240 32
trv 50 6 16896
wl 4
mvva 168 32 64
rda 28 13 60416
rcp 27 27
mvva 168 36 80
trv 52 6 17408
mul 89 25 89
mvva 172 36 84
rda 32 13 32768
mul 90 26 90
mvva 172 32 68
trv 54 6 17920
mul 91 27 91
mvva 176 32 72
rda 36 13 33792
mvva 176 36 88
dma 251 52 66 1024
mvva 180 36 92
L_pgf11:
s_cbranch_execz L_pgf15
trv 240 7 16384
mvva 180 32 76
rda 40 13 34816
exp 28 28
mvva 164 40 76
trv 242 7 16896
s_mov_b32 s66, 73728
mvva 164 44 92
rda 44 13 35840
s_add_u32 m0, s65, 73728
mvva 160 44 88
trv 244 7 17408
exp 29 29
mvva 160 40 72
trv 246 7 17920
exp 30 30
mvva 156 40 68
rda 48 13 40960
fma 28 28 20 20
mvva 156 44 84
rda 52 13 41984
exp 31 31
mvva 152 44 80
dma 250 52 66 0
mvva 152 40 64
trv 32 7 24576
wl 3
mvva 152 48 96
rda 56 13 43008
fma 29 29 20 20
mvva 152 52 112
trv 34 7 25088
fma 30 30 20 20
mvva 156 52 116
rda 60 13 44032
fma 31 31 20 20
mvva 156 48 100
trv 36 7 25600
rcp 28 28
mvva 160 48 104
rda 64 13 16384
rcp 29 29
mvva 160 52 120
dma 251 52 66 1024
mvva 164 52 124
trv 38 7 26112
rcp 30 30
mvva 164 48 108
rda 68 13 17408
mul 104 28 104
mvva 180 240 108
trv 40 6 24576
rcp 31 31
mvva 180 244 124
s_waitcnt vmcnt(8)
s_barrier
mvva 176 244 120
rda 72 13 18432
s_mov_b32 s66, 147456
mvva 176 240 104
trv 42 6 25088
trv 44 6 25600
trv 46 6 26112
mvva 172 240 100
rda 76 13 19456
s_add_u32 m0, s65, 0
mvva 172 244 116
rda 80 13 24576
mul 105 29 105
mvva 168 244 112
rda 84 13 25600
mul 106 30 106
mvva 168 240 96
trv 48 6 32768
wl 4
mvva 168 32 128
dma 250 52 66 0
mul 107 31 107
mvva 168 36 144
rda 88 13 26624
mul 24 17 92
mvva 172 36 148
trv 50 6 33280
mul 25 17 93
mvva 172 32 132
rda 92 13 27648
mul 26 17 94
mvva 176 32 136
trv 52 6 33792
mul 27 17 95
mvva 176 36 152
rda 96 13 0
exp 24 24
mvva 180 36 156
trv 54 6 34304
exp 25 25
mvva 180 32 140
rda 100 13 1024
exp 26 26
mvva 164 40 140
dma 251 52 66 1024
s_mov_b32 s66, 221184
mvva 164 44 156
trv 240 7 32768
rda 104 13 2048
mvva 160 44 152
trv 242 7 33280
s_add_u32 m0, s65, 8192
mvva 160 40 136
trv 244 7 33792
trv 246 7 34304
mvva 156 40 132
rda 108 13 3072
exp 27 27
mvva 156 44 148
rda 112 13 8192
fma 24 24 21 21
mvva 152 44 144
rda 116 13 9216
fma 25 25 21 21
mvva 152 40 128
dma 250 52 66 0
wl 3
mvva 152 48 160
trv 32 7 40960
fma 26 26 21 21
mvva 152 52 176
rda 120 13 10240
fma 27 27 21 21
mvva 156 52 180
trv 34 7 41472
rcp 24 24
mvva 156 48 164
rda 124 13 11264
rcp 25 25
mvva 160 48 168
trv 36 7 41984
rcp 26 26
mvva 160 52 184
rda 128 15 0
rcp 27 27
mvva 164 52 188
dma 251 52 66 1024
mul 92 24 92
mvva 164 48 172
trv 38 7 42496
rda 132 15 1024
mvva 180 240 172
trv 40 6 40960
mul 93 25 93
mvva 180 244 188
s_waitcnt vmcnt(8)
s_barrier
mvva 176 244 184
rda 136 15 2048
s_mov_b32 s66, 294912
mvva 176 240 168
trv 42 6 41472
trv 44 6 41984
trv 46 6 42496
mvva 172 240 164
rda 140 15 3072
s_add_u32 m0, s65, 16384
mvva 172 244 180
rda 144 15 8192
mul 94 26 94
mvva 168 244 176
rda 148 15 9216
mul 95 27 95
mvva 168 240 160
trv 48 6 49152
wl 4
mvva 168 32 192
rda 152 15 10240
mul 28 17 108
mvva 168 36 208
dma 250 52 66 0
mul 29 17 109
mvva 172 36 212
trv 50 6 49664
mul 30 17 110
mvva 172 32 196
rda 156 15 11264
mul 31 17 111
mvva 176 32 200
trv 52 6 50176
exp 28 28
mvva 176 36 216
trv 54 6 50688
exp 29 29
mvva 180 36 220
dma 251 52 66 1024
fma 28 28 21 21
mvva 180 32 204
trv 240 7 49152
exp 30 30
mvva 164 40 204
trv 242 7 49664
s_mov_b32 s66, 128
mvva 164 44 220
trv 244 7 50176
s_add_u32 m0, s65, 24576
mvva 160 44 216
trv 246 7 50688
exp 31 31
mvva 160 40 200
dma 250 52 66 0
fma 29 29 21 21
mvva 156 40 196
trv 32 7 57344
fma 30 30 21 21
mvva 156 44 212
trv 34 7 57856
fma 31 31 21 21
mvva 152 44 208
trv 36 7 58368
rcp 28 28
mvva 152 40 192
rcp 29 29
wl 3
mvva 152 48 224
dma 251 52 66 1024
mul 108 28 108
mvva 152 52 240
trv 38 7 58880
rcp 30 30
mvva 156 52 244
trv 40 6 57344
rcp 31 31
mvva 156 48 228
mul 109 29 109
mul 110 30 110
mvva 160 48 232
trv 42 6 57856
mul 111 31 111
mvva 160 52 248
mul 24 18 96
mul 25 18 97
mvva 164 52 252
trv 44 6 58368
mul 26 18 98
mvva 164 48 236
exp 24 24
mvva 180 240 236
trv 46 6 58880
mul 27 18 99
mvva 180 244 252
s_waitcnt vmcnt(8)
s_barrier
mvva 176 244 248
s_mov_b32 s66, 73856
s_add_u32 m0, s65, 81920
mvva 176 240 232
trv 48 8 0
exp 25 25
mvva 172 240 228
dma 250 52 66 0
fma 24 24 22 22
mvva 172 244 244
ds_write_b128 v12, v[184:187] offset:49152
mvva 168 244 240
trv 50 8 512
exp 26 26
mvva 168 240 224
trv 52 8 1024
wl 4
mvvv 168 32 56
trv 54 8 1536
exp 27 27
mvvv 168 36 72
dma 251 52 66 1024
fma 25 25 22 22
mvvv 172 36 76
trv 240 9 0
fma 26 26 22 22
mvvv 172 32 60
ds_write_b128 v12, v[188:191] offset:50176
mvvv 176 32 64
trv 242 9 512
fma 27 27 22 22
mvvv 176 36 80
rcp 24 24
mvvv 180 36 84
trv 244 9 1024
rcp 25 25
mvvv 180 32 68
rcp 26 26
mvvv 164 40 68
trv 246 9 1536
s_mov_b32 s66, 147584
mvvv 164 44 84
s_add_u32 m0, s65, 90112
rcp 27 27
mvvv 160 44 80
dma 250 52 66 0
mul 96 24 96
mvvv 160 40 64
trv 32 9 8192
mul 97 25 97
mvvv 156 40 60
ds_write_b128 v12, v[192:195] offset:51200
mvvv 156 44 76
trv 34 9 8704
mul 98 26 98
mvvv 152 44 72
trv 36 9 9216
mul 99 27 99
mvvv 152 40 56
mul 28 18 112
wl 4
mzvva 120 48 0
dma 251 52 66 1024
mul 29 18 113
mvva 120 52 16
trv 38 9 9728
mul 30 18 114
mzvva 124 52 20
trv 40 8 8192
mul 31 18 115
mvva 124 48 4
ds_write_b128 v12, v[196:199] offset:52224
mzvva 128 48 8
trv 42 8 8704
exp 28 28
mvva 128 52 24
exp 29 29
mzvva 132 52 28
trv 44 8 9216
exp 30 30
mvva 132 48 12
exp 31 31
mzvva 148 240 12
trv 46 8 9728
fma 28 28 22 22
mvva 148 244 28
s_waitcnt vmcnt(8)
s_barrier
mzvva 144 244 24
s_mov_b32 s66, 221312
s_add_u32 m0, s65, 32768
mvva 144 240 8
trv 48 6 0
fma 29 29 22 22
mzvva 140 240 4
dma 250 52 66 0
fma 30 30 22 22
mvva 140 244 20
ds_write_b128 v12, v[200:203] offset:32768
mzvva 136 244 16
trv 50 6 512
fma 31 31 22 22
mvva 136 240 0
trv 52 6 1024
wl 4
mvva 136 32 32
dma 251 52 66 1024
mul 24 19 100
mvva 136 36 48
trv 54 6 1536
rcp 28 28
mvva 140 36 52
trv 240 7 0
rcp 29 29
mvva 140 32 36
ds_write_b128 v12, v[204:207] offset:33792
mvva 144 32 40
s_mov_b32 s66, 295040
s_add_u32 m0, s65, 40960
mvva 144 36 56
trv 242 7 512
rcp 30 30
mvva 148 36 60
dma 250 52 66 0
mul 112 28 112
mvva 148 32 44
trv 244 7 1024
rcp 31 31
mvva 132 40 44
trv 246 7 1536
mul 113 29 113
mvva 132 44 60
dma 251 52 66 1024
mul 114 30 114
mvva 128 44 56
trv 32 7 8192
mul 115 31 115
mvva 128 40 40
ds_write_b128 v12, v[208:211] offset:34816
mvva 124 40 36
trv 34 7 8704
mul 25 19 101
mvva 124 44 52
s_mov_b32 s66, 368640
s_add_u32 m0, s65, 49152
mvva 120 44 48
dma 250 52 66 0
mul 26 19 102
mvva 120 40 32
trv 36 7 9216
wl 4
mvva 120 48 64
trv 38 7 9728
mul 27 19 103
mvva 120 52 80
exp 24 24
mvva 124 52 84
trv 40 6 8192
exp 25 25
mvva 124 48 68
ds_write_b128 v12, v[212:215] offset:35840
mvva 128 48 72
dma 251 52 66 1024
fma 24 24 23 23
mvva 128 52 88
trv 42 6 8704
exp 26 26
mvva 132 52 92
trv 44 6 9216
exp 27 27
mvva 132 48 76
rcp 24 24
mvva 148 240 76
trv 46 6 9728
fma 25 25 23 23
mvva 148 244 92
s_waitcnt vmcnt(10)
s_barrier
mvva 144 244 88
s_mov_b32 s66, 442368
s_add_u32 m0, s65, 57344
mvva 144 240 72
trv 48 6 16384
fma 26 26 23 23
mvva 140 240 68
dma 250 52 66 0
fma 27 27 23 23
mvva 140 244 84
ds_write_b128 v12, v[216:219] offset:16384
mvva 136 244 80
trv 50 6 16896
rcp 25 25
mvva 136 240 64
trv 52 6 17408
wl 4
mvva 136 32 96
dma 251 52 66 1024
mul 100 24 100
mvva 136 36 112
trv 54 6 17920
rcp 26 26
mvva 140 36 116
trv 240 7 16384
rcp 27 27
mvva 140 32 100
ds_write_b128 v12, v[220:223] offset:17408
mvva 144 32 104
s_mov_b32 s66, 516096
s_add_u32 m0, s65, 65536
mvva 144 36 120
trv 242 7 16896
mul 101 25 101
mvva 148 36 124
dma 250 52 66 0
mul 102 26 102
mvva 148 32 108
trv 244 7 17408
mul 103 27 103
mvva 132 40 108
trv 246 7 17920
mul 28 19 116
mvva 132 44 124
dma 251 52 66 1024
mul 29 19 117
mvva 128 44 120
trv 32 7 24576
mul 30 19 118
mvva 128 40 104
ds_write_b128 v12, v[224:227] offset:18432
mvva 124 40 100
trv 34 7 25088
mul 31 19 119
mvva 124 44 116
s_mov_b32 s66, 589824
s_add_u32 m0, s65, 73728
mvva 120 44 112
dma 250 52 66 0
mvva 120 40 96
trv 36 7 25600
wl 4
mvva 120 48 128
trv 38 7 26112
exp 28 28
mvva 120 52 144
exp 29 29
mvva 124 52 148
trv 40 6 24576
exp 30 30
mvva 124 48 132
ds_write_b128 v12, v[228:231] offset:19456
mvva 128 48 136
dma 251 52 66 1024
fma 28 28 23 23
mvva 128 52 152
trv 42 6 25088
exp 31 31
mvva 132 52 156
trv 44 6 25600
fma 29 29 23 23
mvva 132 48 140
rcp 28 28
mvva 148 240 140
trv 46 6 26112
fma 30 30 23 23
mvva 148 244 156
s_waitcnt vmcnt(12)
s_barrier
mvva 144 244 152
s_mov_b32 s66, 368768
s_add_u32 m0, s65, 0
mvva 144 240 136
trv 48 8 16384
fma 31 31 23 23
mvva 140 240 132
dma 250 52 66 0
mul 116 28 116
mvva 140 244 148
trv 50 8 16896
rcp 29 29
mvva 136 244 144
trv 52 8 17408
rcp 30 30
mvva 136 240 128
rcp 31 31
wl 3
mzvva 200 32 0
trv 54 8 17920
mul 117 29 117
mvva 200 36 16
dma 251 52 66 1024
mul 118 30 118
mzvva 204 36 20
trv 240 9 16384
mul 119 31 119
mvva 204 32 4
mul 152 88 152
mul 153 89 153
mzvva 208 32 8
trv 242 9 16896
mul 154 90 154
mvva 208 36 24
mul 155 91 155
mul 168 104 168
mzvva 212 36 28
trv 244 9 17408
mul 169 105 169
mvva 212 32 12
mul 170 106 170
mul 171 107 171
mzvva 196 40 12
trv 246 9 17920
s_mov_b32 s66, 442496
mvva 196 44 28
s_add_u32 m0, s65, 8192
cvt 88 152 153
mzvva 192 44 24
dma 250 52 66 0
cvt 89 154 155
mvva 192 40 8
trv 32 9 24576
cvt 90 168 169
mzvva 188 40 4
trv 34 9 25088
cvt 91 170 171
mvva 188 44 20
ds_write_b128 v12, v[88:91] offset:0
mzvva 184 44 16
trv 36 9 25600
mul 156 92 156
mvva 184 40 0
mul 157 93 157
wl 4
mvva 184 48 32
dma 251 52 66 1024
mvva 184 52 48
L_pgf12:
s_cbranch_execz L_pgf16
trv 38 9 26112
mul 158 94 158
mvva 188 52 52
trv 40 8 24576
mul 159 95 159
mvva 188 48 36
mul 172 108 172
mul 173 109 173
mvva 192 48 40
trv 42 8 25088
mul 174 110 174
mvva 192 52 56
mul 175 111 175
cvt 92 156 157
mvva 196 52 60
trv 44 8 25600
cvt 93 158 159
mvva 196 48 44
cvt 94 172 173
cvt 95 174 175
mvva 212 240 44
ds_write_b128 v12, v[92:95] offset:1024
mvva 212 244 60
s_waitcnt vmcnt(12)
s_barrier
mvva 208 244 56
trv 46 8 26112
s_mov_b32 s66, 516224
mvva 208 240 40
s_add_u32 m0, s65, 16384
trv 48 6 32768
mvva 204 240 36
dma 250 52 66 0
mvva 204 244 52
trv 50 6 33280
mul 160 96 160
mvva 200 244 48
trv 52 6 33792
mul 161 97 161
mvva 200 240 32
mul 162 98 162
wl 3
mvva 200 32 64
trv 54 6 34304
mul 163 99 163
mvva 200 36 80
dma 251 52 66 1024
mvva 204 36 84
trv 240 7 32768
mul 176 112 176
mvva 204 32 68
mul 177 113 177
mul 178 114 178
mvva 208 32 72
trv 242 7 33280
mul 179 115 179
mvva 208 36 88
cvt 96 160 161
cvt 97 162 163
mvva 212 36 92
trv 244 7 33792
cvt 98 176 177
mvva 212 32 76
cvt 99 178 179
mul 164 100 164
mvva 196 40 76
ds_write_b128 v12, v[96:99] offset:2048
mvva 196 44 92
trv 246 7 34304
s_mov_b32 s66, 589952
mvva 192 44 88
s_add_u32 m0, s65, 24576
trv 32 7 40960
mvva 192 40 72
dma 250 52 66 0
mvva 188 40 68
trv 34 7 41472
mul 165 101 165
mvva 188 44 84
mul 166 102 166
mul 167 103 167
mvva 184 44 80
trv 36 7 41984
mul 180 116 180
mvva 184 40 64
mul 181 117 181
wl 3
mvva 184 48 96
dma 251 52 66 1024
mvva 184 52 112
trv 38 7 42496
mul 182 118 182
mvva 188 52 116
trv 40 6 40960
mul 183 119 183
mvva 188 48 100
cvt 100 164 165
cvt 101 166 167
mvva 192 48 104
trv 42 6 41472
cvt 102 180 181
mvva 192 52 120
cvt 103 182 183
mvva 196 52 124
ds_write_b128 v12, v[100:103] offset:3072
mvva 196 48 108
trv 44 6 41984
mvva 212 240 108
trv 46 6 42496
mvva 212 244 124
s_waitcnt vmcnt(12)
s_barrier
mvva 208 244 120
s_add_u32 s52, s52, 256
s_addc_u32 s53, s53, 0
s_sub_u32 s54, s54, 256
s_add_u32 m0, s65, 81920
s_nop 0
buffer_load_dwordx4 v250, s[52:55], 0 offen lds
buffer_load_dwordx4 v251, s[52:55], 0 offen offset:1024 lds
s_mov_b32 s76, 73728
s_add_u32 m0, s65, 90112
s_nop 0
dma 250 52 76 0
dma 251 52 76 1024
mvva 208 240 104
wl 2
s_barrier
mvva 204 240 100
trv 48 6 49152
mvva 204 244 116
rda 160 13 49152
mvva 200 244 112
rda 164 13 50176
mvva 200 240 96
trv 50 6 49664
wl 4
mvva 200 32 128
rda 168 13 51200
mvva 200 36 144
rda 172 13 52224
mvva 204 36 148
trv 52 6 50176
mvva 204 32 132
rda 176 13 57344
mvva 208 32 136
rda 180 13 58368
mvva 208 36 152
trv 54 6 50688
mvva 212 36 156
rda 184 13 59392
mvva 212 32 140
rda 188 13 60416
mvva 196 40 140
trv 240 7 49152
mvva 196 44 156
rda 192 13 32768
mvva 192 44 152
rda 196 13 33792
mvva 192 40 136
trv 242 7 49664
trv 244 7 50176
trv 246 7 50688
mvva 188 40 132
rda 200 13 34816
rda 204 13 35840
mvva 188 44 148
rda 208 13 40960
mvva 184 44 144
rda 212 13 41984
mvva 184 40 128
rda 216 13 43008
wl 5
mvva 120 48 160
rda 220 13 44032
mvva 120 52 176
trv 32 7 57344
rda 224 13 16384
mvva 124 52 180
rda 228 13 17408
mvva 124 48 164
trv 34 7 57856
rda 232 13 18432
mvva 128 48 168
rda 236 13 19456
mvva 128 52 184
trv 36 7 58368
rda 240 13 24576
mvva 132 52 188
rda 244 13 25600
mvva 132 48 172
trv 38 7 58880
rda 248 13 26624
mvva 148 240 172
rda 252 13 27648
mvva 148 244 188
s_waitcnt vmcnt(12)
s_barrier
mvva 144 244 184
trv 40 6 57344
rdv 56 13 0
mvva 144 240 168
trv 42 6 57856
trv 44 6 58368
trv 46 6 58880
mvva 140 240 164
rdv 60 13 1024
rdv 64 13 2048
mvva 140 244 180
rdv 68 13 3072
rdv 72 13 8192
mvva 136 244 176
rdv 76 13 9216
s_mov_b32 s77, 147456
mvva 136 240 160
rdv 80 13 10240
wl 6
mvva 136 32 192
rdv 84 13 11264
s_add_u32 m0, s65, 32768
mvva 136 36 208
trv 48 8 0
dma 250 52 77 0
mvva 140 36 212
trv 50 8 512
mvva 140 32 196
trv 52 8 1024
mvva 144 32 200
trv 54 8 1536
mvva 144 36 216
dma 251 52 77 1024
mvva 148 36 220
trv 240 9 0
mvva 148 32 204
trv 242 9 512
mvva 132 40 204
trv 244 9 1024
s_mov_b32 s88, 221184
mvva 132 44 220
trv 246 9 1536
s_add_u32 m0, s65, 40960
mvva 128 44 216
dma 250 52 88 0
mvva 128 40 200
trv 32 9 8192
mvva 124 40 196
trv 34 9 8704
mvva 124 44 212
mvva 120 44 208
trv 36 9 9216
mvva 120 40 192
wl 3
mvva 120 48 224
dma 251 52 88 1024
mvva 120 52 240
trv 38 9 9728
mvva 124 52 244
trv 40 8 8192
mvva 124 48 228
mvva 128 48 232
trv 42 8 8704
mvva 128 52 248
mvva 132 52 252
trv 44 8 9216
mvva 132 48 236
mvva 148 240 236
trv 46 8 9728
mvva 148 244 252
s_waitcnt vmcnt(12)
s_barrier
mvva 144 244 248
s_mov_b32 s89, 294912
s_add_u32 m0, s65, 131072
mvva 144 240 232
trv 48 6 0
mvva 140 240 228
dma 250 52 89 0
mvva 140 244 244
trv 50 6 512
s_load_dwordx2 s[44:45], s[0:1], 0
mvva 136 244 240
trv 52 6 1024
s_load_dwordx2 s[56:57], s[0:1], 72
mvva 136 240 224
dma 251 52 89 1024
wl 0
mvvv 136 32 56
trv 54 6 1536
mvvv 136 36 72
v_and_b32 v12, 15, v1
mvvv 140 36 76
trv 240 7 0
mvvv 140 32 60
s_mov_b32 s90, 368640
s_add_u32 m0, s65, 139264
mvvv 144 32 64
trv 242 7 512
v_lshlrev_b32 v12, 7, v12
mvvv 144 36 80
dma 250 52 90 0
mvvv 148 36 84
trv 244 7 1024
mvvv 148 32 68
s_lshl_b32 s78, s72, 2
mvvv 132 40 68
trv 246 7 1536
mvvv 132 44 84
dma 251 52 90 1024
mvvv 128 44 80
trv 32 7 8192
v_mov_b32 v13, s78
mvvv 128 40 64
mvvv 124 40 60
trv 34 7 8704
s_lshl_b32 s78, s74, 3
mvvv 124 44 76
s_mov_b32 s91, 442368
s_add_u32 m0, s65, 114688
mvvv 120 44 72
dma 250 52 91 0
mvvv 120 40 56
trv 36 7 9216
wl 3
mvva 184 48 160
trv 38 7 9728
s_add_u32 s78, s78, s70
mvva 184 52 176
mvva 188 52 180
trv 40 6 8192
s_lshl_b32 s79, s78, 10
mvva 188 48 164
dma 251 52 91 1024
mvva 192 48 168
trv 42 6 8704
cvt 152 120 121
mvva 192 52 184
cvt 153 122 123
s_lshl_b32 s80, s75, 14
mvva 196 52 188
trv 44 6 9216
cvt 154 136 137
mvva 196 48 172
s_add_u32 s79, s79, s80
cvt 156 124 125
mvva 212 240 172
trv 46 6 9728
cvt 155 138 139
mvva 212 244 188
s_waitcnt vmcnt(14)
s_barrier
mvva 208 244 184
s_mov_b32 s96, 516096
s_add_u32 m0, s65, 122880
mvva 208 240 168
trv 48 6 16384
s_mul_i32 s80, s72, 147456
mvva 204 240 164
dma 250 52 96 0
mvva 204 244 180
buffer_store_dwordx4 v[152:155], v248, s[60:63], s69 offen offset:0 sc1
mvva 200 244 176
trv 50 6 16896
s_add_u32 s79, s79, s80
mvva 200 240 160
trv 52 6 17408
wl 3
mvva 200 32 192
dma 251 52 96 1024
mvva 200 36 208
trv 54 6 17920
v_lshlrev_b32 v14, 4, v1
mvva 204 36 212
trv 240 7 16384
cvt 157 126 127
mvva 204 32 196
s_mov_b32 s97, 589824
s_add_u32 m0, s65, 98304
mvva 208 32 200
trv 242 7 16896
cvt 158 140 141
mvva 208 36 216
dma 250 52 97 0
mvva 212 36 220
trv 244 7 17408
v_add_u32 v14, s79, v14
mvva 212 32 204
cvt 159 142 143
s_lshl_b32 s80, s70, 4
mvva 196 40 204
buffer_store_dwordx4 v[156:159], v248, s[60:63], s69 offen offset:1024 sc1
mvva 196 44 220
trv 246 7 17920
s_lshl_b32 s81, s72, 7
mvva 192 44 216
dma 251 52 97 1024
mvva 192 40 200
trv 32 7 24576
cvt 160 128 129
mvva 188 40 196
trv 34 7 25088
s_add_u32 s80, s80, s81
mvva 188 44 212
s_add_u32 s52, s52, 128
s_addc_u32 s53, s53, 0
mvva 184 44 208
s_sub_u32 s54, s54, 128
s_add_u32 m0, s65, 106496
mvva 184 40 192
buffer_load_dwordx4 v250, s[52:55], 0 offen lds
wl 2
mvva 184 48 224
trv 36 7 25600
cvt 161 130 131
mvva 184 52 240
trv 38 7 26112
v_and_b32 v15, 15, v1
mvva 188 52 244
trv 40 6 24576
cvt 162 144 145
mvva 188 48 228
buffer_load_dwordx4 v251, s[52:55], 0 offen offset:1024 lds
mvva 192 48 232
trv 42 6 25088
v_add_u32 v15, s80, v15
mvva 192 52 248
cvt 163 146 147
v_mul_u32_u24 v15, 1152, v15
mvva 196 52 252
buffer_store_dwordx4 v[160:163], v248, s[60:63], s69 offen offset:2048 sc1
mvva 196 48 236
trv 44 6 25600
s_lshl_b32 s79, s74, 6
mvva 212 240 236
trv 46 6 26112
cvt 164 132 133
mvva 212 244 252
s_waitcnt vmcnt(13)
s_barrier
mvva 208 244 248
s_add_u32 m0, s65, 49152
trv 48 8 16384
mvva 208 240 232
dma 250 52 76 0
s_lshl_b32 s80, s75, 7
mvva 204 240 228
trv 50 8 16896
cvt 165 134 135
mvva 204 244 244
cvt 166 148 149
s_add_u32 s79, s79, s80
mvva 200 244 240
trv 52 8 17408
cvt 167 150 151
mvva 200 240 224
v_lshrrev_b32 v20, 4, v1
wl 3
mvvv 200 32 56
buffer_store_dwordx4 v[164:167], v248, s[60:63], s69 offen offset:3072 sc1
mvvv 200 36 72
trv 54 8 17920
v_lshlrev_b32 v20, 3, v20
mvvv 204 36 76
trv 240 9 16384
mvvv 204 32 60
dma 251 52 76 1024
s_add_u32 s69, s69, 16384
mvvv 208 32 64
trv 242 9 16896
v_add3_u32 v15, v15, v20, s79
mvvv 208 36 80
mvvv 212 36 84
trv 244 9 17408
v_add_u32 v16, v15, v20
mvvv 212 32 68
mvvv 196 40 68
trv 246 9 17920
mvvv 196 44 84
v_lshrrev_b32 v22, 4, v1
mvvv 192 44 80
trv 32 9 24576
s_add_u32 m0, s65, 57344
mvvv 192 40 64
dma 250 52 77 0
mvvv 188 40 60
trv 34 9 25088
v_bfe_u32 v20, v1, 2, 2
mvvv 188 44 76
mvvv 184 44 72
trv 36 9 25600
v_cmp_eq_u32 s[78:79], v20, v22
mvvv 184 40 56
wl 3
mzvva 120 48 0
trv 38 9 26112
mvva 120 52 16
v_and_b32 v20, 1, v1
mzvva 124 52 20
trv 40 8 24576
mvva 124 48 4
dma 251 52 77 1024
mzvva 128 48 8
trv 42 8 25088
cvt 168 184 185
mvva 128 52 24
v_lshlrev_b32 v20, 4, v20
cvt 170 200 201
mzvva 132 52 28
trv 44 8 25600
cvt 169 186 187
mvva 132 48 12
v_mov_b32 v21, 0x3f80
mzvva 148 240 12
trv 46 8 26112
mvva 148 244 28
mzvva 144 244 24
trv 48 6 32768
v_lshlrev_b32 v21, v20, v21
mvva 144 240 8
mzvva 140 240 4
trv 50 6 33280
s_add_u32 m0, s65, 65536
mvva 140 244 20
dma 250 52 88 0
mzvva 136 244 16
trv 52 6 33792
v_cndmask_b32 v21, 0, v21, s[78:79]
mvva 136 240 0
cvt 171 202 203
wl 3
mvva 136 32 32
trv 54 6 34304
v_and_b32 v20, 2, v1
mvva 136 36 48
cvt 172 188 189
mvva 140 36 52
trv 240 7 32768
v_cmp_eq_u32 vcc, 0, v20
mvva 140 32 36
buffer_store_dwordx4 v[168:171], v248, s[60:63], s69 offen offset:0 sc1
mvva 144 32 40
trv 242 7 33280
mvva 144 36 56
dma 251 52 88 1024
mvva 148 36 60
trv 244 7 33792
v_cndmask_b32 v234, 0, v21, vcc
mvva 148 32 44
v_cndmask_b32 v235, v21, 0, vcc
cvt 174 204 205
mvva 132 40 44
trv 246 7 34304
mvva 132 44 60
mvva 128 44 56
L_pgf13:
s_cbranch_execz L_pgf_back
trv 32 7 40960
v_mov_b32 v232, 0
mvva 128 40 40
cvt 175 206 207
mvva 124 40 36
trv 34 7 41472
mvva 124 44 52
v_mov_b32 v233, 0
mvva 120 44 48
trv 36 7 41984
s_add_u32 m0, s65, 73728
mvva 120 40 32
dma 250 52 89 0
wl 3
mvva 120 48 64
trv 38 7 42496
cvt 173 190 191
mvva 120 52 80
v_mov_b32 v236, 0
mvva 124 52 84
trv 40 6 40960
v_mov_b32 v237, 0
mvva 124 48 68
mvva 128 48 72
trv 42 6 41472
mvva 128 52 88
v_and_b32 v20, 8, v1
mvva 132 52 92
trv 44 6 41984
mvva 132 48 76
dma 251 52 89 1024
mvva 148 240 76
trv 46 6 42496
v_cmp_eq_u32 s[78:79], 0, v20
mvva 148 244 92
cvt 176 192 193
mvva 144 244 88
trv 48 10 0
mvva 144 240 72
v_cmp_ne_u32 s[80:81], 0, v20
mvva 140 240 68
trv 50 10 512
cvt 177 194 195
mvva 140 244 84
buffer_store_dwordx4 v[172:175], v248, s[60:63], s69 offen offset:1024 sc1
mvva 136 244 80
trv 52 10 1024
s_mov_b32 s48, s38
mvva 136 240 64
wl 3
mvva 136 32 96
trv 54 10 1536
s_mov_b32 s49, s39
mvva 136 36 112
s_waitcnt vmcnt(14)
s_barrier
mvva 140 36 116
s_add_u32 m0, s65, 0
trv 240 11 0
mvva 140 32 100
dma 250 52 90 0
s_mov_b32 s50, 37748736
mvva 144 32 104
trv 242 11 512
cvt 179 210 211
mvva 144 36 120
mvva 148 36 124
trv 244 11 1024
s_mov_b32 s51, 0x20000
mvva 148 32 108
mvva 132 40 108
trv 246 11 1536
mvva 132 44 124
mvva 128 44 120
trv 32 11 8192
mvva 128 40 104
dma 251 52 90 1024
s_mov_b32 s46, 2359296
mvva 124 40 100
trv 34 11 8704
mvva 124 44 116
cvt 178 208 209
mvva 120 44 112
trv 36 11 9216
s_mov_b32 s47, 0x20000
mvva 120 40 96
wl 3
mvva 120 48 128
trv 38 11 9728
mvva 120 52 144
s_mov_b32 s58, 2359296
cvt 180 196 197
mvva 124 52 148
trv 40 10 8192
s_add_u32 m0, s65, 8192
mvva 124 48 132
dma 250 52 91 0
mvva 128 48 136
trv 42 10 8704
s_mov_b32 s59, 0x20000
mvva 128 52 152
cvt 181 198 199
mvva 132 52 156
buffer_store_dwordx4 v[176:179], v248, s[60:63], s69 offen offset:2048 sc1
mvva 132 48 140
trv 44 10 9216
s_add_u32 s84, s75, 1
mvva 148 240 140
trv 46 10 9728
mvva 148 244 156
s_mov_b32 s85, 0
mvva 144 244 152
trv 48 8 49152
mvva 144 240 136
dma 251 52 91 1024
mvva 140 240 132
trv 50 8 49664
s_add_u32 s3, s75, 1
mvva 140 244 148
mvva 136 244 144
trv 52 8 50176
cvt 183 214 215
mvva 136 240 128
buffer_load_dwordx2 v[216:217], v15, s[44:47], 0 offen offset:0
wl 3
mvva 136 32 160
trv 54 8 50688
mvva 136 36 176
mvva 140 36 180
trv 240 9 49152
mvva 140 32 164
mvva 144 32 168
trv 242 9 49664
s_add_u32 m0, s65, 16384
mvva 144 36 184
buffer_load_dwordx2 v[218:219], v15, s[44:47], 0 offen offset:32
mvva 148 36 188
dma 250 52 96 0
mvva 148 32 172
trv 244 9 50176
cvt 182 212 213
mvva 132 40 172
trv 246 9 50688
mvva 132 44 188
mvva 128 44 184
trv 32 9 57344
mvva 128 40 168
buffer_load_dwordx2 v[220:221], v15, s[44:47], 0 offen offset:256
mvva 124 40 164
trv 34 9 57856
mvva 124 44 180
dma 251 52 96 1024
mvva 120 44 176
trv 36 9 58368
mvva 120 40 160
buffer_load_dwordx2 v[222:223], v15, s[44:47], 0 offen offset:288
wl 3
mvva 120 48 192
buffer_store_dwordx4 v[180:183], v248, s[60:63], s69 offen offset:3072 sc1
mvva 120 52 208
trv 38 9 58880
mvva 124 52 212
trv 40 8 57344
mvva 124 48 196
mvva 128 48 200
trv 42 8 57856
mvva 128 52 216
buffer_load_dwordx2 v[224:225], v15, s[44:47], 0 offen offset:512
mvva 132 52 220
trv 44 8 58368
s_add_u32 m0, s65, 24576
mvva 132 48 204
dma 250 52 97 0
s_add_u32 s69, s69, 16384
mvva 148 240 204
trv 46 8 58880
mvva 148 244 220
mvva 144 244 216
trv 48 8 32768
mvva 144 240 200
buffer_load_dwordx2 v[226:227], v15, s[44:47], 0 offen offset:544
mvva 140 240 196
trv 50 8 33280
mvva 140 244 212
mvva 136 244 208
trv 52 8 33792
mvva 136 240 192
dma 251 52 97 1024
wl 3
mvva 136 32 224
trv 54 8 34304
mvva 136 36 240
buffer_load_dwordx2 v[228:229], v15, s[44:47], 0 offen offset:768
mvva 140 36 244
trv 240 9 32768
mvva 140 32 228
mvva 144 32 232
trv 242 9 33280
mvva 144 36 248
buffer_load_dwordx2 v[230:231], v15, s[44:47], 0 offen offset:800
mvva 148 36 252
trv 244 9 33792
mvva 148 32 236
mvva 132 40 236
trv 246 9 34304
mvva 132 44 252
s_waitcnt vmcnt(19)
s_barrier
mvva 128 44 248
s_add_u32 s52, s52, 128
s_addc_u32 s53, s53, 0
mvva 128 40 232
s_sub_u32 s54, s54, 128
s_add_u32 m0, s65, 81920
mvva 124 40 228
trv 32 9 40960
mvva 124 44 244
buffer_load_dwordx4 v250, s[52:55], 0 offen lds
mvva 120 44 240
buffer_load_dwordx2 v[24:25], v15, s[44:47], 0 offen offset:1024
mvva 120 40 224
trv 34 9 41472
wl 2
mvvv 120 48 56
trv 36 9 41984
mvvv 120 52 72
trv 38 9 42496
mvvv 124 52 76
buffer_load_dwordx2 v[26:27], v15, s[44:47], 0 offen offset:1056
mvvv 124 48 60
buffer_load_dwordx4 v251, s[52:55], 0 offen offset:1024 lds
mvvv 128 48 64
trv 40 8 40960
mvvv 128 52 80
trv 42 8 41472
mvvv 132 52 84
trv 44 8 41984
mvvv 132 48 68
buffer_load_dword v17, v13, s[92:95], 0 offen sc1
s_add_u32 m0, s65, 90112
mvvv 148 240 68
trv 46 8 42496
mvvv 148 244 84
dma 250 52 76 0
mvvv 144 244 80
trv 48 6 49152
mvvv 144 240 64
mvvv 140 240 60
trv 50 6 49664
mvvv 140 244 76
mvvv 136 244 72
trv 52 6 50176
mvvv 136 240 56
wl 3
s_mov_b32 s68, 2
.p2align 3
L_ffn_d:
mzvva 104 32 0
dma 251 52 76 1024
mvva 104 36 16
trv 54 6 50688
mzvva 108 36 20
trv 240 7 49152
mvva 108 32 4
cvt 152 120 121
cvt 154 136 137
mzvva 112 32 8
trv 242 7 49664
cvt 155 138 139
mvva 112 36 24
s_add_u32 m0, s65, 32768
mzvva 116 36 28
trv 244 7 50176
cvt 153 122 123
mvva 116 32 12
dma 250 52 77 0
mzvva 100 40 12
trv 246 7 50688
mvva 100 44 28
mzvva 96 44 24
trv 32 7 57344
mvva 96 40 8
mzvva 92 40 4
trv 34 7 57856
mvva 92 44 20
dma 251 52 77 1024
mzvva 88 44 16
trv 36 7 58368
cvt 156 124 125
mvva 88 40 0
wl 3
mvva 88 48 32
trv 38 7 58880
mvva 88 52 48
mvva 92 52 52
trv 40 6 57344
cvt 157 126 127
mvva 92 48 36
buffer_store_dwordx4 v[152:155], v248, s[60:63], s69 offen offset:0 sc1
mvva 96 48 40
s_add_u32 m0, s65, 40960
trv 42 6 57856
mvva 96 52 56
dma 250 52 88 0
mvva 100 52 60
trv 44 6 58368
mvva 100 48 44
mvva 116 240 44
trv 46 6 58880
mvva 116 244 60
mvva 112 244 56
trv 48 8 0
mvva 112 240 40
dma 251 52 88 1024
mvva 108 240 36
trv 50 8 512
cvt 159 142 143
mvva 108 244 52
mvva 104 244 48
trv 52 8 1024
mvva 104 240 32
wl 3
mvva 104 32 64
trv 54 8 1536
mvva 104 36 80
s_add_u32 m0, s65, 131072
mvva 108 36 84
trv 240 9 0
mvva 108 32 68
dma 250 52 89 0
mvva 112 32 72
trv 242 9 512
cvt 158 140 141
mvva 112 36 88
mvva 116 36 92
trv 244 9 1024
mvva 116 32 76
cvt 160 128 129
mvva 100 40 76
trv 246 9 1536
mvva 100 44 92
dma 251 52 89 1024
mvva 96 44 88
trv 32 9 8192
mvva 96 40 72
mvva 92 40 68
trv 34 9 8704
cvt 161 130 131
mvva 92 44 84
buffer_store_dwordx4 v[156:159], v248, s[60:63], s69 offen offset:1024 sc1
mvva 88 44 80
trv 36 9 9216
mvva 88 40 64
wl 3
mvva 88 48 96
trv 38 9 9728
mvva 88 52 112
s_waitcnt vmcnt(12)
s_barrier
mvva 92 52 116
s_add_u32 m0, s65, 139264
trv 40 8 8192
mvva 92 48 100
dma 250 52 90 0
mvva 96 48 104
trv 42 8 8704
v_add_u32 v253, 1, v253
mvva 96 52 120
buffer_store_dword v253, v252, s[40:43], 0 offen sc1
mvva 100 52 124
trv 44 8 9216
cvt 163 146 147
mvva 100 48 108
mvva 116 240 108
trv 46 8 9728
mvva 116 244 124
mvva 112 244 120
trv 48 6 0
mvva 112 240 104
dma 251 52 90 1024
mvva 108 240 100
trv 50 6 512
mvva 108 244 116
cvt 162 144 145
mvva 104 244 112
trv 52 6 1024
mvva 104 240 96
wl 3
mvva 104 32 128
trv 54 6 1536
mvva 104 36 144
cvt 164 132 133
mvva 108 36 148
trv 240 7 0
s_add_u32 m0, s65, 114688
mvva 108 32 132
dma 250 52 91 0
mvva 112 32 136
trv 242 7 512
mvva 112 36 152
cvt 165 134 135
mvva 116 36 156
buffer_store_dwordx4 v[160:163], v248, s[60:63], s69 offen offset:2048 sc1
mvva 116 32 140
trv 244 7 1024
mvva 100 40 140
trv 246 7 1536
mvva 100 44 156
mvva 96 44 152
trv 32 7 8192
mvva 96 40 136
dma 251 52 91 1024
mvva 92 40 132
trv 34 7 8704
mvva 92 44 148
mvva 88 44 144
trv 36 7 9216
cvt 167 150 151
mvva 88 40 128
wl 3
mvva 88 48 160
trv 38 7 9728
mvva 88 52 176
mvva 92 52 180
trv 40 6 8192
mvva 92 48 164
mvva 96 48 168
trv 42 6 8704
s_add_u32 m0, s65, 122880
mvva 96 52 184
dma 250 52 96 0
mvva 100 52 188
trv 44 6 9216
cvt 166 148 149
mvva 100 48 172
mvva 116 240 172
trv 46 6 9728
mvva 116 244 188
mvva 112 244 184
trv 48 6 16384
mvva 112 240 168
mvva 108 240 164
trv 50 6 16896
mvva 108 244 180
dma 251 52 96 1024
mvva 104 244 176
trv 52 6 17408
mvva 104 240 160
wl 3
mvva 104 32 192
buffer_store_dwordx4 v[164:167], v248, s[60:63], s69 offen offset:3072 sc1
mvva 104 36 208
trv 54 6 17920
mvva 108 36 212
trv 240 7 16384
mvva 108 32 196
mvva 112 32 200
trv 242 7 16896
mvva 112 36 216
mvva 116 36 220
trv 244 7 17408
s_add_u32 m0, s65, 98304
mvva 116 32 204
dma 250 52 97 0
s_add_u32 s69, s69, 16384
mvva 100 40 204
trv 246 7 17920
mvva 100 44 220
mvva 96 44 216
trv 32 7 24576
mvva 96 40 200
mvva 92 40 196
trv 34 7 25088
mvva 92 44 212
mvva 88 44 208
trv 36 7 25600
mvva 88 40 192
dma 251 52 97 1024
wl 3
mvva 88 48 224
trv 38 7 26112
mvva 88 52 240
mvva 92 52 244
trv 40 6 24576
mvva 92 48 228
mvva 96 48 232
trv 42 6 25088
mvva 96 52 248
mvva 100 52 252
trv 44 6 25600
mvva 100 48 236
mvva 116 240 236
trv 46 6 26112
mvva 116 244 252
s_waitcnt vmcnt(12)
s_barrier
mvva 112 244 248
s_add_u32 s52, s52, 128
s_addc_u32 s53, s53, 0
mvva 112 240 232
s_sub_u32 s54, s54, 128
s_add_u32 m0, s65, 106496
mvva 108 240 228
trv 48 8 16384
mvva 108 244 244
buffer_load_dwordx4 v250, s[52:55], 0 offen lds
mvva 104 244 240
trv 50 8 16896
mvva 104 240 224
trv 52 8 17408
wl 3
mvvv 104 32 56
trv 54 8 17920
mvvv 104 36 72
buffer_load_dwordx4 v251, s[52:55], 0 offen offset:1024 lds
mvvv 108 36 76
trv 240 9 16384
mvvv 108 32 60
mvvv 112 32 64
trv 242 9 16896
mvvv 112 36 80
mvvv 116 36 84
trv 244 9 17408
mvvv 116 32 68
s_add_u32 m0, s65, 49152
mvvv 100 40 68
trv 246 9 17920
mvvv 100 44 84
dma 250 52 76 0
mvvv 96 44 80
trv 32 9 24576
mvvv 96 40 64
mvvv 92 40 60
L_pgf14:
s_cbranch_execz L_pgf_back
trv 34 9 25088
mvvv 92 44 76
mvvv 88 44 72
trv 36 9 25600
mvvv 88 40 56
dma 251 52 76 1024
wl 3
mzvva 120 48 0
trv 38 9 26112
mvva 120 52 16
mzvva 124 52 20
trv 40 8 24576
mvva 124 48 4
cvt 168 88 89
cvt 170 104 105
mzvva 128 48 8
trv 42 8 25088
cvt 171 106 107
mvva 128 52 24
s_add_u32 m0, s65, 57344
mzvva 132 52 28
trv 44 8 25600
cvt 169 90 91
mvva 132 48 12
dma 250 52 77 0
mzvva 148 240 12
trv 46 8 26112
mvva 148 244 28
mzvva 144 244 24
trv 48 6 32768
mvva 144 240 8
mzvva 140 240 4
trv 50 6 33280
mvva 140 244 20
dma 251 52 77 1024
mzvva 136 244 16
trv 52 6 33792
cvt 172 92 93
mvva 136 240 0
wl 3
mvva 136 32 32
trv 54 6 34304
mvva 136 36 48
mvva 140 36 52
trv 240 7 32768
cvt 173 94 95
mvva 140 32 36
buffer_store_dwordx4 v[168:171], v248, s[60:63], s69 offen offset:0 sc1
mvva 144 32 40
s_add_u32 m0, s65, 65536
trv 242 7 33280
mvva 144 36 56
dma 250 52 88 0
mvva 148 36 60
trv 244 7 33792
mvva 148 32 44
mvva 132 40 44
trv 246 7 34304
mvva 132 44 60
mvva 128 44 56
trv 32 7 40960
mvva 128 40 40
dma 251 52 88 1024
mvva 124 40 36
trv 34 7 41472
cvt 175 110 111
mvva 124 44 52
mvva 120 44 48
trv 36 7 41984
mvva 120 40 32
wl 3
mvva 120 48 64
trv 38 7 42496
mvva 120 52 80
s_add_u32 m0, s65, 73728
mvva 124 52 84
trv 40 6 40960
mvva 124 48 68
dma 250 52 89 0
mvva 128 48 72
trv 42 6 41472
cvt 174 108 109
mvva 128 52 88
mvva 132 52 92
trv 44 6 41984
mvva 132 48 76
cvt 176 96 97
mvva 148 240 76
trv 46 6 42496
mvva 148 244 92
dma 251 52 89 1024
mvva 144 244 88
trv 48 10 0
mvva 144 240 72
mvva 140 240 68
trv 50 10 512
cvt 177 98 99
mvva 140 244 84
buffer_store_dwordx4 v[172:175], v248, s[60:63], s69 offen offset:1024 sc1
mvva 136 244 80
trv 52 10 1024
mvva 136 240 64
wl 3
mvva 136 32 96
trv 54 10 1536
mvva 136 36 112
s_waitcnt vmcnt(12)
s_barrier
mvva 140 36 116
s_add_u32 m0, s65, 0
trv 240 11 0
mvva 140 32 100
dma 250 52 90 0
mvva 144 32 104
trv 242 11 512
v_add_u32 v253, 1, v253
mvva 144 36 120
buffer_store_dword v253, v252, s[40:43], 0 offen sc1
mvva 148 36 124
trv 244 11 1024
cvt 179 114 115
mvva 148 32 108
mvva 132 40 108
trv 246 11 1536
mvva 132 44 124
mvva 128 44 120
trv 32 11 8192
mvva 128 40 104
dma 251 52 90 1024
mvva 124 40 100
trv 34 11 8704
mvva 124 44 116
cvt 178 112 113
mvva 120 44 112
trv 36 11 9216
mvva 120 40 96
wl 3
mvva 120 48 128
trv 38 11 9728
mvva 120 52 144
cvt 180 100 101
mvva 124 52 148
trv 40 10 8192
s_add_u32 m0, s65, 8192
mvva 124 48 132
dma 250 52 91 0
mvva 128 48 136
trv 42 10 8704
mvva 128 52 152
cvt 181 102 103
mvva 132 52 156
buffer_store_dwordx4 v[176:179], v248, s[60:63], s69 offen offset:2048 sc1
mvva 132 48 140
trv 44 10 9216
mvva 148 240 140
trv 46 10 9728
mvva 148 244 156
mvva 144 244 152
trv 48 8 49152
mvva 144 240 136
dma 251 52 91 1024
mvva 140 240 132
trv 50 8 49664
mvva 140 244 148
mvva 136 244 144
trv 52 8 50176
cvt 183 118 119
mvva 136 240 128
wl 3
mvva 136 32 160
trv 54 8 50688
mvva 136 36 176
mvva 140 36 180
trv 240 9 49152
mvva 140 32 164
mvva 144 32 168
trv 242 9 49664
s_add_u32 m0, s65, 16384
mvva 144 36 184
dma 250 52 96 0
mvva 148 36 188
trv 244 9 50176
cvt 182 116 117
mvva 148 32 172
mvva 132 40 172
trv 246 9 50688
mvva 132 44 188
mvva 128 44 184
trv 32 9 57344
mvva 128 40 168
mvva 124 40 164
trv 34 9 57856
mvva 124 44 180
dma 251 52 96 1024
mvva 120 44 176
trv 36 9 58368
mvva 120 40 160
wl 3
mvva 120 48 192
buffer_store_dwordx4 v[180:183], v248, s[60:63], s69 offen offset:3072 sc1
mvva 120 52 208
trv 38 9 58880
mvva 124 52 212
buffer_load_dword v18, v12, s[40:43], 0 offen sc1
mvva 124 48 196
trv 40 8 57344
mvva 128 48 200
trv 42 8 57856
mvva 128 52 216
mvva 132 52 220
trv 44 8 58368
s_add_u32 m0, s65, 24576
mvva 132 48 204
dma 250 52 97 0
s_add_u32 s69, s69, 16384
mvva 148 240 204
trv 46 8 58880
mvva 148 244 220
mvva 144 244 216
trv 48 8 32768
mvva 144 240 200
mvva 140 240 196
trv 50 8 33280
mvva 140 244 212
mvva 136 244 208
trv 52 8 33792
mvva 136 240 192
dma 251 52 97 1024
wl 3
mvva 136 32 224
trv 54 8 34304
mvva 136 36 240
mvva 140 36 244
trv 240 9 32768
mvva 140 32 228
mvva 144 32 232
trv 242 9 33280
mvva 144 36 248
mvva 148 36 252
trv 244 9 33792
mvva 148 32 236
mvva 132 40 236
trv 246 9 34304
mvva 132 44 252
s_waitcnt vmcnt(13)
s_barrier
mvva 128 44 248
s_add_u32 s52, s52, 128
s_addc_u32 s53, s53, 0
mvva 128 40 232
s_sub_u32 s54, s54, 128
s_add_u32 m0, s65, 81920
mvva 124 40 228
trv 32 9 40960
mvva 124 44 244
buffer_load_dwordx4 v250, s[52:55], 0 offen lds
mvva 120 44 240
trv 34 9 41472
mvva 120 40 224
trv 36 9 41984
wl 3
mvvv 120 48 56
trv 38 9 42496
mvvv 120 52 72
buffer_load_dwordx4 v251, s[52:55], 0 offen offset:1024 lds
mvvv 124 52 76
trv 40 8 40960
mvvv 124 48 60
mvvv 128 48 64
trv 42 8 41472
mvvv 128 52 80
mvvv 132 52 84
trv 44 8 41984
mvvv 132 48 68
s_add_u32 m0, s65, 90112
mvvv 148 240 68
trv 46 8 42496
mvvv 148 244 84
dma 250 52 76 0
mvvv 144 244 80
trv 48 6 49152
mvvv 144 240 64
mvvv 140 240 60
trv 50 6 49664
mvvv 140 244 76
mvvv 136 244 72
trv 52 6 50176
mvvv 136 240 56
wl 3
s_sub_u32 s68, s68, 1
s_cbranch_scc0 L_ffn_d
cvt 152 120 121
cvt 153 122 123
s_nop 2
cvt 154 136 137
cvt 155 138 139
buffer_store_dwordx4 v[152:155], v248, s[60:63], s69 offen offset:0 sc1
cvt 156 124 125
cvt 157 126 127
cvt 158 140 141
cvt 159 142 143
buffer_store_dwordx4 v[156:159], v248, s[60:63], s69 offen offset:1024 sc1
cvt 160 128 129
cvt 161 130 131
cvt 162 144 145
cvt 163 146 147
buffer_store_dwordx4 v[160:163], v248, s[60:63], s69 offen offset:2048 sc1
cvt 164 132 133
cvt 165 134 135
cvt 166 148 149
cvt 167 150 151
buffer_store_dwordx4 v[164:167], v248, s[60:63], s69 offen offset:3072 sc1
s_add_u32 s69, s69, 16384
s_mov_b32 s68, 0x40000
s_waitcnt vmcnt(9)
L_val:
v_cmp_gt_u32 vcc, 16, v17
s_nop 1
s_cbranch_vccz L_valid
buffer_load_dword v17, v13, s[92:95], 0 offen sc1
s_waitcnt vmcnt(0)
buffer_load_dword v18, v12, s[40:43], 0 offen sc1
s_waitcnt vmcnt(0)
s_sub_u32 s68, s68, 1
s_cbranch_scc0 L_val
s_mov_b32 s68, 0
L_valid:
L_spin0:
v_cmp_gt_u32 vcc, s3, v18
s_nop 0
s_and_b64 vcc, vcc, s[80:81]
s_cbranch_scc0 L_spun0
s_sleep 6
buffer_load_dword v18, v12, s[40:43], 0 offen sc1
s_waitcnt vmcnt(0)
s_sub_u32 s68, s68, 1
s_cbranch_scc0 L_spin0
s_mov_b32 s68, 0
L_spun0:
v_add_u32 v20, 0, v14
s_mov_b32 s82, 18874368
buffer_load_dwordx4 a[0:3], v20, s[48:51], s82 offen sc1
s_mov_b32 s82, 21233664
buffer_load_dwordx4 a[4:7], v20, s[48:51], s82 offen sc1
s_mov_b32 s82, 23592960
buffer_load_dwordx4 a[8:11], v20, s[48:51], s82 offen sc1
s_mov_b32 s82, 25952256
buffer_load_dwordx4 a[12:15], v20, s[48:51], s82 offen sc1
s_mov_b32 s82, 28311552
buffer_load_dwordx4 a[16:19], v20, s[48:51], s82 offen sc1
s_mov_b32 s82, 30670848
buffer_load_dwordx4 a[20:23], v20, s[48:51], s82 offen sc1
s_mov_b32 s82, 33030144
buffer_load_dwordx4 a[24:27], v20, s[48:51], s82 offen sc1
s_mov_b32 s82, 35389440
buffer_load_dwordx4 a[28:31], v20, s[48:51], s82 offen sc1
s_add_u32 s3, s3, 2
L_spin1:
v_cmp_gt_u32 vcc, s3, v18
s_nop 0
s_and_b64 vcc, vcc, s[80:81]
s_cbranch_scc0 L_spun1
s_sleep 6
buffer_load_dword v18, v12, s[40:43], 0 offen sc1
s_waitcnt vmcnt(0)
s_sub_u32 s68, s68, 1
s_cbranch_scc0 L_spin1
s_mov_b32 s68, 0
L_spun1:
v_add_u32 v20, 32768, v14
s_mov_b32 s82, 18874368
buffer_load_dwordx4 a[32:35], v20, s[48:51], s82 offen sc1
s_mov_b32 s82, 21233664
buffer_load_dwordx4 a[36:39], v20, s[48:51], s82 offen sc1
s_mov_b32 s82, 23592960
buffer_load_dwordx4 a[40:43], v20, s[48:51], s82 offen sc1
s_mov_b32 s82, 25952256
buffer_load_dwordx4 a[44:47], v20, s[48:51], s82 offen sc1
s_mov_b32 s82, 28311552
buffer_load_dwordx4 a[48:51], v20, s[48:51], s82 offen sc1
s_mov_b32 s82, 30670848
buffer_load_dwordx4 a[52:55], v20, s[48:51], s82 offen sc1
s_mov_b32 s82, 33030144
buffer_load_dwordx4 a[56:59], v20, s[48:51], s82 offen sc1
s_mov_b32 s82, 35389440
buffer_load_dwordx4 a[60:63], v20, s[48:51], s82 offen sc1
s_add_u32 s3, s3, 2
L_spin2:
v_cmp_gt_u32 vcc, s3, v18
s_nop 0
s_and_b64 vcc, vcc, s[80:81]
s_cbranch_scc0 L_spun2
s_sleep 6
buffer_load_dword v18, v12, s[40:43], 0 offen sc1
s_waitcnt vmcnt(0)
s_sub_u32 s68, s68, 1
s_cbranch_scc0 L_spin2
s_mov_b32 s68, 0
L_spun2:
v_add_u32 v20, 65536, v14
s_mov_b32 s82, 18874368
buffer_load_dwordx4 a[64:67], v20, s[48:51], s82 offen sc1
s_mov_b32 s82, 21233664
buffer_load_dwordx4 a[68:71], v20, s[48:51], s82 offen sc1
s_mov_b32 s82, 23592960
buffer_load_dwordx4 a[72:75], v20, s[48:51], s82 offen sc1
s_mov_b32 s82, 25952256
buffer_load_dwordx4 a[76:79], v20, s[48:51], s82 offen sc1
s_mov_b32 s82, 28311552
buffer_load_dwordx4 a[80:83], v20, s[48:51], s82 offen sc1
s_mov_b32 s82, 30670848
buffer_load_dwordx4 a[84:87], v20, s[48:51], s82 offen sc1
s_mov_b32 s82, 33030144
buffer_load_dwordx4 a[88:91], v20, s[48:51], s82 offen sc1
s_mov_b32 s82, 35389440
buffer_load_dwordx4 a[92:95], v20, s[48:51], s82 offen sc1
s_add_u32 s3, s3, 2
s_waitcnt vmcnt(24)
s_barrier
v_mov_b32 v253, 9
buffer_store_dword v253, v252, s[40:43], 0 offen sc1
buffer_load_dword v18, v12, s[40:43], 0 offen sc1
s_waitcnt vmcnt(18)
mzvva 32 234 0
mzvva 36 232 0
mvva 32 234 4
mvva 36 232 4
mvva 32 234 8
mvva 36 232 8
mvva 32 234 12
mvva 36 232 12
mvva 32 234 16
mvva 36 232 16
mvva 32 234 20
mvva 36 232 20
mvva 32 234 24
mvva 36 232 24
mvva 32 234 28
mvva 36 232 28
s_waitcnt vmcnt(10)
mzvva 40 234 32
s_nop 4
v_mul_f32 v238, 0xbfb8aa3b, v32
v_mul_f32 v239, 0xbfb8aa3b, v33
v_mul_f32 v240, 0xbfb8aa3b, v34
mzvva 44 232 32
v_mul_f32 v241, 0xbfb8aa3b, v35
v_mul_f32 v242, 0xbfb8aa3b, v36
mvva 40 234 36
v_mul_f32 v243, 0xbfb8aa3b, v37
v_mul_f32 v244, 0xbfb8aa3b, v38
v_mul_f32 v245, 0xbfb8aa3b, v39
mvva 44 232 36
exp 238 238
exp 239 239
mvva 40 234 40
exp 240 240
exp 241 241
exp 242 242
mvva 44 232 40
exp 243 243
exp 244 244
mvva 40 234 44
exp 245 245
v_add_f32 v238, 1.0, v238
v_add_f32 v239, 1.0, v239
mvva 44 232 44
v_add_f32 v240, 1.0, v240
v_add_f32 v241, 1.0, v241
mvva 40 234 48
v_add_f32 v242, 1.0, v242
v_add_f32 v243, 1.0, v243
v_add_f32 v244, 1.0, v244
mvva 44 232 48
v_add_f32 v245, 1.0, v245
rcp 238 238
mvva 40 234 52
rcp 239 239
rcp 240 240
rcp 241 241
mvva 44 232 52
rcp 242 242
rcp 243 243
mvva 40 234 56
rcp 244 244
rcp 245 245
mul 32 238 32
mvva 44 232 56
mul 33 239 33
mul 34 240 34
mvva 40 234 60
mul 35 241 35
mul 36 242 36
mul 37 243 37
mvva 44 232 60
mul 38 244 38
mul 39 245 39
s_waitcnt vmcnt(2)
wl 1
mzvva 48 234 64
v_mul_f32 v238, 0xbfb8aa3b, v40
v_mul_f32 v239, 0xbfb8aa3b, v41
v_mul_f32 v240, 0xbfb8aa3b, v42
wl 0
mzvva 52 232 64
v_mul_f32 v241, 0xbfb8aa3b, v43
v_mul_f32 v242, 0xbfb8aa3b, v44
mvva 48 234 68
v_mul_f32 v243, 0xbfb8aa3b, v45
v_mul_f32 v244, 0xbfb8aa3b, v46
v_mul_f32 v245, 0xbfb8aa3b, v47
mvva 52 232 68
exp 238 238
exp 239 239
mvva 48 234 72
exp 240 240
exp 241 241
exp 242 242
mvva 52 232 72
exp 243 243
exp 244 244
mvva 48 234 76
exp 245 245
v_add_f32 v238, 1.0, v238
v_add_f32 v239, 1.0, v239
mvva 52 232 76
v_add_f32 v240, 1.0, v240
v_add_f32 v241, 1.0, v241
mvva 48 234 80
v_add_f32 v242, 1.0, v242
v_add_f32 v243, 1.0, v243
v_add_f32 v244, 1.0, v244
mvva 52 232 80
v_add_f32 v245, 1.0, v245
rcp 238 238
mvva 48 234 84
rcp 239 239
rcp 240 240
rcp 241 241
mvva 52 232 84
rcp 242 242
rcp 243 243
mvva 48 234 88
rcp 244 244
rcp 245 245
mul 40 238 40
mvva 52 232 88
mul 41 239 41
mul 42 240 42
mvva 48 234 92
mul 43 241 43
mul 44 242 44
mul 45 243 45
mvva 52 232 92
mul 46 244 46
mul 47 245 47
s_nop 1
v_mul_f32 v238, 0xbfb8aa3b, v48
v_mul_f32 v239, 0xbfb8aa3b, v49
v_mul_f32 v240, 0xbfb8aa3b, v50
v_mul_f32 v241, 0xbfb8aa3b, v51
v_mul_f32 v242, 0xbfb8aa3b, v52
v_mul_f32 v243, 0xbfb8aa3b, v53
v_mul_f32 v244, 0xbfb8aa3b, v54
v_mul_f32 v245, 0xbfb8aa3b, v55
exp 238 238
exp 239 239
exp 240 240
exp 241 241
exp 242 242
exp 243 243
exp 244 244
exp 245 245
v_add_f32 v238, 1.0, v238
v_add_f32 v239, 1.0, v239
v_add_f32 v240, 1.0, v240
v_add_f32 v241, 1.0, v241
v_add_f32 v242, 1.0, v242
v_add_f32 v243, 1.0, v243
v_add_f32 v244, 1.0, v244
v_add_f32 v245, 1.0, v245
rcp 238 238
rcp 239 239
rcp 240 240
rcp 241 241
rcp 242 242
rcp 243 243
rcp 244 244
rcp 245 245
mul 48 238 48
mul 49 239 49
mul 50 240 50
mul 51 241 51
mul 52 242 52
mul 53 243 53
mul 54 244 54
mul 55 245 55
s_waitcnt vmcnt(0)
s_cmp_gt_u32 s85, 0
s_cbranch_scc1 L_sa0
L_spin3:
v_cmp_gt_u32 vcc, s84, v18
s_nop 0
s_and_b64 vcc, vcc, s[78:79]
s_cbranch_scc1 L_sa_end
v_add_u32 v20, 0, v14
s_mov_b32 s82, 0
buffer_load_dwordx4 v[72:75], v20, s[48:51], s82 offen sc1
L_pgf15:
s_cbranch_execz L_pgf_back
s_mov_b32 s82, 2359296
buffer_load_dwordx4 v[76:79], v20, s[48:51], s82 offen sc1
s_mov_b32 s82, 4718592
buffer_load_dwordx4 v[80:83], v20, s[48:51], s82 offen sc1
s_mov_b32 s82, 7077888
buffer_load_dwordx4 v[84:87], v20, s[48:51], s82 offen sc1
s_mov_b32 s82, 9437184
buffer_load_dwordx4 v[88:91], v20, s[48:51], s82 offen sc1
s_mov_b32 s82, 11796480
buffer_load_dwordx4 v[92:95], v20, s[48:51], s82 offen sc1
s_mov_b32 s82, 14155776
buffer_load_dwordx4 v[96:99], v20, s[48:51], s82 offen sc1
s_mov_b32 s82, 16515072
buffer_load_dwordx4 v[100:103], v20, s[48:51], s82 offen sc1
s_add_u32 s84, s84, 2
s_add_u32 s85, s85, 1
L_sa0:
s_cmp_gt_u32 s85, 1
s_cbranch_scc1 L_sa1
L_spin4:
v_cmp_gt_u32 vcc, s84, v18
s_nop 0
s_and_b64 vcc, vcc, s[78:79]
s_cbranch_scc1 L_sa_end
v_add_u32 v20, 32768, v14
s_mov_b32 s82, 0
buffer_load_dwordx4 v[104:107], v20, s[48:51], s82 offen sc1
s_mov_b32 s82, 2359296
buffer_load_dwordx4 v[108:111], v20, s[48:51], s82 offen sc1
s_mov_b32 s82, 4718592
buffer_load_dwordx4 v[112:115], v20, s[48:51], s82 offen sc1
s_mov_b32 s82, 7077888
buffer_load_dwordx4 v[116:119], v20, s[48:51], s82 offen sc1
s_mov_b32 s82, 9437184
buffer_load_dwordx4 v[120:123], v20, s[48:51], s82 offen sc1
s_mov_b32 s82, 11796480
buffer_load_dwordx4 v[124:127], v20, s[48:51], s82 offen sc1
s_mov_b32 s82, 14155776
buffer_load_dwordx4 v[128:131], v20, s[48:51], s82 offen sc1
s_mov_b32 s82, 16515072
buffer_load_dwordx4 v[132:135], v20, s[48:51], s82 offen sc1
s_add_u32 s84, s84, 2
s_add_u32 s85, s85, 1
L_sa1:
s_cmp_gt_u32 s85, 2
s_cbranch_scc1 L_sa2
L_spin5:
v_cmp_gt_u32 vcc, s84, v18
s_nop 0
s_and_b64 vcc, vcc, s[78:79]
s_cbranch_scc1 L_sa_end
v_add_u32 v20, 65536, v14
s_mov_b32 s82, 0
buffer_load_dwordx4 v[136:139], v20, s[48:51], s82 offen sc1
s_mov_b32 s82, 2359296
buffer_load_dwordx4 v[140:143], v20, s[48:51], s82 offen sc1
s_mov_b32 s82, 4718592
buffer_load_dwordx4 v[144:147], v20, s[48:51], s82 offen sc1
s_mov_b32 s82, 7077888
buffer_load_dwordx4 v[148:151], v20, s[48:51], s82 offen sc1
s_mov_b32 s82, 9437184
buffer_load_dwordx4 v[152:155], v20, s[48:51], s82 offen sc1
s_mov_b32 s82, 11796480
buffer_load_dwordx4 v[156:159], v20, s[48:51], s82 offen sc1
s_mov_b32 s82, 14155776
buffer_load_dwordx4 v[160:163], v20, s[48:51], s82 offen sc1
s_mov_b32 s82, 16515072
buffer_load_dwordx4 v[164:167], v20, s[48:51], s82 offen sc1
s_add_u32 s84, s84, 2
s_add_u32 s85, s85, 1
L_sa2:
s_cmp_gt_u32 s85, 3
s_cbranch_scc1 L_sa3
L_spin6:
v_cmp_gt_u32 vcc, s84, v18
s_nop 0
s_and_b64 vcc, vcc, s[78:79]
s_cbranch_scc1 L_sa_end
v_add_u32 v20, 98304, v14
s_mov_b32 s82, 0
buffer_load_dwordx4 a[160:163], v20, s[48:51], s82 offen sc1
s_mov_b32 s82, 2359296
buffer_load_dwordx4 a[164:167], v20, s[48:51], s82 offen sc1
s_mov_b32 s82, 4718592
buffer_load_dwordx4 a[168:171], v20, s[48:51], s82 offen sc1
s_mov_b32 s82, 7077888
buffer_load_dwordx4 a[172:175], v20, s[48:51], s82 offen sc1
s_mov_b32 s82, 9437184
buffer_load_dwordx4 a[176:179], v20, s[48:51], s82 offen sc1
s_mov_b32 s82, 11796480
buffer_load_dwordx4 a[180:183], v20, s[48:51], s82 offen sc1
s_mov_b32 s82, 14155776
buffer_load_dwordx4 a[184:187], v20, s[48:51], s82 offen sc1
s_mov_b32 s82, 16515072
buffer_load_dwordx4 a[188:191], v20, s[48:51], s82 offen sc1
s_add_u32 s84, s84, 2
s_add_u32 s85, s85, 1
L_sa3:
L_sa_end:
s_min_u32 s83, s85, 3
L_spin7:
v_cmp_gt_u32 vcc, s3, v18
s_nop 0
s_and_b64 vcc, vcc, s[80:81]
s_cbranch_scc0 L_spun7
s_sleep 6
buffer_load_dword v18, v12, s[40:43], 0 offen sc1
s_waitcnt vmcnt(0)
s_sub_u32 s68, s68, 1
s_cbranch_scc0 L_spin7
s_mov_b32 s68, 0
L_spun7:
v_add_u32 v20, 98304, v14
s_mov_b32 s82, 18874368
buffer_load_dwordx4 a[96:99], v20, s[48:51], s82 offen sc1
s_mov_b32 s82, 21233664
buffer_load_dwordx4 a[100:103], v20, s[48:51], s82 offen sc1
s_mov_b32 s82, 23592960
buffer_load_dwordx4 a[104:107], v20, s[48:51], s82 offen sc1
s_mov_b32 s82, 25952256
buffer_load_dwordx4 a[108:111], v20, s[48:51], s82 offen sc1
s_mov_b32 s82, 28311552
buffer_load_dwordx4 a[112:115], v20, s[48:51], s82 offen sc1
s_mov_b32 s82, 30670848
buffer_load_dwordx4 a[116:119], v20, s[48:51], s82 offen sc1
s_mov_b32 s82, 33030144
buffer_load_dwordx4 a[120:123], v20, s[48:51], s82 offen sc1
s_mov_b32 s82, 35389440
buffer_load_dwordx4 a[124:127], v20, s[48:51], s82 offen sc1
s_add_u32 s3, s3, 2
s_min_u32 s3, s3, 9
L_spin8:
v_cmp_gt_u32 vcc, s3, v18
s_nop 0
s_and_b64 vcc, vcc, s[80:81]
s_cbranch_scc0 L_spun8
s_sleep 6
buffer_load_dword v18, v12, s[40:43], 0 offen sc1
s_waitcnt vmcnt(0)
s_sub_u32 s68, s68, 1
s_cbranch_scc0 L_spin8
s_mov_b32 s68, 0
L_spun8:
v_add_u32 v20, 131072, v14
s_mov_b32 s82, 18874368
buffer_load_dwordx4 a[128:131], v20, s[48:51], s82 offen sc1
s_mov_b32 s82, 21233664
buffer_load_dwordx4 a[132:135], v20, s[48:51], s82 offen sc1
s_mov_b32 s82, 23592960
buffer_load_dwordx4 a[136:139], v20, s[48:51], s82 offen sc1
s_mov_b32 s82, 25952256
buffer_load_dwordx4 a[140:143], v20, s[48:51], s82 offen sc1
s_mov_b32 s82, 28311552
buffer_load_dwordx4 a[144:147], v20, s[48:51], s82 offen sc1
s_mov_b32 s82, 30670848
buffer_load_dwordx4 a[148:151], v20, s[48:51], s82 offen sc1
s_mov_b32 s82, 33030144
buffer_load_dwordx4 a[152:155], v20, s[48:51], s82 offen sc1
s_mov_b32 s82, 35389440
buffer_load_dwordx4 a[156:159], v20, s[48:51], s82 offen sc1
s_add_u32 s3, s3, 2
buffer_load_dword v18, v12, s[40:43], 0 offen sc1
s_waitcnt vmcnt(17)
s_cmp_le_u32 s83, 0
s_cbranch_scc1 L_ef
mzvvv 246 234 216
mzvvv 250 232 216
mzvvv 238 234 72
mzvvv 242 232 72
mvvv 238 234 76
mvvv 242 232 76
mvvv 238 234 80
mvvv 242 232 80
mvvv 238 234 84
mvvv 242 232 84
mvvv 238 234 88
mvvv 242 232 88
mvvv 238 234 92
mvvv 242 232 92
mvvv 238 234 96
mvvv 242 232 96
mvvv 238 234 100
mvvv 242 232 100
s_nop 6
v_fmac_f32 v246, v238, v32
v_fmac_f32 v247, v239, v33
v_fmac_f32 v248, v240, v34
v_fmac_f32 v249, v241, v35
v_fmac_f32 v250, v242, v36
v_fmac_f32 v251, v243, v37
v_fmac_f32 v252, v244, v38
v_fmac_f32 v253, v245, v39
cvt 216 246 247
cvt 217 248 249
cvt 218 250 251
cvt 219 252 253
s_nop 0
v_permlane32_swap_b32 v216, v218
v_permlane32_swap_b32 v217, v219
s_nop 0
v_permlane16_swap_b32 v216, v218
v_permlane16_swap_b32 v217, v219
buffer_store_dwordx4 v[216:219], v16, s[56:59], 0 offen offset:0 nt
s_cmp_le_u32 s83, 1
s_cbranch_scc1 L_ef
mzvvv 246 234 220
mzvvv 250 232 220
mzvvv 238 234 104
mzvvv 242 232 104
mvvv 238 234 108
mvvv 242 232 108
mvvv 238 234 112
mvvv 242 232 112
mvvv 238 234 116
mvvv 242 232 116
mvvv 238 234 120
mvvv 242 232 120
mvvv 238 234 124
mvvv 242 232 124
mvvv 238 234 128
mvvv 242 232 128
mvvv 238 234 132
mvvv 242 232 132
s_nop 6
v_fmac_f32 v246, v238, v40
v_fmac_f32 v247, v239, v41
v_fmac_f32 v248, v240, v42
v_fmac_f32 v249, v241, v43
v_fmac_f32 v250, v242, v44
v_fmac_f32 v251, v243, v45
v_fmac_f32 v252, v244, v46
v_fmac_f32 v253, v245, v47
cvt 220 246 247
cvt 221 248 249
cvt 222 250 251
cvt 223 252 253
s_nop 0
v_permlane32_swap_b32 v220, v222
v_permlane32_swap_b32 v221, v223
s_nop 0
v_permlane16_swap_b32 v220, v222
v_permlane16_swap_b32 v221, v223
buffer_store_dwordx4 v[220:223], v16, s[56:59], 0 offen offset:256 nt
s_cmp_le_u32 s83, 2
s_cbranch_scc1 L_ef
mzvvv 246 234 224
mzvvv 250 232 224
mzvvv 238 234 136
mzvvv 242 232 136
mvvv 238 234 140
mvvv 242 232 140
mvvv 238 234 144
mvvv 242 232 144
mvvv 238 234 148
mvvv 242 232 148
mvvv 238 234 152
mvvv 242 232 152
mvvv 238 234 156
mvvv 242 232 156
mvvv 238 234 160
mvvv 242 232 160
mvvv 238 234 164
mvvv 242 232 164
s_nop 6
v_fmac_f32 v246, v238, v48
v_fmac_f32 v247, v239, v49
v_fmac_f32 v248, v240, v50
v_fmac_f32 v249, v241, v51
v_fmac_f32 v250, v242, v52
v_fmac_f32 v251, v243, v53
v_fmac_f32 v252, v244, v54
v_fmac_f32 v253, v245, v55
cvt 224 246 247
cvt 225 248 249
cvt 226 250 251
cvt 227 252 253
s_nop 0
v_permlane32_swap_b32 v224, v226
v_permlane32_swap_b32 v225, v227
s_nop 0
v_permlane16_swap_b32 v224, v226
v_permlane16_swap_b32 v225, v227
buffer_store_dwordx4 v[224:227], v16, s[56:59], 0 offen offset:512 nt
L_ef:
s_waitcnt vmcnt(9)
mzvva 56 234 96
mzvva 60 232 96
mvva 56 234 100
mvva 60 232 100
mvva 56 234 104
mvva 60 232 104
mvva 56 234 108
mvva 60 232 108
mvva 56 234 112
mvva 60 232 112
mvva 56 234 116
mvva 60 232 116
mvva 56 234 120
mvva 60 232 120
mvva 56 234 124
mvva 60 232 124
s_waitcnt vmcnt(1)
mzvva 64 234 128
s_nop 4
v_mul_f32 v238, 0xbfb8aa3b, v56
v_mul_f32 v239, 0xbfb8aa3b, v57
v_mul_f32 v240, 0xbfb8aa3b, v58
mzvva 68 232 128
v_mul_f32 v241, 0xbfb8aa3b, v59
v_mul_f32 v242, 0xbfb8aa3b, v60
mvva 64 234 132
v_mul_f32 v243, 0xbfb8aa3b, v61
v_mul_f32 v244, 0xbfb8aa3b, v62
v_mul_f32 v245, 0xbfb8aa3b, v63
mvva 68 232 132
exp 238 238
exp 239 239
mvva 64 234 136
exp 240 240
exp 241 241
exp 242 242
mvva 68 232 136
exp 243 243
exp 244 244
mvva 64 234 140
exp 245 245
v_add_f32 v238, 1.0, v238
v_add_f32 v239, 1.0, v239
mvva 68 232 140
v_add_f32 v240, 1.0, v240
v_add_f32 v241, 1.0, v241
mvva 64 234 144
v_add_f32 v242, 1.0, v242
v_add_f32 v243, 1.0, v243
v_add_f32 v244, 1.0, v244
mvva 68 232 144
v_add_f32 v245, 1.0, v245
rcp 238 238
mvva 64 234 148
rcp 239 239
rcp 240 240
rcp 241 241
mvva 68 232 148
rcp 242 242
rcp 243 243
mvva 64 234 152
rcp 244 244
rcp 245 245
mul 56 238 56
mvva 68 232 152
mul 57 239 57
mul 58 240 58
mvva 64 234 156
mul 59 241 59
mul 60 242 60
mul 61 243 61
mvva 68 232 156
mul 62 244 62
mul 63 245 63
s_nop 1
v_mul_f32 v238, 0xbfb8aa3b, v64
v_mul_f32 v239, 0xbfb8aa3b, v65
v_mul_f32 v240, 0xbfb8aa3b, v66
v_mul_f32 v241, 0xbfb8aa3b, v67
v_mul_f32 v242, 0xbfb8aa3b, v68
v_mul_f32 v243, 0xbfb8aa3b, v69
v_mul_f32 v244, 0xbfb8aa3b, v70
v_mul_f32 v245, 0xbfb8aa3b, v71
exp 238 238
exp 239 239
exp 240 240
exp 241 241
exp 242 242
exp 243 243
exp 244 244
exp 245 245
v_add_f32 v238, 1.0, v238
v_add_f32 v239, 1.0, v239
v_add_f32 v240, 1.0, v240
v_add_f32 v241, 1.0, v241
v_add_f32 v242, 1.0, v242
v_add_f32 v243, 1.0, v243
v_add_f32 v244, 1.0, v244
v_add_f32 v245, 1.0, v245
rcp 238 238
rcp 239 239
rcp 240 240
rcp 241 241
rcp 242 242
rcp 243 243
rcp 244 244
rcp 245 245
mul 64 238 64
mul 65 239 65
mul 66 240 66
mul 67 241 67
mul 68 242 68
mul 69 243 69
mul 70 244 70
mul 71 245 71
s_waitcnt vmcnt(0)
s_cmp_gt_u32 s85, 0
s_cbranch_scc1 L_sb0
L_spin9:
v_cmp_gt_u32 vcc, s84, v18
s_nop 0
s_and_b64 vcc, vcc, s[78:79]
s_cbranch_scc1 L_sb_end
v_add_u32 v20, 0, v14
s_mov_b32 s82, 0
buffer_load_dwordx4 v[72:75], v20, s[48:51], s82 offen sc1
s_mov_b32 s82, 2359296
buffer_load_dwordx4 v[76:79], v20, s[48:51], s82 offen sc1
s_mov_b32 s82, 4718592
buffer_load_dwordx4 v[80:83], v20, s[48:51], s82 offen sc1
s_mov_b32 s82, 7077888
buffer_load_dwordx4 v[84:87], v20, s[48:51], s82 offen sc1
s_mov_b32 s82, 9437184
buffer_load_dwordx4 v[88:91], v20, s[48:51], s82 offen sc1
s_mov_b32 s82, 11796480
buffer_load_dwordx4 v[92:95], v20, s[48:51], s82 offen sc1
s_mov_b32 s82, 14155776
buffer_load_dwordx4 v[96:99], v20, s[48:51], s82 offen sc1
s_mov_b32 s82, 16515072
buffer_load_dwordx4 v[100:103], v20, s[48:51], s82 offen sc1
s_add_u32 s84, s84, 2
s_add_u32 s85, s85, 1
L_sb0:
s_cmp_gt_u32 s85, 1
s_cbranch_scc1 L_sb1
L_spin10:
v_cmp_gt_u32 vcc, s84, v18
s_nop 0
s_and_b64 vcc, vcc, s[78:79]
s_cbranch_scc1 L_sb_end
v_add_u32 v20, 32768, v14
s_mov_b32 s82, 0
buffer_load_dwordx4 v[104:107], v20, s[48:51], s82 offen sc1
s_mov_b32 s82, 2359296
buffer_load_dwordx4 v[108:111], v20, s[48:51], s82 offen sc1
s_mov_b32 s82, 4718592
buffer_load_dwordx4 v[112:115], v20, s[48:51], s82 offen sc1
s_mov_b32 s82, 7077888
buffer_load_dwordx4 v[116:119], v20, s[48:51], s82 offen sc1
s_mov_b32 s82, 9437184
buffer_load_dwordx4 v[120:123], v20, s[48:51], s82 offen sc1
s_mov_b32 s82, 11796480
buffer_load_dwordx4 v[124:127], v20, s[48:51], s82 offen sc1
s_mov_b32 s82, 14155776
buffer_load_dwordx4 v[128:131], v20, s[48:51], s82 offen sc1
s_mov_b32 s82, 16515072
buffer_load_dwordx4 v[132:135], v20, s[48:51], s82 offen sc1
s_add_u32 s84, s84, 2
s_add_u32 s85, s85, 1
L_sb1:
s_cmp_gt_u32 s85, 2
s_cbranch_scc1 L_sb2
L_spin11:
v_cmp_gt_u32 vcc, s84, v18
s_nop 0
s_and_b64 vcc, vcc, s[78:79]
s_cbranch_scc1 L_sb_end
v_add_u32 v20, 65536, v14
s_mov_b32 s82, 0
buffer_load_dwordx4 v[136:139], v20, s[48:51], s82 offen sc1
s_mov_b32 s82, 2359296
buffer_load_dwordx4 v[140:143], v20, s[48:51], s82 offen sc1
s_mov_b32 s82, 4718592
buffer_load_dwordx4 v[144:147], v20, s[48:51], s82 offen sc1
s_mov_b32 s82, 7077888
buffer_load_dwordx4 v[148:151], v20, s[48:51], s82 offen sc1
s_mov_b32 s82, 9437184
buffer_load_dwordx4 v[152:155], v20, s[48:51], s82 offen sc1
s_mov_b32 s82, 11796480
buffer_load_dwordx4 v[156:159], v20, s[48:51], s82 offen sc1
s_mov_b32 s82, 14155776
buffer_load_dwordx4 v[160:163], v20, s[48:51], s82 offen sc1
s_mov_b32 s82, 16515072
buffer_load_dwordx4 v[164:167], v20, s[48:51], s82 offen sc1
s_add_u32 s84, s84, 2
s_add_u32 s85, s85, 1
L_sb2:
s_cmp_gt_u32 s85, 3
s_cbranch_scc1 L_sb3
L_spin12:
v_cmp_gt_u32 vcc, s84, v18
s_nop 0
s_and_b64 vcc, vcc, s[78:79]
s_cbranch_scc1 L_sb_end
v_add_u32 v20, 98304, v14
s_mov_b32 s82, 0
buffer_load_dwordx4 a[160:163], v20, s[48:51], s82 offen sc1
s_mov_b32 s82, 2359296
buffer_load_dwordx4 a[164:167], v20, s[48:51], s82 offen sc1
s_mov_b32 s82, 4718592
buffer_load_dwordx4 a[168:171], v20, s[48:51], s82 offen sc1
s_mov_b32 s82, 7077888
buffer_load_dwordx4 a[172:175], v20, s[48:51], s82 offen sc1
s_mov_b32 s82, 9437184
buffer_load_dwordx4 a[176:179], v20, s[48:51], s82 offen sc1
s_mov_b32 s82, 11796480
buffer_load_dwordx4 a[180:183], v20, s[48:51], s82 offen sc1
s_mov_b32 s82, 14155776
buffer_load_dwordx4 a[184:187], v20, s[48:51], s82 offen sc1
s_mov_b32 s82, 16515072
buffer_load_dwordx4 a[188:191], v20, s[48:51], s82 offen sc1
s_add_u32 s84, s84, 2
s_add_u32 s85, s85, 1
L_sb3:
L_sb_end:
buffer_load_dword v18, v12, s[40:43], 0 offen sc1
s_cmp_gt_u32 s85, 0
s_cbranch_scc1 L_have0
s_waitcnt vmcnt(0)
L_spin13:
v_cmp_gt_u32 vcc, s84, v18
s_nop 0
s_and_b64 vcc, vcc, s[78:79]
s_cbranch_scc0 L_spun13
s_sleep 6
buffer_load_dword v18, v12, s[40:43], 0 offen sc1
s_waitcnt vmcnt(0)
s_sub_u32 s68, s68, 1
s_cbranch_scc0 L_spin13
s_mov_b32 s68, 0
L_spun13:
v_add_u32 v20, 0, v14
s_mov_b32 s82, 0
buffer_load_dwordx4 v[72:75], v20, s[48:51], s82 offen sc1
s_mov_b32 s82, 2359296
buffer_load_dwordx4 v[76:79], v20, s[48:51], s82 offen sc1
s_mov_b32 s82, 4718592
buffer_load_dwordx4 v[80:83], v20, s[48:51], s82 offen sc1
s_mov_b32 s82, 7077888
buffer_load_dwordx4 v[84:87], v20, s[48:51], s82 offen sc1
s_mov_b32 s82, 9437184
buffer_load_dwordx4 v[88:91], v20, s[48:51], s82 offen sc1
s_mov_b32 s82, 11796480
buffer_load_dwordx4 v[92:95], v20, s[48:51], s82 offen sc1
s_mov_b32 s82, 14155776
buffer_load_dwordx4 v[96:99], v20, s[48:51], s82 offen sc1
s_mov_b32 s82, 16515072
buffer_load_dwordx4 v[100:103], v20, s[48:51], s82 offen sc1
s_add_u32 s84, s84, 2
L_have0:
s_cmp_gt_u32 s85, 1
s_cbranch_scc1 L_have1
s_waitcnt vmcnt(0)
L_spin14:
v_cmp_gt_u32 vcc, s84, v18
s_nop 0
s_and_b64 vcc, vcc, s[78:79]
s_cbranch_scc0 L_spun14
s_sleep 6
buffer_load_dword v18, v12, s[40:43], 0 offen sc1
s_waitcnt vmcnt(0)
s_sub_u32 s68, s68, 1
s_cbranch_scc0 L_spin14
s_mov_b32 s68, 0
L_spun14:
v_add_u32 v20, 32768, v14
s_mov_b32 s82, 0
buffer_load_dwordx4 v[104:107], v20, s[48:51], s82 offen sc1
s_mov_b32 s82, 2359296
buffer_load_dwordx4 v[108:111], v20, s[48:51], s82 offen sc1
s_mov_b32 s82, 4718592
buffer_load_dwordx4 v[112:115], v20, s[48:51], s82 offen sc1
s_mov_b32 s82, 7077888
buffer_load_dwordx4 v[116:119], v20, s[48:51], s82 offen sc1
s_mov_b32 s82, 9437184
buffer_load_dwordx4 v[120:123], v20, s[48:51], s82 offen sc1
s_mov_b32 s82, 11796480
buffer_load_dwordx4 v[124:127], v20, s[48:51], s82 offen sc1
s_mov_b32 s82, 14155776
buffer_load_dwordx4 v[128:131], v20, s[48:51], s82 offen sc1
s_mov_b32 s82, 16515072
buffer_load_dwordx4 v[132:135], v20, s[48:51], s82 offen sc1
s_add_u32 s84, s84, 2
L_have1:
s_cmp_gt_u32 s83, 0
s_cbranch_scc1 L_done1
s_cmp_gt_u32 s85, 1
s_cbranch_scc1 L_wa15
s_waitcnt vmcnt(8)
s_branch L_wb15
L_wa15:
s_waitcnt vmcnt(0)
L_wb15:
mzvvv 246 234 216
mzvvv 250 232 216
mzvvv 238 234 72
mzvvv 242 232 72
mvvv 238 234 76
mvvv 242 232 76
mvvv 238 234 80
mvvv 242 232 80
mvvv 238 234 84
mvvv 242 232 84
mvvv 238 234 88
mvvv 242 232 88
mvvv 238 234 92
mvvv 242 232 92
mvvv 238 234 96
mvvv 242 232 96
mvvv 238 234 100
mvvv 242 232 100
s_nop 6
v_fmac_f32 v246, v238, v32
v_fmac_f32 v247, v239, v33
v_fmac_f32 v248, v240, v34
v_fmac_f32 v249, v241, v35
v_fmac_f32 v250, v242, v36
v_fmac_f32 v251, v243, v37
v_fmac_f32 v252, v244, v38
v_fmac_f32 v253, v245, v39
cvt 216 246 247
cvt 217 248 249
cvt 218 250 251
cvt 219 252 253
s_nop 0
v_permlane32_swap_b32 v216, v218
v_permlane32_swap_b32 v217, v219
s_nop 0
v_permlane16_swap_b32 v216, v218
v_permlane16_swap_b32 v217, v219
buffer_store_dwordx4 v[216:219], v16, s[56:59], 0 offen offset:0 nt
L_done1:
s_cmp_gt_u32 s85, 2
s_cbranch_scc1 L_have2
s_waitcnt vmcnt(0)
L_spin16:
v_cmp_gt_u32 vcc, s84, v18
s_nop 0
s_and_b64 vcc, vcc, s[78:79]
s_cbranch_scc0 L_spun16
s_sleep 6
buffer_load_dword v18, v12, s[40:43], 0 offen sc1
s_waitcnt vmcnt(0)
s_sub_u32 s68, s68, 1
s_cbranch_scc0 L_spin16
s_mov_b32 s68, 0
L_spun16:
v_add_u32 v20, 65536, v14
s_mov_b32 s82, 0
buffer_load_dwordx4 v[136:139], v20, s[48:51], s82 offen sc1
s_mov_b32 s82, 2359296
buffer_load_dwordx4 v[140:143], v20, s[48:51], s82 offen sc1
s_mov_b32 s82, 4718592
buffer_load_dwordx4 v[144:147], v20, s[48:51], s82 offen sc1
s_mov_b32 s82, 7077888
buffer_load_dwordx4 v[148:151], v20, s[48:51], s82 offen sc1
s_mov_b32 s82, 9437184
buffer_load_dwordx4 v[152:155], v20, s[48:51], s82 offen sc1
s_mov_b32 s82, 11796480
buffer_load_dwordx4 v[156:159], v20, s[48:51], s82 offen sc1
s_mov_b32 s82, 14155776
buffer_load_dwordx4 v[160:163], v20, s[48:51], s82 offen sc1
s_mov_b32 s82, 16515072
buffer_load_dwordx4 v[164:167], v20, s[48:51], s82 offen sc1
s_add_u32 s84, s84, 2
L_have2:
s_cmp_gt_u32 s83, 1
s_cbranch_scc1 L_done2
s_cmp_gt_u32 s85, 2
s_cbranch_scc1 L_wa17
s_waitcnt vmcnt(8)
s_branch L_wb17
L_wa17:
s_waitcnt vmcnt(0)
L_wb17:
mzvvv 246 234 220
mzvvv 250 232 220
mzvvv 238 234 104
mzvvv 242 232 104
mvvv 238 234 108
mvvv 242 232 108
mvvv 238 234 112
mvvv 242 232 112
mvvv 238 234 116
mvvv 242 232 116
mvvv 238 234 120
mvvv 242 232 120
mvvv 238 234 124
mvvv 242 232 124
mvvv 238 234 128
mvvv 242 232 128
mvvv 238 234 132
mvvv 242 232 132
L_pgf16:
s_cbranch_execz L_pgf_back
s_nop 6
v_fmac_f32 v246, v238, v40
v_fmac_f32 v247, v239, v41
v_fmac_f32 v248, v240, v42
v_fmac_f32 v249, v241, v43
v_fmac_f32 v250, v242, v44
v_fmac_f32 v251, v243, v45
v_fmac_f32 v252, v244, v46
v_fmac_f32 v253, v245, v47
cvt 220 246 247
cvt 221 248 249
cvt 222 250 251
cvt 223 252 253
s_nop 0
v_permlane32_swap_b32 v220, v222
v_permlane32_swap_b32 v221, v223
s_nop 0
v_permlane16_swap_b32 v220, v222
v_permlane16_swap_b32 v221, v223
buffer_store_dwordx4 v[220:223], v16, s[56:59], 0 offen offset:256 nt
L_done2:
s_cmp_gt_u32 s85, 3
s_cbranch_scc1 L_have3
s_waitcnt vmcnt(0)
L_spin18:
v_cmp_gt_u32 vcc, s84, v18
s_nop 0
s_and_b64 vcc, vcc, s[78:79]
s_cbranch_scc0 L_spun18
s_sleep 6
buffer_load_dword v18, v12, s[40:43], 0 offen sc1
s_waitcnt vmcnt(0)
s_sub_u32 s68, s68, 1
s_cbranch_scc0 L_spin18
s_mov_b32 s68, 0
L_spun18:
v_add_u32 v20, 98304, v14
s_mov_b32 s82, 0
buffer_load_dwordx4 a[160:163], v20, s[48:51], s82 offen sc1
s_mov_b32 s82, 2359296
buffer_load_dwordx4 a[164:167], v20, s[48:51], s82 offen sc1
s_mov_b32 s82, 4718592
buffer_load_dwordx4 a[168:171], v20, s[48:51], s82 offen sc1
s_mov_b32 s82, 7077888
buffer_load_dwordx4 a[172:175], v20, s[48:51], s82 offen sc1
s_mov_b32 s82, 9437184
buffer_load_dwordx4 a[176:179], v20, s[48:51], s82 offen sc1
s_mov_b32 s82, 11796480
buffer_load_dwordx4 a[180:183], v20, s[48:51], s82 offen sc1
s_mov_b32 s82, 14155776
buffer_load_dwordx4 a[184:187], v20, s[48:51], s82 offen sc1
s_mov_b32 s82, 16515072
buffer_load_dwordx4 a[188:191], v20, s[48:51], s82 offen sc1
s_add_u32 s84, s84, 2
L_have3:
s_cmp_gt_u32 s83, 2
s_cbranch_scc1 L_done3
s_cmp_gt_u32 s85, 3
s_cbranch_scc1 L_wa19
s_waitcnt vmcnt(8)
s_branch L_wb19
L_wa19:
s_waitcnt vmcnt(0)
L_wb19:
mzvvv 246 234 224
mzvvv 250 232 224
mzvvv 238 234 136
mzvvv 242 232 136
mvvv 238 234 140
mvvv 242 232 140
mvvv 238 234 144
mvvv 242 232 144
mvvv 238 234 148
mvvv 242 232 148
mvvv 238 234 152
mvvv 242 232 152
mvvv 238 234 156
mvvv 242 232 156
mvvv 238 234 160
mvvv 242 232 160
mvvv 238 234 164
mvvv 242 232 164
s_nop 6
v_fmac_f32 v246, v238, v48
v_fmac_f32 v247, v239, v49
v_fmac_f32 v248, v240, v50
v_fmac_f32 v249, v241, v51
v_fmac_f32 v250, v242, v52
v_fmac_f32 v251, v243, v53
v_fmac_f32 v252, v244, v54
v_fmac_f32 v253, v245, v55
cvt 224 246 247
cvt 225 248 249
cvt 226 250 251
cvt 227 252 253
s_nop 0
v_permlane32_swap_b32 v224, v226
v_permlane32_swap_b32 v225, v227
s_nop 0
v_permlane16_swap_b32 v224, v226
v_permlane16_swap_b32 v225, v227
buffer_store_dwordx4 v[224:227], v16, s[56:59], 0 offen offset:512 nt
L_done3:
s_cmp_lg_u32 s75, 0
s_cbranch_scc1 L_last3
s_cmp_le_u32 s85, 3
s_cbranch_scc1 L_pv
s_waitcnt vmcnt(0)
L_pv:
L_spin20:
v_cmp_gt_u32 vcc, s84, v18
s_nop 0
s_and_b64 vcc, vcc, s[78:79]
s_cbranch_scc0 L_spun20
s_sleep 6
buffer_load_dword v18, v12, s[40:43], 0 offen sc1
s_waitcnt vmcnt(0)
s_sub_u32 s68, s68, 1
s_cbranch_scc0 L_spin20
s_mov_b32 s68, 0
L_spun20:
v_add_u32 v20, 131072, v14
s_mov_b32 s82, 0
buffer_load_dwordx4 a[192:195], v20, s[48:51], s82 offen sc1
s_mov_b32 s82, 2359296
buffer_load_dwordx4 a[196:199], v20, s[48:51], s82 offen sc1
s_mov_b32 s82, 4718592
buffer_load_dwordx4 a[200:203], v20, s[48:51], s82 offen sc1
s_mov_b32 s82, 7077888
buffer_load_dwordx4 a[204:207], v20, s[48:51], s82 offen sc1
s_mov_b32 s82, 9437184
buffer_load_dwordx4 a[208:211], v20, s[48:51], s82 offen sc1
s_mov_b32 s82, 11796480
buffer_load_dwordx4 a[212:215], v20, s[48:51], s82 offen sc1
s_mov_b32 s82, 14155776
buffer_load_dwordx4 a[216:219], v20, s[48:51], s82 offen sc1
s_mov_b32 s82, 16515072
buffer_load_dwordx4 a[220:223], v20, s[48:51], s82 offen sc1
s_waitcnt vmcnt(8)
mzvvv 246 234 228
mzvvv 250 232 228
mzvva 238 234 160
mzvva 242 232 160
mvva 238 234 164
mvva 242 232 164
mvva 238 234 168
mvva 242 232 168
mvva 238 234 172
mvva 242 232 172
mvva 238 234 176
mvva 242 232 176
mvva 238 234 180
mvva 242 232 180
mvva 238 234 184
mvva 242 232 184
mvva 238 234 188
mvva 242 232 188
s_nop 6
v_fmac_f32 v246, v238, v56
v_fmac_f32 v247, v239, v57
v_fmac_f32 v248, v240, v58
v_fmac_f32 v249, v241, v59
v_fmac_f32 v250, v242, v60
v_fmac_f32 v251, v243, v61
v_fmac_f32 v252, v244, v62
v_fmac_f32 v253, v245, v63
cvt 228 246 247
cvt 229 248 249
cvt 230 250 251
cvt 231 252 253
s_nop 0
v_permlane32_swap_b32 v228, v230
v_permlane32_swap_b32 v229, v231
s_nop 0
v_permlane16_swap_b32 v228, v230
v_permlane16_swap_b32 v229, v231
buffer_store_dwordx4 v[228:231], v16, s[56:59], 0 offen offset:768 nt
s_waitcnt vmcnt(0)
mzvvv 246 234 24
mzvvv 250 232 24
mzvva 238 234 192
mzvva 242 232 192
mvva 238 234 196
mvva 242 232 196
mvva 238 234 200
mvva 242 232 200
mvva 238 234 204
mvva 242 232 204
mvva 238 234 208
mvva 242 232 208
mvva 238 234 212
mvva 242 232 212
mvva 238 234 216
mvva 242 232 216
mvva 238 234 220
mvva 242 232 220
s_nop 6
v_fmac_f32 v246, v238, v64
v_fmac_f32 v247, v239, v65
v_fmac_f32 v248, v240, v66
v_fmac_f32 v249, v241, v67
v_fmac_f32 v250, v242, v68
v_fmac_f32 v251, v243, v69
v_fmac_f32 v252, v244, v70
v_fmac_f32 v253, v245, v71
cvt 24 246 247
cvt 25 248 249
cvt 26 250 251
cvt 27 252 253
s_nop 0
v_permlane32_swap_b32 v24, v26
v_permlane32_swap_b32 v25, v27
s_nop 0
v_permlane16_swap_b32 v24, v26
v_permlane16_swap_b32 v25, v27
buffer_store_dwordx4 v[24:27], v16, s[56:59], 0 offen offset:1024 nt
s_branch L_cdone
L_last3:
s_waitcnt vmcnt(0)
mzvvv 246 234 228
mzvvv 250 232 228
mzvva 238 234 160
mzvva 242 232 160
mvva 238 234 164
mvva 242 232 164
mvva 238 234 168
mvva 242 232 168
mvva 238 234 172
mvva 242 232 172
mvva 238 234 176
mvva 242 232 176
mvva 238 234 180
mvva 242 232 180
mvva 238 234 184
mvva 242 232 184
mvva 238 234 188
mvva 242 232 188
s_nop 6
v_fmac_f32 v246, v238, v56
v_fmac_f32 v247, v239, v57
v_fmac_f32 v248, v240, v58
v_fmac_f32 v249, v241, v59
v_fmac_f32 v250, v242, v60
v_fmac_f32 v251, v243, v61
v_fmac_f32 v252, v244, v62
v_fmac_f32 v253, v245, v63
cvt 228 246 247
cvt 229 248 249
cvt 230 250 251
cvt 231 252 253
s_nop 0
v_permlane32_swap_b32 v228, v230
v_permlane32_swap_b32 v229, v231
s_nop 0
v_permlane16_swap_b32 v228, v230
v_permlane16_swap_b32 v229, v231
buffer_store_dwordx4 v[228:231], v16, s[56:59], 0 offen offset:768 nt
L_cdone:
s_endpgm
.p2align 12
L_end:
.section .rodata,"a"
.p2align 6
.amdhsa_kernel recurrent_scan__sliding_block_cached__swiglu_ffn__prompt_kernel
  .amdhsa_next_free_vgpr 512
  .amdhsa_next_free_sgpr 102
  .amdhsa_accum_offset 256
  .amdhsa_group_segment_fixed_size 0
  .amdhsa_kernarg_size 96
  .amdhsa_user_sgpr_count 2
  .amdhsa_user_sgpr_kernarg_segment_ptr 1
  .amdhsa_system_sgpr_workgroup_id_x 1
.end_amdhsa_kernel
```
